```python
import torch

def _softmax(x, axis=-1):
    return torch.softmax(x, dim=axis)

def _gelu(x):
    return torch.nn.functional.gelu(x, approximate='tanh')

def _silu(x):
    return torch.nn.functional.silu(x)

def _sigmoid(x):
    return torch.sigmoid(x)

def _layernorm(x, axis=-1, eps=1e-05):
    m = x.mean(dim=axis, keepdim=True)
    v = x.var(dim=axis, keepdim=True, unbiased=False)
    return (x - m) / torch.sqrt(v + eps)

def _scatter_add(tgt, idx, src, axis=0):
    return tgt.clone().index_add_(axis, idx, src)

def _segment_sum(src, seg, n):
    out = torch.zeros((n,) + src.shape[1:], dtype=src.dtype)
    return out.index_add_(0, seg, src)

def _pad(x, pw):
    flat = tuple((v for pair in reversed(pw) for v in pair))
    return torch.nn.functional.pad(x, flat)
kernel_name = 'gated_mix__memory_aug_recurrent_mem_tr__linear_attn_block__prompt'

def setup_inputs():

    _w = lambda a: (lambda t: t.to(torch.bfloat16) if t.is_floating_point() else t)(torch.as_tensor(a))

    def _A_setup():
        B, S, Dm = (1, 2048, 576)
        H, Dh = (32, 128)
        M, seg = (8, 32)
        seg = min(seg, S)
        S = S // seg * seg
        return {'x': _w((lambda *s: torch.randn(*s, dtype=torch.bfloat16) * 0.05)(B, S, Dm)), 'mem0': _w((lambda *s: torch.randn(*s, dtype=torch.bfloat16) * 0.8)(B, M, Dm)), 'Wq': _w((lambda *s: torch.randn(*s, dtype=torch.bfloat16) * 3.2)(Dm, H, Dh) * Dm ** (-0.5)), 'Wk': _w((lambda *s: torch.randn(*s, dtype=torch.bfloat16) * 3.2)(Dm, H, Dh) * Dm ** (-0.5)), 'Wv': _w((lambda *s: torch.randn(*s, dtype=torch.bfloat16) * 0.8)(Dm, H, Dh) * Dm ** (-0.5)), 'Wo': _w((lambda *s: torch.randn(*s, dtype=torch.bfloat16) * 0.8)(H, Dh, Dm) * (H * Dh) ** (-0.5)), 'seg_len': seg}
    _A_in = _A_setup()

    def _B_setup():
        B, S, D = (1, 2048, 576)
        return {'x': _w((lambda *s: torch.randn(*s, dtype=torch.bfloat16) * 0.05)(B, S, D)), 'wqkv': _w((lambda *s: torch.randn(*s, dtype=torch.bfloat16) * 0.8)(D, 3 * D)), 'wo': _w((lambda *s: torch.randn(*s, dtype=torch.bfloat16) * 0.2)(D, D))}
    _B_in = _B_setup()
    return {'A_x': _A_in['x'], 'A_mem0': _A_in['mem0'], 'A_Wq': _A_in['Wq'], 'A_Wk': _A_in['Wk'], 'A_Wv': _A_in['Wv'], 'A_Wo': _A_in['Wo'], 'A_seg_len': _A_in['seg_len'], 'B_x': _B_in['x'], 'B_wqkv': _B_in['wqkv'], 'B_wo': _B_in['wo'], 'gate_w': _w((lambda *s: torch.randn(*s, dtype=torch.bfloat16) * 0.05)(576) * 16.0)}

def reference(A_x, A_mem0, A_Wq, A_Wk, A_Wv, A_Wo, A_seg_len, B_x, B_wqkv, B_wo, gate_w):

    def _A_ref(x, mem0, Wq, Wk, Wv, Wo, seg_len):
        B, S, Dm = x.shape
        H, Dh = (Wq.shape[1], Wq.shape[2])
        M = mem0.shape[1]
        scale = Dh ** (-0.5)
        n_seg = S // seg_len
        L = M + seg_len
        idx = torch.arange(L)
        mask = (idx[:, None] < M) | (idx[:, None] >= idx[None, :])
        mem = mem0
        outs = []
        for s in range(n_seg):
            xs = x[:, s * seg_len:(s + 1) * seg_len, :].clone()
            h = torch.concatenate([mem, xs], axis=1)
            q = torch.einsum('btd,dhe->bhte', h, Wq)
            k = torch.einsum('btd,dhe->bhte', h, Wk)
            v = torch.einsum('btd,dhe->bhte', h, Wv)
            scores = torch.einsum('bhqe,bhke->bhqk', q, k) * scale
            scores = torch.where(mask[None, None], scores, -1000000000.0)
            p = _softmax(scores, axis=-1)
            o = torch.einsum('bhqk,bhke->bhqe', p, v)
            o = torch.einsum('bhte,hed->btd', o, Wo)
            mem = o[:, :M, :].clone()
            outs.append(o[:, M:, :])
        return torch.concatenate(outs, axis=1)

    def _B_ref(x, wqkv, wo):
        B, S, D = x.shape
        H = 32
        Dh = D // H
        qkv = (lambda x, *d: x.permute(*d))((x @ wqkv).reshape(B, S, 3, H, Dh), 2, 0, 3, 1, 4)
        q, k, v = (qkv[0], qkv[1], qkv[2])
        phi = lambda t: torch.where(t > 0, t + 1, torch.exp(t)) + 1e-06
        pq, pk = (phi(q), phi(k))
        kv = torch.einsum('bhsd,bhse->bhde', pk, v)
        z = torch.einsum('bhsd->bhd', pk)
        num = torch.einsum('bhqd,bhde->bhqe', pq, kv)
        den = torch.einsum('bhqd,bhd->bhq', pq, z)[..., None] + 1e-06
        o = num / den
        return (lambda x, *d: x.permute(*d))(o, 0, 2, 1, 3).reshape(B, S, D) @ wo
    x = A_x
    g = _sigmoid((x * gate_w).sum(-1, keepdims=True))
    a = _A_ref(x, A_mem0, A_Wq, A_Wk, A_Wv, A_Wo, A_seg_len)
    b = _B_ref(x, B_wqkv, B_wo)
    return g * a + (1 - g) * b
```

```asm
; @launch grid=(256,1,1) block=(256,1,1) lds=163840
.amdgcn_target "amdgcn-amd-amdhsa--gfx950"
.text
.globl gated_mix__memory_aug_recurrent_mem_tr__linear_attn_block__prompt_kernel
.p2align 8
.type gated_mix__memory_aug_recurrent_mem_tr__linear_attn_block__prompt_kernel,@function
gated_mix__memory_aug_recurrent_mem_tr__linear_attn_block__prompt_kernel:
    s_cmp_ge_u32 s2, 256
    s_cbranch_scc1 X_DONE
    s_load_dwordx2 s[4:5], s[0:1], 104
    s_mov_b32 s6, 268435456
    s_mov_b32 s7, 0x20000
    s_load_dwordx2 s[12:13], s[0:1], 96
    s_mov_b32 s14, 256
    s_mov_b32 s15, 0x20000
    s_getreg_b32 s3, hwreg(HW_REG_XCC_ID, 0, 3)
    v_lshrrev_b32 v1, 6, v0
    v_mov_b32 v2, 1
    v_readfirstlane_b32 s20, v1
    s_lshl_b32 s21, s3, 4
    v_mov_b32 v3, s21
    v_mov_b32 v4, 0
    s_mov_b32 s22, 2000000
    s_mov_b32 s23, 0
    s_lshl_b32 s24, s2, 12
    v_lshlrev_b32 v5, 4, v0
    v_add_u32 v5, s24, v5
    v_mov_b32 v8, 0xffbfffbf
    v_mov_b32 v12, 0
    v_mov_b32 v9, 0xffbfffbf
    v_mov_b32 v13, 0
    v_mov_b32 v10, 0xffbfffbf
    v_mov_b32 v14, 0
    v_mov_b32 v11, 0xffbfffbf
    v_mov_b32 v15, 0
    s_mov_b32 s25, 0x800000
    s_mov_b32 s26, 0xf0000
    s_mov_b32 s27, 0x200000
    s_waitcnt lgkmcnt(0)
    s_cmp_lg_u32 s20, 0
    s_cbranch_scc1 ROLE_I
    s_mov_b64 exec, 1
    buffer_atomic_add v2, v3, s[12:15], 0 offen sc0
    s_mov_b64 exec, -1
ROLE_I:
    buffer_store_dwordx4 v[12:15], v5, s[4:7], s25 offen sc1
    s_cmp_ge_u32 s2, 176
    s_cbranch_scc1 ROLE_I2
    buffer_store_dwordx4 v[8:11], v5, s[4:7], s26 offen sc1
    s_cmp_ge_u32 s2, 16
    s_cbranch_scc1 ROLE_I2
    buffer_store_dwordx4 v[12:15], v5, s[4:7], s27 offen sc1
ROLE_I2:
    s_waitcnt vmcnt(0)
    s_barrier
    s_cmp_lg_u32 s20, 0
    s_cbranch_scc1 ROLE_WAIT
    s_mov_b64 exec, 1
    v_readfirstlane_b32 s24, v2
    v_mov_b32 v2, 1
    buffer_atomic_add v2, v4, s[12:15], s23 offen offset:128
    s_lshl_b32 s21, s3, 5
    s_add_u32 s21, s21, s24
    s_cmp_lt_u32 s24, 32
    s_cbranch_scc1 ROLE_SET
    v_mov_b32 v5, 1
    buffer_atomic_add v5, v4, s[12:15], s23 offen offset:192 sc0
ROLE_P:
    buffer_load_dword v6, v4, s[12:15], s23 offen offset:128 sc1
    s_waitcnt vmcnt(0)
    v_readfirstlane_b32 s24, v6
    s_sub_u32 s22, s22, 1
    s_cbranch_scc1 ROLE_GIVEUP
    s_cmp_lt_u32 s24, 256
    s_cbranch_scc1 ROLE_P
    v_readfirstlane_b32 s25, v5
    buffer_load_dword v6, v4, s[12:15], s23 offen offset:0 sc1
    s_waitcnt vmcnt(0)
    v_readfirstlane_b32 s24, v6
    s_nop 0
    s_min_u32 s24, s24, 32
    s_sub_u32 s26, 32, s24
    s_add_u32 s21, s24, s25
    s_add_u32 s21, s21, 0
    s_cmp_lt_u32 s25, s26
    s_cbranch_scc1 ROLE_SET
    s_sub_u32 s25, s25, s26
    buffer_load_dword v6, v4, s[12:15], s23 offen offset:16 sc1
    s_waitcnt vmcnt(0)
    v_readfirstlane_b32 s24, v6
    s_nop 0
    s_min_u32 s24, s24, 32
    s_sub_u32 s26, 32, s24
    s_add_u32 s21, s24, s25
    s_add_u32 s21, s21, 32
    s_cmp_lt_u32 s25, s26
    s_cbranch_scc1 ROLE_SET
    s_sub_u32 s25, s25, s26
    buffer_load_dword v6, v4, s[12:15], s23 offen offset:32 sc1
    s_waitcnt vmcnt(0)
    v_readfirstlane_b32 s24, v6
    s_nop 0
    s_min_u32 s24, s24, 32
    s_sub_u32 s26, 32, s24
    s_add_u32 s21, s24, s25
    s_add_u32 s21, s21, 64
    s_cmp_lt_u32 s25, s26
    s_cbranch_scc1 ROLE_SET
    s_sub_u32 s25, s25, s26
    buffer_load_dword v6, v4, s[12:15], s23 offen offset:48 sc1
    s_waitcnt vmcnt(0)
    v_readfirstlane_b32 s24, v6
    s_nop 0
    s_min_u32 s24, s24, 32
    s_sub_u32 s26, 32, s24
    s_add_u32 s21, s24, s25
    s_add_u32 s21, s21, 96
    s_cmp_lt_u32 s25, s26
    s_cbranch_scc1 ROLE_SET
    s_sub_u32 s25, s25, s26
    buffer_load_dword v6, v4, s[12:15], s23 offen offset:64 sc1
    s_waitcnt vmcnt(0)
    v_readfirstlane_b32 s24, v6
    s_nop 0
    s_min_u32 s24, s24, 32
    s_sub_u32 s26, 32, s24
    s_add_u32 s21, s24, s25
    s_add_u32 s21, s21, 128
    s_cmp_lt_u32 s25, s26
    s_cbranch_scc1 ROLE_SET
    s_sub_u32 s25, s25, s26
    buffer_load_dword v6, v4, s[12:15], s23 offen offset:80 sc1
    s_waitcnt vmcnt(0)
    v_readfirstlane_b32 s24, v6
    s_nop 0
    s_min_u32 s24, s24, 32
    s_sub_u32 s26, 32, s24
    s_add_u32 s21, s24, s25
    s_add_u32 s21, s21, 160
    s_cmp_lt_u32 s25, s26
    s_cbranch_scc1 ROLE_SET
    s_sub_u32 s25, s25, s26
    buffer_load_dword v6, v4, s[12:15], s23 offen offset:96 sc1
    s_waitcnt vmcnt(0)
    v_readfirstlane_b32 s24, v6
    s_nop 0
    s_min_u32 s24, s24, 32
    s_sub_u32 s26, 32, s24
    s_add_u32 s21, s24, s25
    s_add_u32 s21, s21, 192
    s_cmp_lt_u32 s25, s26
    s_cbranch_scc1 ROLE_SET
    s_sub_u32 s25, s25, s26
    buffer_load_dword v6, v4, s[12:15], s23 offen offset:112 sc1
    s_waitcnt vmcnt(0)
    v_readfirstlane_b32 s24, v6
    s_nop 0
    s_min_u32 s24, s24, 32
    s_sub_u32 s26, 32, s24
    s_add_u32 s21, s24, s25
    s_add_u32 s21, s21, 224
    s_cmp_lt_u32 s25, s26
    s_cbranch_scc1 ROLE_SET
    s_sub_u32 s25, s25, s26
ROLE_GIVEUP:
    s_mov_b32 s21, 1000
ROLE_SET:
    v_mov_b32 v2, s21
    ds_write_b32 v4, v2
    s_mov_b64 exec, -1
    s_waitcnt lgkmcnt(0)
ROLE_WAIT:
    s_barrier
    ds_read_b32 v2, v4
    s_waitcnt lgkmcnt(0)
    v_readfirstlane_b32 s21, v2
    s_barrier
    s_cmp_ge_u32 s21, 256
    s_cbranch_scc1 X_DONE
    s_mov_b32 s96, s21
    s_mov_b32 s66, 0
    s_mov_b32 s16, s21
    s_cmp_lt_u32 s21, 32
    s_cbranch_scc1 TEAM
    s_lshr_b32 s22, s21, 5
    s_sub_u32 s22, s22, 1
    s_and_b32 s23, s21, 31
    s_mul_i32 s24, s22, 27
    s_add_u32 s24, s24, s23
    s_sub_u32 s24, s24, 5
    s_cmp_ge_u32 s23, 5
    s_cbranch_scc1 RANK_J
    s_mul_i32 s25, s22, 5
    s_add_u32 s25, s25, s23
    s_add_u32 s24, s25, 157
    s_cmp_ge_u32 s25, 32
    s_cbranch_scc1 RANK_J
    s_add_u32 s68, s25, 128
    s_mov_b32 s16, s25
    s_mov_b32 s66, 1
    s_add_u32 s96, s68, 32
    s_branch TEAM
RANK_J:
    s_cmp_ge_u32 s24, 128
    s_cselect_b32 s25, 32, 0
    s_add_u32 s68, s24, s25
    s_add_u32 s96, s68, 32
    s_branch WORKER
TEAM:
    s_load_dwordx2 s[4:5], s[0:1], 104
    s_load_dwordx2 s[48:49], s[0:1], 16
    s_load_dwordx2 s[50:51], s[0:1], 24
    s_load_dwordx2 s[52:53], s[0:1], 32
    s_load_dwordx2 s[54:55], s[0:1], 40
    s_load_dwordx2 s[56:57], s[0:1], 8
    v_lshrrev_b32 v1, 6, v0
    v_and_b32 v0, 63, v0
    v_readfirstlane_b32 s17, v1
    s_mov_b32 s6, 268435456
    s_mov_b32 s7, 0x20000
    s_mov_b32 s10, 4718592
    s_mov_b32 s11, 0x20000
    s_mov_b32 s32, 0x00ff00ff
    s_mov_b32 s33, 0x00ff00ff
    s_mov_b32 s34, 0xff00ff00
    s_mov_b32 s35, 0xff00ff00
    s_mov_b32 s36, 0x3e0293ee
    s_mov_b32 s19, 1000000
    s_mov_b32 s92, s36
    s_mov_b32 s93, s36
    s_mov_b32 s94, 0x3e800000
    s_mov_b32 s95, 0x3e800000
    s_xor_b32 s91, s36, 0x80000000
    s_mov_b32 s47, 0xffbfffbf
    s_lshl_b32 s37, s17, 9
    v_and_b32 v1, 15, v0
    v_lshrrev_b32 v2, 4, v0
    v_bfe_u32 v3, v0, 2, 2
    v_and_b32 v4, 3, v0
    v_lshlrev_b32 v73, 4, v0
    v_mov_b32 v72, 0x4444
    v_mov_b32 v5, 0xeeee
    v_cndmask_b32 v72, v72, v5, s[34:35]
    v_lshl_add_u32 v5, v2, 2, v3
    v_lshlrev_b32 v5, 4, v5
    v_and_b32 v6, 1, v4
    v_lshl_add_u32 v74, v6, 3, v5
    v_lshrrev_b32 v5, 5, v0
    v_lshl_add_u32 v5, v5, 4, v1
    v_lshlrev_b32 v5, 4, v5
    v_and_b32 v6, 1, v2
    v_lshl_add_u32 v75, v6, 3, v5
    v_and_b32 v5, 7, v0
    v_lshl_add_u32 v5, v2, 3, v5
    v_lshlrev_b32 v76, 4, v5
    s_waitcnt lgkmcnt(0)
    s_lshl_b32 s31, s16, 2
    s_add_u32 s31, s31, s17
    s_lshl_b32 s31, s31, 13
    s_add_u32 s44, s31, 0x300000
    s_lshl_b32 s28, s17, 5
    s_add_u32 s28, s28, s16
    s_load_dwordx2 s[12:13], s[0:1], 96
    s_mov_b32 s14, 256
    s_mov_b32 s15, 0x20000
    s_waitcnt lgkmcnt(0)
    v_and_b32 v5, 1, v2
    s_lshl_b32 s31, s17, 1
    v_or_b32 v5, s31, v5
    v_lshlrev_b32 v5, 1, v5
    v_xor_b32 v5, v5, v1
    v_lshlrev_b32 v5, 4, v5
    v_lshl_add_u32 v8, v2, 13, v5
    s_lshl_b32 s31, s17, 15
    s_lshl_b32 s38, s16, 8
    s_add_u32 s31, s31, s38
    v_add_u32 v8, s31, v8
    v_and_b32 v5, 1, v2
    s_and_b32 s31, s17, 1
    s_lshl_b32 s31, s31, 1
    v_or_b32 v5, s31, v5
    v_lshlrev_b32 v5, 2, v5
    v_xor_b32 v5, v5, v1
    v_lshlrev_b32 v5, 4, v5
    v_mul_u32_u24 v6, 1152, v2
    v_add_u32 v9, v5, v6
    s_mul_i32 s31, s17, 18432
    s_mul_i32 s38, s16, 147456
    s_add_u32 s31, s31, s38
    v_add_u32 v9, s31, v9
    v_and_b32 v5, 7, v0
    v_lshlrev_b32 v5, 4, v5
    v_lshrrev_b32 v6, 3, v0
    v_mul_u32_u24 v6, 1152, v6
    s_mul_i32 s31, s17, 36864
    s_add_u32 s31, s31, s38
    s_add_u32 s31, s31, 1024
    v_add_u32 v6, s31, v6
    v_add_u32 v60, v5, v6
    v_xor_b32 v5, 64, v5
    v_add_u32 v61, v5, v6
    v_lshrrev_b32 v5, 1, v2
    v_lshlrev_b32 v5, 4, v5
    v_and_b32 v6, 1, v2
    v_lshl_add_u32 v5, v6, 2, v5
    v_and_b32 v7, 1, v3
    v_add_u32 v5, v5, v7
    v_lshrrev_b32 v10, 1, v3
    v_lshl_add_u32 v5, v10, 3, v5
    v_lshl_or_b32 v11, v6, 1, v7
    v_lshl_or_b32 v11, v10, 2, v11
    s_lshl_b32 s31, s17, 1
    v_xor_b32 v12, s31, v11
    v_lshlrev_b32 v12, 5, v12
    v_lshl_add_u32 v12, v4, 3, v12
    v_lshl_add_u32 v12, v5, 8, v12
    v_add_u32 v12, 16384, v12
    v_xor_b32 v13, 32, v12
    v_lshrrev_b32 v5, 1, v2
    v_lshl_add_u32 v5, v5, 2, v7
    v_lshl_add_u32 v5, v6, 4, v5
    v_lshl_or_b32 v14, v6, 1, v7
    v_lshl_or_b32 v14, v14, 1, v10
    s_lshl_b32 s31, s17, 1
    v_xor_b32 v14, s31, v14
    v_lshlrev_b32 v14, 5, v14
    v_lshl_add_u32 v14, v4, 3, v14
    v_lshl_add_u32 v14, v5, 8, v14
    v_add_u32 v14, 16384, v14
    v_lshl_or_b32 v62, v6, 1, v10
    v_lshlrev_b32 v62, 5, v62
    v_lshl_add_u32 v62, v4, 3, v62
    v_lshl_add_u32 v62, v5, 7, v62
    s_lshl_b32 s31, s17, 12
    s_add_u32 s31, s31, 147456
    v_add_u32 v62, s31, v62
    v_xor_b32 v63, 64, v62
    v_add_u32 v64, s31, v73
    s_lshl_b32 s40, s17, 12
    s_lshl_b32 s31, s17, 11
    v_add_u32 v15, s31, v73
    v_add_u32 v15, 16384, v15
    s_lshl_b32 s39, s17, 10
    s_mov_b32 s8, s48
    s_mov_b32 s9, s49
    s_add_u32 m0, s39, 16384
    s_mov_b32 s31, 0
    buffer_load_dwordx4 v8, s[8:11], s31 offen lds
    s_add_u32 m0, s39, 20480
    s_mov_b32 s31, 131072
    buffer_load_dwordx4 v8, s[8:11], s31 offen lds
    s_add_u32 m0, s39, 24576
    s_mov_b32 s31, 262144
    buffer_load_dwordx4 v8, s[8:11], s31 offen lds
    s_add_u32 m0, s39, 28672
    s_mov_b32 s31, 393216
    buffer_load_dwordx4 v8, s[8:11], s31 offen lds
    s_add_u32 m0, s39, 32768
    s_mov_b32 s31, 524288
    buffer_load_dwordx4 v8, s[8:11], s31 offen lds
    s_add_u32 m0, s39, 36864
    s_mov_b32 s31, 655360
    buffer_load_dwordx4 v8, s[8:11], s31 offen lds
    s_add_u32 m0, s39, 40960
    s_mov_b32 s31, 786432
    buffer_load_dwordx4 v8, s[8:11], s31 offen lds
    s_add_u32 m0, s39, 45056
    s_mov_b32 s31, 917504
    buffer_load_dwordx4 v8, s[8:11], s31 offen lds
    s_add_u32 m0, s39, 49152
    s_mov_b32 s31, 1048576
    buffer_load_dwordx4 v8, s[8:11], s31 offen lds
    s_add_u32 m0, s39, 53248
    s_mov_b32 s31, 1179648
    buffer_load_dwordx4 v8, s[8:11], s31 offen lds
    s_add_u32 m0, s39, 57344
    s_mov_b32 s31, 1310720
    buffer_load_dwordx4 v8, s[8:11], s31 offen lds
    s_add_u32 m0, s39, 61440
    s_mov_b32 s31, 1441792
    buffer_load_dwordx4 v8, s[8:11], s31 offen lds
    s_add_u32 m0, s39, 65536
    s_mov_b32 s31, 1572864
    buffer_load_dwordx4 v8, s[8:11], s31 offen lds
    s_add_u32 m0, s39, 69632
    s_mov_b32 s31, 1703936
    buffer_load_dwordx4 v8, s[8:11], s31 offen lds
    s_add_u32 m0, s39, 73728
    s_mov_b32 s31, 1835008
    buffer_load_dwordx4 v8, s[8:11], s31 offen lds
    s_add_u32 m0, s39, 77824
    s_mov_b32 s31, 1966080
    buffer_load_dwordx4 v8, s[8:11], s31 offen lds
    s_add_u32 m0, s39, 81920
    s_mov_b32 s31, 2097152
    buffer_load_dwordx4 v8, s[8:11], s31 offen lds
    s_add_u32 m0, s39, 86016
    s_mov_b32 s31, 2228224
    buffer_load_dwordx4 v8, s[8:11], s31 offen lds
    s_add_u32 m0, s39, 90112
    s_mov_b32 s31, 2359296
    buffer_load_dwordx4 v8, s[8:11], s31 offen lds
    s_add_u32 m0, s39, 94208
    s_mov_b32 s31, 2490368
    buffer_load_dwordx4 v8, s[8:11], s31 offen lds
    s_add_u32 m0, s39, 98304
    s_mov_b32 s31, 2621440
    buffer_load_dwordx4 v8, s[8:11], s31 offen lds
    s_add_u32 m0, s39, 102400
    s_mov_b32 s31, 2752512
    buffer_load_dwordx4 v8, s[8:11], s31 offen lds
    s_add_u32 m0, s39, 106496
    s_mov_b32 s31, 2883584
    buffer_load_dwordx4 v8, s[8:11], s31 offen lds
    s_add_u32 m0, s39, 110592
    s_mov_b32 s31, 3014656
    buffer_load_dwordx4 v8, s[8:11], s31 offen lds
    s_add_u32 m0, s39, 114688
    s_mov_b32 s31, 3145728
    buffer_load_dwordx4 v8, s[8:11], s31 offen lds
    s_add_u32 m0, s39, 118784
    s_mov_b32 s31, 3276800
    buffer_load_dwordx4 v8, s[8:11], s31 offen lds
    s_add_u32 m0, s39, 122880
    s_mov_b32 s31, 3407872
    buffer_load_dwordx4 v8, s[8:11], s31 offen lds
    s_add_u32 m0, s39, 126976
    s_mov_b32 s31, 3538944
    buffer_load_dwordx4 v8, s[8:11], s31 offen lds
    s_add_u32 m0, s39, 131072
    s_mov_b32 s31, 3670016
    buffer_load_dwordx4 v8, s[8:11], s31 offen lds
    s_add_u32 m0, s39, 135168
    s_mov_b32 s31, 3801088
    buffer_load_dwordx4 v8, s[8:11], s31 offen lds
    s_add_u32 m0, s39, 139264
    s_mov_b32 s31, 3932160
    buffer_load_dwordx4 v8, s[8:11], s31 offen lds
    s_add_u32 m0, s39, 143360
    s_mov_b32 s31, 4063232
    buffer_load_dwordx4 v8, s[8:11], s31 offen lds
    s_add_u32 m0, s39, 147456
    s_mov_b32 s31, 4194304
    buffer_load_dwordx4 v8, s[8:11], s31 offen lds
    s_add_u32 m0, s39, 151552
    s_mov_b32 s31, 4325376
    buffer_load_dwordx4 v8, s[8:11], s31 offen lds
    s_add_u32 m0, s39, 155648
    s_mov_b32 s31, 4456448
    buffer_load_dwordx4 v8, s[8:11], s31 offen lds
    s_add_u32 m0, s39, 159744
    s_mov_b32 s31, 4587520
    buffer_load_dwordx4 v8, s[8:11], s31 offen lds
    s_waitcnt vmcnt(32) lgkmcnt(0)
    s_barrier
    v_add_u32 v16, 0, v12
    v_add_u32 v17, 0, v13
    ds_read_b64_tr_b16 a[0:1], v16 offset:0
    ds_read_b64_tr_b16 a[2:3], v16 offset:512
    ds_read_b64_tr_b16 a[4:5], v16 offset:8192
    ds_read_b64_tr_b16 a[6:7], v16 offset:8704
    ds_read_b64_tr_b16 a[8:9], v17 offset:0
    ds_read_b64_tr_b16 a[10:11], v17 offset:512
    ds_read_b64_tr_b16 a[12:13], v17 offset:8192
    ds_read_b64_tr_b16 a[14:15], v17 offset:8704
    s_waitcnt vmcnt(28) lgkmcnt(0)
    s_barrier
    s_mov_b32 s8, s50
    s_mov_b32 s9, s51
    s_add_u32 m0, s39, 16384
    s_mov_b32 s31, 0
    buffer_load_dwordx4 v8, s[8:11], s31 offen lds
    s_add_u32 m0, s39, 20480
    s_mov_b32 s31, 131072
    buffer_load_dwordx4 v8, s[8:11], s31 offen lds
    s_add_u32 m0, s39, 24576
    s_mov_b32 s31, 262144
    buffer_load_dwordx4 v8, s[8:11], s31 offen lds
    s_add_u32 m0, s39, 28672
    s_mov_b32 s31, 393216
    buffer_load_dwordx4 v8, s[8:11], s31 offen lds
    v_add_u32 v16, 16384, v12
    v_add_u32 v17, 16384, v13
    ds_read_b64_tr_b16 a[16:17], v16 offset:0
    ds_read_b64_tr_b16 a[18:19], v16 offset:512
    ds_read_b64_tr_b16 a[20:21], v16 offset:8192
    ds_read_b64_tr_b16 a[22:23], v16 offset:8704
    ds_read_b64_tr_b16 a[24:25], v17 offset:0
    ds_read_b64_tr_b16 a[26:27], v17 offset:512
    ds_read_b64_tr_b16 a[28:29], v17 offset:8192
    ds_read_b64_tr_b16 a[30:31], v17 offset:8704
    s_waitcnt vmcnt(28) lgkmcnt(0)
    s_barrier
    s_add_u32 m0, s39, 32768
    s_mov_b32 s31, 524288
    buffer_load_dwordx4 v8, s[8:11], s31 offen lds
    s_add_u32 m0, s39, 36864
    s_mov_b32 s31, 655360
    buffer_load_dwordx4 v8, s[8:11], s31 offen lds
    s_add_u32 m0, s39, 40960
    s_mov_b32 s31, 786432
    buffer_load_dwordx4 v8, s[8:11], s31 offen lds
    s_add_u32 m0, s39, 45056
    s_mov_b32 s31, 917504
    buffer_load_dwordx4 v8, s[8:11], s31 offen lds
    v_add_u32 v16, 32768, v12
    v_add_u32 v17, 32768, v13
    ds_read_b64_tr_b16 a[32:33], v16 offset:0
    ds_read_b64_tr_b16 a[34:35], v16 offset:512
    ds_read_b64_tr_b16 a[36:37], v16 offset:8192
    ds_read_b64_tr_b16 a[38:39], v16 offset:8704
    ds_read_b64_tr_b16 a[40:41], v17 offset:0
    ds_read_b64_tr_b16 a[42:43], v17 offset:512
    ds_read_b64_tr_b16 a[44:45], v17 offset:8192
    ds_read_b64_tr_b16 a[46:47], v17 offset:8704
    s_waitcnt vmcnt(28) lgkmcnt(0)
    s_barrier
    s_add_u32 m0, s39, 49152
    s_mov_b32 s31, 1048576
    buffer_load_dwordx4 v8, s[8:11], s31 offen lds
    s_add_u32 m0, s39, 53248
    s_mov_b32 s31, 1179648
    buffer_load_dwordx4 v8, s[8:11], s31 offen lds
    s_add_u32 m0, s39, 57344
    s_mov_b32 s31, 1310720
    buffer_load_dwordx4 v8, s[8:11], s31 offen lds
    s_add_u32 m0, s39, 61440
    s_mov_b32 s31, 1441792
    buffer_load_dwordx4 v8, s[8:11], s31 offen lds
    v_add_u32 v16, 49152, v12
    v_add_u32 v17, 49152, v13
    ds_read_b64_tr_b16 a[48:49], v16 offset:0
    ds_read_b64_tr_b16 a[50:51], v16 offset:512
    ds_read_b64_tr_b16 a[52:53], v16 offset:8192
    ds_read_b64_tr_b16 a[54:55], v16 offset:8704
    ds_read_b64_tr_b16 a[56:57], v17 offset:0
    ds_read_b64_tr_b16 a[58:59], v17 offset:512
    ds_read_b64_tr_b16 a[60:61], v17 offset:8192
    ds_read_b64_tr_b16 a[62:63], v17 offset:8704
    s_waitcnt vmcnt(28) lgkmcnt(0)
    s_barrier
    s_add_u32 m0, s39, 65536
    s_mov_b32 s31, 1572864
    buffer_load_dwordx4 v8, s[8:11], s31 offen lds
    s_add_u32 m0, s39, 69632
    s_mov_b32 s31, 1703936
    buffer_load_dwordx4 v8, s[8:11], s31 offen lds
    s_add_u32 m0, s39, 73728
    s_mov_b32 s31, 1835008
    buffer_load_dwordx4 v8, s[8:11], s31 offen lds
    s_add_u32 m0, s39, 77824
    s_mov_b32 s31, 1966080
    buffer_load_dwordx4 v8, s[8:11], s31 offen lds
    v_add_u32 v16, 65536, v12
    v_add_u32 v17, 65536, v13
    ds_read_b64_tr_b16 a[64:65], v16 offset:0
    ds_read_b64_tr_b16 a[66:67], v16 offset:512
    ds_read_b64_tr_b16 a[68:69], v16 offset:8192
    ds_read_b64_tr_b16 a[70:71], v16 offset:8704
    ds_read_b64_tr_b16 a[72:73], v17 offset:0
    ds_read_b64_tr_b16 a[74:75], v17 offset:512
    ds_read_b64_tr_b16 a[76:77], v17 offset:8192
    ds_read_b64_tr_b16 a[78:79], v17 offset:8704
    s_waitcnt vmcnt(28) lgkmcnt(0)
    s_barrier
    s_add_u32 m0, s39, 81920
    s_mov_b32 s31, 2097152
    buffer_load_dwordx4 v8, s[8:11], s31 offen lds
    s_add_u32 m0, s39, 86016
    s_mov_b32 s31, 2228224
    buffer_load_dwordx4 v8, s[8:11], s31 offen lds
    s_add_u32 m0, s39, 90112
    s_mov_b32 s31, 2359296
    buffer_load_dwordx4 v8, s[8:11], s31 offen lds
    s_add_u32 m0, s39, 94208
    s_mov_b32 s31, 2490368
    buffer_load_dwordx4 v8, s[8:11], s31 offen lds
    v_add_u32 v16, 81920, v12
    v_add_u32 v17, 81920, v13
    ds_read_b64_tr_b16 a[80:81], v16 offset:0
    ds_read_b64_tr_b16 a[82:83], v16 offset:512
    ds_read_b64_tr_b16 a[84:85], v16 offset:8192
    ds_read_b64_tr_b16 a[86:87], v16 offset:8704
    ds_read_b64_tr_b16 a[88:89], v17 offset:0
    ds_read_b64_tr_b16 a[90:91], v17 offset:512
    ds_read_b64_tr_b16 a[92:93], v17 offset:8192
    ds_read_b64_tr_b16 a[94:95], v17 offset:8704
    s_waitcnt vmcnt(28) lgkmcnt(0)
    s_barrier
    s_add_u32 m0, s39, 98304
    s_mov_b32 s31, 2621440
    buffer_load_dwordx4 v8, s[8:11], s31 offen lds
    s_add_u32 m0, s39, 102400
    s_mov_b32 s31, 2752512
    buffer_load_dwordx4 v8, s[8:11], s31 offen lds
    s_add_u32 m0, s39, 106496
    s_mov_b32 s31, 2883584
    buffer_load_dwordx4 v8, s[8:11], s31 offen lds
    s_add_u32 m0, s39, 110592
    s_mov_b32 s31, 3014656
    buffer_load_dwordx4 v8, s[8:11], s31 offen lds
    v_add_u32 v16, 98304, v12
    v_add_u32 v17, 98304, v13
    ds_read_b64_tr_b16 a[96:97], v16 offset:0
    ds_read_b64_tr_b16 a[98:99], v16 offset:512
    ds_read_b64_tr_b16 a[100:101], v16 offset:8192
    ds_read_b64_tr_b16 a[102:103], v16 offset:8704
    ds_read_b64_tr_b16 a[104:105], v17 offset:0
    ds_read_b64_tr_b16 a[106:107], v17 offset:512
    ds_read_b64_tr_b16 a[108:109], v17 offset:8192
    ds_read_b64_tr_b16 a[110:111], v17 offset:8704
    s_waitcnt vmcnt(28) lgkmcnt(0)
    s_barrier
    s_add_u32 m0, s39, 114688
    s_mov_b32 s31, 3145728
    buffer_load_dwordx4 v8, s[8:11], s31 offen lds
    s_add_u32 m0, s39, 118784
    s_mov_b32 s31, 3276800
    buffer_load_dwordx4 v8, s[8:11], s31 offen lds
    s_add_u32 m0, s39, 122880
    s_mov_b32 s31, 3407872
    buffer_load_dwordx4 v8, s[8:11], s31 offen lds
    s_add_u32 m0, s39, 126976
    s_mov_b32 s31, 3538944
    buffer_load_dwordx4 v8, s[8:11], s31 offen lds
    v_add_u32 v16, 114688, v12
    v_add_u32 v17, 114688, v13
    ds_read_b64_tr_b16 a[112:113], v16 offset:0
    ds_read_b64_tr_b16 a[114:115], v16 offset:512
    ds_read_b64_tr_b16 a[116:117], v16 offset:8192
    ds_read_b64_tr_b16 a[118:119], v16 offset:8704
    ds_read_b64_tr_b16 a[120:121], v17 offset:0
    ds_read_b64_tr_b16 a[122:123], v17 offset:512
    ds_read_b64_tr_b16 a[124:125], v17 offset:8192
    ds_read_b64_tr_b16 a[126:127], v17 offset:8704
    s_waitcnt vmcnt(28) lgkmcnt(0)
    s_barrier
    s_add_u32 m0, s39, 131072
    s_mov_b32 s31, 3670016
    buffer_load_dwordx4 v8, s[8:11], s31 offen lds
    s_add_u32 m0, s39, 135168
    s_mov_b32 s31, 3801088
    buffer_load_dwordx4 v8, s[8:11], s31 offen lds
    s_add_u32 m0, s39, 139264
    s_mov_b32 s31, 3932160
    buffer_load_dwordx4 v8, s[8:11], s31 offen lds
    s_add_u32 m0, s39, 143360
    s_mov_b32 s31, 4063232
    buffer_load_dwordx4 v8, s[8:11], s31 offen lds
    v_add_u32 v16, 131072, v12
    v_add_u32 v17, 131072, v13
    ds_read_b64_tr_b16 a[128:129], v16 offset:0
    ds_read_b64_tr_b16 a[130:131], v16 offset:512
    ds_read_b64_tr_b16 a[132:133], v16 offset:8192
    ds_read_b64_tr_b16 a[134:135], v16 offset:8704
    ds_read_b64_tr_b16 a[136:137], v17 offset:0
    ds_read_b64_tr_b16 a[138:139], v17 offset:512
    ds_read_b64_tr_b16 a[140:141], v17 offset:8192
    ds_read_b64_tr_b16 a[142:143], v17 offset:8704
    s_waitcnt vmcnt(28) lgkmcnt(0)
    s_barrier
    s_add_u32 m0, s39, 147456
    s_mov_b32 s31, 4194304
    buffer_load_dwordx4 v8, s[8:11], s31 offen lds
    s_add_u32 m0, s39, 151552
    s_mov_b32 s31, 4325376
    buffer_load_dwordx4 v8, s[8:11], s31 offen lds
    s_add_u32 m0, s39, 155648
    s_mov_b32 s31, 4456448
    buffer_load_dwordx4 v8, s[8:11], s31 offen lds
    s_add_u32 m0, s39, 159744
    s_mov_b32 s31, 4587520
    buffer_load_dwordx4 v8, s[8:11], s31 offen lds
    v_add_u32 v16, 0, v12
    v_add_u32 v17, 0, v13
    ds_read_b64_tr_b16 a[144:145], v16 offset:0
    ds_read_b64_tr_b16 a[146:147], v16 offset:512
    ds_read_b64_tr_b16 a[148:149], v16 offset:8192
    ds_read_b64_tr_b16 a[150:151], v16 offset:8704
    ds_read_b64_tr_b16 a[152:153], v17 offset:0
    ds_read_b64_tr_b16 a[154:155], v17 offset:512
    ds_read_b64_tr_b16 a[156:157], v17 offset:8192
    ds_read_b64_tr_b16 a[158:159], v17 offset:8704
    s_waitcnt vmcnt(28) lgkmcnt(0)
    s_barrier
    s_mov_b32 s8, s52
    s_mov_b32 s9, s53
    s_add_u32 m0, s39, 16384
    s_mov_b32 s31, 0
    buffer_load_dwordx4 v8, s[8:11], s31 offen lds
    s_add_u32 m0, s39, 20480
    s_mov_b32 s31, 131072
    buffer_load_dwordx4 v8, s[8:11], s31 offen lds
    s_add_u32 m0, s39, 24576
    s_mov_b32 s31, 262144
    buffer_load_dwordx4 v8, s[8:11], s31 offen lds
    s_add_u32 m0, s39, 28672
    s_mov_b32 s31, 393216
    buffer_load_dwordx4 v8, s[8:11], s31 offen lds
    v_add_u32 v16, 16384, v12
    v_add_u32 v17, 16384, v13
    ds_read_b64_tr_b16 a[160:161], v16 offset:0
    ds_read_b64_tr_b16 a[162:163], v16 offset:512
    ds_read_b64_tr_b16 a[164:165], v16 offset:8192
    ds_read_b64_tr_b16 a[166:167], v16 offset:8704
    ds_read_b64_tr_b16 a[168:169], v17 offset:0
    ds_read_b64_tr_b16 a[170:171], v17 offset:512
    ds_read_b64_tr_b16 a[172:173], v17 offset:8192
    ds_read_b64_tr_b16 a[174:175], v17 offset:8704
    s_waitcnt vmcnt(28) lgkmcnt(0)
    s_barrier
    s_add_u32 m0, s39, 32768
    s_mov_b32 s31, 524288
    buffer_load_dwordx4 v8, s[8:11], s31 offen lds
    s_add_u32 m0, s39, 36864
    s_mov_b32 s31, 655360
    buffer_load_dwordx4 v8, s[8:11], s31 offen lds
    s_add_u32 m0, s39, 40960
    s_mov_b32 s31, 786432
    buffer_load_dwordx4 v8, s[8:11], s31 offen lds
    s_add_u32 m0, s39, 45056
    s_mov_b32 s31, 917504
    buffer_load_dwordx4 v8, s[8:11], s31 offen lds
    v_add_u32 v16, 32768, v12
    v_add_u32 v17, 32768, v13
    ds_read_b64_tr_b16 a[176:177], v16 offset:0
    ds_read_b64_tr_b16 a[178:179], v16 offset:512
    ds_read_b64_tr_b16 a[180:181], v16 offset:8192
    ds_read_b64_tr_b16 a[182:183], v16 offset:8704
    ds_read_b64_tr_b16 a[184:185], v17 offset:0
    ds_read_b64_tr_b16 a[186:187], v17 offset:512
    ds_read_b64_tr_b16 a[188:189], v17 offset:8192
    ds_read_b64_tr_b16 a[190:191], v17 offset:8704
    s_waitcnt vmcnt(28) lgkmcnt(0)
    s_barrier
    s_add_u32 m0, s39, 49152
    s_mov_b32 s31, 1048576
    buffer_load_dwordx4 v8, s[8:11], s31 offen lds
    s_add_u32 m0, s39, 53248
    s_mov_b32 s31, 1179648
    buffer_load_dwordx4 v8, s[8:11], s31 offen lds
    s_add_u32 m0, s39, 57344
    s_mov_b32 s31, 1310720
    buffer_load_dwordx4 v8, s[8:11], s31 offen lds
    s_add_u32 m0, s39, 61440
    s_mov_b32 s31, 1441792
    buffer_load_dwordx4 v8, s[8:11], s31 offen lds
    v_add_u32 v16, 49152, v12
    v_add_u32 v17, 49152, v13
    ds_read_b64_tr_b16 a[192:193], v16 offset:0
    ds_read_b64_tr_b16 a[194:195], v16 offset:512
    ds_read_b64_tr_b16 a[196:197], v16 offset:8192
    ds_read_b64_tr_b16 a[198:199], v16 offset:8704
    ds_read_b64_tr_b16 a[200:201], v17 offset:0
    ds_read_b64_tr_b16 a[202:203], v17 offset:512
    ds_read_b64_tr_b16 a[204:205], v17 offset:8192
    ds_read_b64_tr_b16 a[206:207], v17 offset:8704
    s_waitcnt vmcnt(28) lgkmcnt(0)
    s_barrier
    s_add_u32 m0, s39, 65536
    s_mov_b32 s31, 1572864
    buffer_load_dwordx4 v8, s[8:11], s31 offen lds
    s_add_u32 m0, s39, 69632
    s_mov_b32 s31, 1703936
    buffer_load_dwordx4 v8, s[8:11], s31 offen lds
    s_add_u32 m0, s39, 73728
    s_mov_b32 s31, 1835008
    buffer_load_dwordx4 v8, s[8:11], s31 offen lds
    s_add_u32 m0, s39, 77824
    s_mov_b32 s31, 1966080
    buffer_load_dwordx4 v8, s[8:11], s31 offen lds
    v_add_u32 v16, 65536, v12
    v_add_u32 v17, 65536, v13
    ds_read_b64_tr_b16 a[208:209], v16 offset:0
    ds_read_b64_tr_b16 a[210:211], v16 offset:512
    ds_read_b64_tr_b16 a[212:213], v16 offset:8192
    ds_read_b64_tr_b16 a[214:215], v16 offset:8704
    ds_read_b64_tr_b16 a[216:217], v17 offset:0
    ds_read_b64_tr_b16 a[218:219], v17 offset:512
    ds_read_b64_tr_b16 a[220:221], v17 offset:8192
    ds_read_b64_tr_b16 a[222:223], v17 offset:8704
    s_waitcnt vmcnt(28) lgkmcnt(0)
    s_barrier
    s_add_u32 m0, s39, 81920
    s_mov_b32 s31, 2097152
    buffer_load_dwordx4 v8, s[8:11], s31 offen lds
    s_add_u32 m0, s39, 86016
    s_mov_b32 s31, 2228224
    buffer_load_dwordx4 v8, s[8:11], s31 offen lds
    s_add_u32 m0, s39, 90112
    s_mov_b32 s31, 2359296
    buffer_load_dwordx4 v8, s[8:11], s31 offen lds
    s_add_u32 m0, s39, 94208
    s_mov_b32 s31, 2490368
    buffer_load_dwordx4 v8, s[8:11], s31 offen lds
    v_add_u32 v16, 81920, v12
    v_add_u32 v17, 81920, v13
    ds_read_b64_tr_b16 a[224:225], v16 offset:0
    ds_read_b64_tr_b16 a[226:227], v16 offset:512
    ds_read_b64_tr_b16 a[228:229], v16 offset:8192
    ds_read_b64_tr_b16 a[230:231], v16 offset:8704
    ds_read_b64_tr_b16 a[232:233], v17 offset:0
    ds_read_b64_tr_b16 a[234:235], v17 offset:512
    ds_read_b64_tr_b16 a[236:237], v17 offset:8192
    ds_read_b64_tr_b16 a[238:239], v17 offset:8704
    s_waitcnt vmcnt(28) lgkmcnt(0)
    s_barrier
    s_add_u32 m0, s39, 98304
    s_mov_b32 s31, 2621440
    buffer_load_dwordx4 v8, s[8:11], s31 offen lds
    s_add_u32 m0, s39, 102400
    s_mov_b32 s31, 2752512
    buffer_load_dwordx4 v8, s[8:11], s31 offen lds
    s_add_u32 m0, s39, 106496
    s_mov_b32 s31, 2883584
    buffer_load_dwordx4 v8, s[8:11], s31 offen lds
    s_add_u32 m0, s39, 110592
    s_mov_b32 s31, 3014656
    buffer_load_dwordx4 v8, s[8:11], s31 offen lds
    v_add_u32 v16, 98304, v12
    v_add_u32 v17, 98304, v13
    ds_read_b64_tr_b16 a[240:241], v16 offset:0
    ds_read_b64_tr_b16 a[242:243], v16 offset:512
    ds_read_b64_tr_b16 a[244:245], v16 offset:8192
    ds_read_b64_tr_b16 a[246:247], v16 offset:8704
    ds_read_b64_tr_b16 a[248:249], v17 offset:0
    ds_read_b64_tr_b16 a[250:251], v17 offset:512
    ds_read_b64_tr_b16 a[252:253], v17 offset:8192
    ds_read_b64_tr_b16 a[254:255], v17 offset:8704
    s_waitcnt vmcnt(28) lgkmcnt(0)
    s_barrier
    s_add_u32 m0, s39, 114688
    s_mov_b32 s31, 3145728
    buffer_load_dwordx4 v8, s[8:11], s31 offen lds
    s_add_u32 m0, s39, 118784
    s_mov_b32 s31, 3276800
    buffer_load_dwordx4 v8, s[8:11], s31 offen lds
    s_add_u32 m0, s39, 122880
    s_mov_b32 s31, 3407872
    buffer_load_dwordx4 v8, s[8:11], s31 offen lds
    s_add_u32 m0, s39, 126976
    s_mov_b32 s31, 3538944
    buffer_load_dwordx4 v8, s[8:11], s31 offen lds
    v_add_u32 v16, 114688, v12
    v_add_u32 v17, 114688, v13
    ds_read_b64_tr_b16 v[80:81], v16 offset:0
    ds_read_b64_tr_b16 v[82:83], v16 offset:512
    ds_read_b64_tr_b16 v[84:85], v16 offset:8192
    ds_read_b64_tr_b16 v[86:87], v16 offset:8704
    ds_read_b64_tr_b16 v[88:89], v17 offset:0
    ds_read_b64_tr_b16 v[90:91], v17 offset:512
    ds_read_b64_tr_b16 v[92:93], v17 offset:8192
    ds_read_b64_tr_b16 v[94:95], v17 offset:8704
    s_waitcnt vmcnt(28) lgkmcnt(0)
    s_barrier
    s_add_u32 m0, s39, 131072
    s_mov_b32 s31, 3670016
    buffer_load_dwordx4 v8, s[8:11], s31 offen lds
    s_add_u32 m0, s39, 135168
    s_mov_b32 s31, 3801088
    buffer_load_dwordx4 v8, s[8:11], s31 offen lds
    s_add_u32 m0, s39, 139264
    s_mov_b32 s31, 3932160
    buffer_load_dwordx4 v8, s[8:11], s31 offen lds
    s_add_u32 m0, s39, 143360
    s_mov_b32 s31, 4063232
    buffer_load_dwordx4 v8, s[8:11], s31 offen lds
    v_add_u32 v16, 131072, v12
    v_add_u32 v17, 131072, v13
    ds_read_b64_tr_b16 v[96:97], v16 offset:0
    ds_read_b64_tr_b16 v[98:99], v16 offset:512
    ds_read_b64_tr_b16 v[100:101], v16 offset:8192
    ds_read_b64_tr_b16 v[102:103], v16 offset:8704
    ds_read_b64_tr_b16 v[104:105], v17 offset:0
    ds_read_b64_tr_b16 v[106:107], v17 offset:512
    ds_read_b64_tr_b16 v[108:109], v17 offset:8192
    ds_read_b64_tr_b16 v[110:111], v17 offset:8704
    s_waitcnt vmcnt(28) lgkmcnt(0)
    s_barrier
    s_add_u32 m0, s39, 147456
    s_mov_b32 s31, 4194304
    buffer_load_dwordx4 v8, s[8:11], s31 offen lds
    s_add_u32 m0, s39, 151552
    s_mov_b32 s31, 4325376
    buffer_load_dwordx4 v8, s[8:11], s31 offen lds
    s_add_u32 m0, s39, 155648
    s_mov_b32 s31, 4456448
    buffer_load_dwordx4 v8, s[8:11], s31 offen lds
    s_add_u32 m0, s39, 159744
    s_mov_b32 s31, 4587520
    buffer_load_dwordx4 v8, s[8:11], s31 offen lds
    v_add_u32 v16, 0, v12
    v_add_u32 v17, 0, v13
    ds_read_b64_tr_b16 v[112:113], v16 offset:0
    ds_read_b64_tr_b16 v[114:115], v16 offset:512
    ds_read_b64_tr_b16 v[116:117], v16 offset:8192
    ds_read_b64_tr_b16 v[118:119], v16 offset:8704
    ds_read_b64_tr_b16 v[120:121], v17 offset:0
    ds_read_b64_tr_b16 v[122:123], v17 offset:512
    ds_read_b64_tr_b16 v[124:125], v17 offset:8192
    ds_read_b64_tr_b16 v[126:127], v17 offset:8704
    s_waitcnt vmcnt(28) lgkmcnt(0)
    s_barrier
    s_mov_b32 s8, s54
    s_mov_b32 s9, s55
    s_add_u32 m0, s40, 16384
    s_mov_b32 s31, 0
    buffer_load_dwordx4 v9, s[8:11], s31 offen lds
    s_add_u32 m0, s40, 17408
    s_mov_b32 s31, 4608
    buffer_load_dwordx4 v9, s[8:11], s31 offen lds
    s_add_u32 m0, s40, 18432
    s_mov_b32 s31, 9216
    buffer_load_dwordx4 v9, s[8:11], s31 offen lds
    s_add_u32 m0, s40, 19456
    s_mov_b32 s31, 13824
    buffer_load_dwordx4 v9, s[8:11], s31 offen lds
    v_add_u32 v16, 16384, v12
    v_add_u32 v17, 16384, v13
    ds_read_b64_tr_b16 v[128:129], v16 offset:0
    ds_read_b64_tr_b16 v[130:131], v16 offset:512
    ds_read_b64_tr_b16 v[132:133], v16 offset:8192
    ds_read_b64_tr_b16 v[134:135], v16 offset:8704
    ds_read_b64_tr_b16 v[136:137], v17 offset:0
    ds_read_b64_tr_b16 v[138:139], v17 offset:512
    ds_read_b64_tr_b16 v[140:141], v17 offset:8192
    ds_read_b64_tr_b16 v[142:143], v17 offset:8704
    s_waitcnt vmcnt(28) lgkmcnt(0)
    s_barrier
    s_add_u32 m0, s40, 32768
    s_mov_b32 s31, 73728
    buffer_load_dwordx4 v9, s[8:11], s31 offen lds
    s_add_u32 m0, s40, 33792
    s_mov_b32 s31, 78336
    buffer_load_dwordx4 v9, s[8:11], s31 offen lds
    s_add_u32 m0, s40, 34816
    s_mov_b32 s31, 82944
    buffer_load_dwordx4 v9, s[8:11], s31 offen lds
    s_add_u32 m0, s40, 35840
    s_mov_b32 s31, 87552
    buffer_load_dwordx4 v9, s[8:11], s31 offen lds
    v_add_u32 v16, 32768, v12
    v_add_u32 v17, 32768, v13
    ds_read_b64_tr_b16 v[144:145], v16 offset:0
    ds_read_b64_tr_b16 v[146:147], v16 offset:512
    ds_read_b64_tr_b16 v[148:149], v16 offset:8192
    ds_read_b64_tr_b16 v[150:151], v16 offset:8704
    ds_read_b64_tr_b16 v[152:153], v17 offset:0
    ds_read_b64_tr_b16 v[154:155], v17 offset:512
    ds_read_b64_tr_b16 v[156:157], v17 offset:8192
    ds_read_b64_tr_b16 v[158:159], v17 offset:8704
    s_waitcnt vmcnt(28) lgkmcnt(0)
    s_barrier
    s_add_u32 m0, s40, 49152
    s_mov_b32 s31, 256
    buffer_load_dwordx4 v9, s[8:11], s31 offen lds
    s_add_u32 m0, s40, 50176
    s_mov_b32 s31, 4864
    buffer_load_dwordx4 v9, s[8:11], s31 offen lds
    s_add_u32 m0, s40, 51200
    s_mov_b32 s31, 9472
    buffer_load_dwordx4 v9, s[8:11], s31 offen lds
    s_add_u32 m0, s40, 52224
    s_mov_b32 s31, 14080
    buffer_load_dwordx4 v9, s[8:11], s31 offen lds
    v_add_u32 v16, 49152, v12
    v_add_u32 v17, 49152, v13
    ds_read_b64_tr_b16 v[160:161], v16 offset:0
    ds_read_b64_tr_b16 v[162:163], v16 offset:512
    ds_read_b64_tr_b16 v[164:165], v16 offset:8192
    ds_read_b64_tr_b16 v[166:167], v16 offset:8704
    ds_read_b64_tr_b16 v[168:169], v17 offset:0
    ds_read_b64_tr_b16 v[170:171], v17 offset:512
    ds_read_b64_tr_b16 v[172:173], v17 offset:8192
    ds_read_b64_tr_b16 v[174:175], v17 offset:8704
    s_waitcnt vmcnt(28) lgkmcnt(0)
    s_barrier
    s_add_u32 m0, s40, 65536
    s_mov_b32 s31, 73984
    buffer_load_dwordx4 v9, s[8:11], s31 offen lds
    s_add_u32 m0, s40, 66560
    s_mov_b32 s31, 78592
    buffer_load_dwordx4 v9, s[8:11], s31 offen lds
    s_add_u32 m0, s40, 67584
    s_mov_b32 s31, 83200
    buffer_load_dwordx4 v9, s[8:11], s31 offen lds
    s_add_u32 m0, s40, 68608
    s_mov_b32 s31, 87808
    buffer_load_dwordx4 v9, s[8:11], s31 offen lds
    v_add_u32 v16, 65536, v12
    v_add_u32 v17, 65536, v13
    ds_read_b64_tr_b16 v[176:177], v16 offset:0
    ds_read_b64_tr_b16 v[178:179], v16 offset:512
    ds_read_b64_tr_b16 v[180:181], v16 offset:8192
    ds_read_b64_tr_b16 v[182:183], v16 offset:8704
    ds_read_b64_tr_b16 v[184:185], v17 offset:0
    ds_read_b64_tr_b16 v[186:187], v17 offset:512
    ds_read_b64_tr_b16 v[188:189], v17 offset:8192
    ds_read_b64_tr_b16 v[190:191], v17 offset:8704
    s_waitcnt vmcnt(28) lgkmcnt(0)
    s_barrier
    s_add_u32 m0, s40, 81920
    s_mov_b32 s31, 512
    buffer_load_dwordx4 v9, s[8:11], s31 offen lds
    s_add_u32 m0, s40, 82944
    s_mov_b32 s31, 5120
    buffer_load_dwordx4 v9, s[8:11], s31 offen lds
    s_add_u32 m0, s40, 83968
    s_mov_b32 s31, 9728
    buffer_load_dwordx4 v9, s[8:11], s31 offen lds
    s_add_u32 m0, s40, 84992
    s_mov_b32 s31, 14336
    buffer_load_dwordx4 v9, s[8:11], s31 offen lds
    v_add_u32 v16, 81920, v12
    v_add_u32 v17, 81920, v13
    ds_read_b64_tr_b16 v[192:193], v16 offset:0
    ds_read_b64_tr_b16 v[194:195], v16 offset:512
    ds_read_b64_tr_b16 v[196:197], v16 offset:8192
    ds_read_b64_tr_b16 v[198:199], v16 offset:8704
    ds_read_b64_tr_b16 v[200:201], v17 offset:0
    ds_read_b64_tr_b16 v[202:203], v17 offset:512
    ds_read_b64_tr_b16 v[204:205], v17 offset:8192
    ds_read_b64_tr_b16 v[206:207], v17 offset:8704
    s_waitcnt vmcnt(28) lgkmcnt(0)
    s_barrier
    s_add_u32 m0, s40, 98304
    s_mov_b32 s31, 74240
    buffer_load_dwordx4 v9, s[8:11], s31 offen lds
    s_add_u32 m0, s40, 99328
    s_mov_b32 s31, 78848
    buffer_load_dwordx4 v9, s[8:11], s31 offen lds
    s_add_u32 m0, s40, 100352
    s_mov_b32 s31, 83456
    buffer_load_dwordx4 v9, s[8:11], s31 offen lds
    s_add_u32 m0, s40, 101376
    s_mov_b32 s31, 88064
    buffer_load_dwordx4 v9, s[8:11], s31 offen lds
    v_add_u32 v16, 98304, v12
    v_add_u32 v17, 98304, v13
    ds_read_b64_tr_b16 v[208:209], v16 offset:0
    ds_read_b64_tr_b16 v[210:211], v16 offset:512
    ds_read_b64_tr_b16 v[212:213], v16 offset:8192
    ds_read_b64_tr_b16 v[214:215], v16 offset:8704
    ds_read_b64_tr_b16 v[216:217], v17 offset:0
    ds_read_b64_tr_b16 v[218:219], v17 offset:512
    ds_read_b64_tr_b16 v[220:221], v17 offset:8192
    ds_read_b64_tr_b16 v[222:223], v17 offset:8704
    s_waitcnt vmcnt(28) lgkmcnt(0)
    s_barrier
    s_add_u32 m0, s40, 114688
    s_mov_b32 s31, 768
    buffer_load_dwordx4 v9, s[8:11], s31 offen lds
    s_add_u32 m0, s40, 115712
    s_mov_b32 s31, 5376
    buffer_load_dwordx4 v9, s[8:11], s31 offen lds
    s_add_u32 m0, s40, 116736
    s_mov_b32 s31, 9984
    buffer_load_dwordx4 v9, s[8:11], s31 offen lds
    s_add_u32 m0, s40, 117760
    s_mov_b32 s31, 14592
    buffer_load_dwordx4 v9, s[8:11], s31 offen lds
    v_add_u32 v16, 114688, v12
    v_add_u32 v17, 114688, v13
    ds_read_b64_tr_b16 v[224:225], v16 offset:0
    ds_read_b64_tr_b16 v[226:227], v16 offset:512
    ds_read_b64_tr_b16 v[228:229], v16 offset:8192
    ds_read_b64_tr_b16 v[230:231], v16 offset:8704
    ds_read_b64_tr_b16 v[232:233], v17 offset:0
    ds_read_b64_tr_b16 v[234:235], v17 offset:512
    ds_read_b64_tr_b16 v[236:237], v17 offset:8192
    ds_read_b64_tr_b16 v[238:239], v17 offset:8704
    s_waitcnt vmcnt(28) lgkmcnt(0)
    s_barrier
    s_add_u32 m0, s40, 131072
    s_mov_b32 s31, 74496
    buffer_load_dwordx4 v9, s[8:11], s31 offen lds
    s_add_u32 m0, s40, 132096
    s_mov_b32 s31, 79104
    buffer_load_dwordx4 v9, s[8:11], s31 offen lds
    s_add_u32 m0, s40, 133120
    s_mov_b32 s31, 83712
    buffer_load_dwordx4 v9, s[8:11], s31 offen lds
    s_add_u32 m0, s40, 134144
    s_mov_b32 s31, 88320
    buffer_load_dwordx4 v9, s[8:11], s31 offen lds
    v_add_u32 v16, 131072, v12
    v_add_u32 v17, 131072, v13
    ds_read_b64_tr_b16 v[240:241], v16 offset:0
    ds_read_b64_tr_b16 v[242:243], v16 offset:512
    ds_read_b64_tr_b16 v[244:245], v16 offset:8192
    ds_read_b64_tr_b16 v[246:247], v16 offset:8704
    ds_read_b64_tr_b16 v[248:249], v17 offset:0
    ds_read_b64_tr_b16 v[250:251], v17 offset:512
    ds_read_b64_tr_b16 v[252:253], v17 offset:8192
    ds_read_b64_tr_b16 v[254:255], v17 offset:8704
    s_waitcnt vmcnt(28) lgkmcnt(0)
    s_barrier
    s_add_u32 m0, s40, 147456
    s_mov_b32 s31, 0
    buffer_load_dwordx4 v60, s[8:11], s31 offen lds
    s_add_u32 m0, s40, 148480
    s_mov_b32 s31, 9216
    buffer_load_dwordx4 v60, s[8:11], s31 offen lds
    s_add_u32 m0, s40, 149504
    s_mov_b32 s31, 18432
    buffer_load_dwordx4 v61, s[8:11], s31 offen lds
    s_add_u32 m0, s40, 150528
    s_mov_b32 s31, 27648
    buffer_load_dwordx4 v61, s[8:11], s31 offen lds
    v_add_u32 v16, 0, v14
    ds_read_b64_tr_b16 v[36:37], v16 offset:0
    ds_read_b64_tr_b16 v[38:39], v16 offset:512
    ds_read_b64_tr_b16 v[40:41], v16 offset:2048
    ds_read_b64_tr_b16 v[42:43], v16 offset:2560
    ds_read_b64_tr_b16 v[44:45], v16 offset:8192
    ds_read_b64_tr_b16 v[46:47], v16 offset:8704
    ds_read_b64_tr_b16 v[48:49], v16 offset:10240
    ds_read_b64_tr_b16 v[50:51], v16 offset:10752
    s_waitcnt vmcnt(28) lgkmcnt(0)
    s_barrier
    v_add_u32 v18, 0, v15
    ds_write_b128 v18, v[36:39] offset:0
    ds_write_b128 v18, v[40:43] offset:1024
    ds_write_b128 v18, v[44:47] offset:8192
    ds_write_b128 v18, v[48:51] offset:9216
    v_add_u32 v16, 16384, v14
    ds_read_b64_tr_b16 v[20:21], v16 offset:0
    ds_read_b64_tr_b16 v[22:23], v16 offset:512
    ds_read_b64_tr_b16 v[24:25], v16 offset:2048
    ds_read_b64_tr_b16 v[26:27], v16 offset:2560
    ds_read_b64_tr_b16 v[28:29], v16 offset:8192
    ds_read_b64_tr_b16 v[30:31], v16 offset:8704
    ds_read_b64_tr_b16 v[32:33], v16 offset:10240
    ds_read_b64_tr_b16 v[34:35], v16 offset:10752
    s_waitcnt vmcnt(24) lgkmcnt(0)
    s_barrier
    v_add_u32 v18, 16384, v15
    ds_write_b128 v18, v[20:23] offset:0
    ds_write_b128 v18, v[24:27] offset:1024
    ds_write_b128 v18, v[28:31] offset:8192
    ds_write_b128 v18, v[32:35] offset:9216
    v_add_u32 v16, 32768, v14
    ds_read_b64_tr_b16 v[36:37], v16 offset:0
    ds_read_b64_tr_b16 v[38:39], v16 offset:512
    ds_read_b64_tr_b16 v[40:41], v16 offset:2048
    ds_read_b64_tr_b16 v[42:43], v16 offset:2560
    ds_read_b64_tr_b16 v[44:45], v16 offset:8192
    ds_read_b64_tr_b16 v[46:47], v16 offset:8704
    ds_read_b64_tr_b16 v[48:49], v16 offset:10240
    ds_read_b64_tr_b16 v[50:51], v16 offset:10752
    s_waitcnt vmcnt(20) lgkmcnt(0)
    s_barrier
    v_add_u32 v18, 32768, v15
    ds_write_b128 v18, v[36:39] offset:0
    ds_write_b128 v18, v[40:43] offset:1024
    ds_write_b128 v18, v[44:47] offset:8192
    ds_write_b128 v18, v[48:51] offset:9216
    v_add_u32 v16, 49152, v14
    ds_read_b64_tr_b16 v[20:21], v16 offset:0
    ds_read_b64_tr_b16 v[22:23], v16 offset:512
    ds_read_b64_tr_b16 v[24:25], v16 offset:2048
    ds_read_b64_tr_b16 v[26:27], v16 offset:2560
    ds_read_b64_tr_b16 v[28:29], v16 offset:8192
    ds_read_b64_tr_b16 v[30:31], v16 offset:8704
    ds_read_b64_tr_b16 v[32:33], v16 offset:10240
    ds_read_b64_tr_b16 v[34:35], v16 offset:10752
    s_waitcnt vmcnt(16) lgkmcnt(0)
    s_barrier
    v_add_u32 v18, 49152, v15
    ds_write_b128 v18, v[20:23] offset:0
    ds_write_b128 v18, v[24:27] offset:1024
    ds_write_b128 v18, v[28:31] offset:8192
    ds_write_b128 v18, v[32:35] offset:9216
    v_add_u32 v16, 65536, v14
    ds_read_b64_tr_b16 v[36:37], v16 offset:0
    ds_read_b64_tr_b16 v[38:39], v16 offset:512
    ds_read_b64_tr_b16 v[40:41], v16 offset:2048
    ds_read_b64_tr_b16 v[42:43], v16 offset:2560
    ds_read_b64_tr_b16 v[44:45], v16 offset:8192
    ds_read_b64_tr_b16 v[46:47], v16 offset:8704
    ds_read_b64_tr_b16 v[48:49], v16 offset:10240
    ds_read_b64_tr_b16 v[50:51], v16 offset:10752
    s_waitcnt vmcnt(12) lgkmcnt(0)
    s_barrier
    v_add_u32 v18, 65536, v15
    ds_write_b128 v18, v[36:39] offset:0
    ds_write_b128 v18, v[40:43] offset:1024
    ds_write_b128 v18, v[44:47] offset:8192
    ds_write_b128 v18, v[48:51] offset:9216
    v_add_u32 v16, 81920, v14
    ds_read_b64_tr_b16 v[20:21], v16 offset:0
    ds_read_b64_tr_b16 v[22:23], v16 offset:512
    ds_read_b64_tr_b16 v[24:25], v16 offset:2048
    ds_read_b64_tr_b16 v[26:27], v16 offset:2560
    ds_read_b64_tr_b16 v[28:29], v16 offset:8192
    ds_read_b64_tr_b16 v[30:31], v16 offset:8704
    ds_read_b64_tr_b16 v[32:33], v16 offset:10240
    ds_read_b64_tr_b16 v[34:35], v16 offset:10752
    s_waitcnt vmcnt(8) lgkmcnt(0)
    s_barrier
    v_add_u32 v18, 81920, v15
    ds_write_b128 v18, v[20:23] offset:0
    ds_write_b128 v18, v[24:27] offset:1024
    ds_write_b128 v18, v[28:31] offset:8192
    ds_write_b128 v18, v[32:35] offset:9216
    v_add_u32 v16, 98304, v14
    ds_read_b64_tr_b16 v[36:37], v16 offset:0
    ds_read_b64_tr_b16 v[38:39], v16 offset:512
    ds_read_b64_tr_b16 v[40:41], v16 offset:2048
    ds_read_b64_tr_b16 v[42:43], v16 offset:2560
    ds_read_b64_tr_b16 v[44:45], v16 offset:8192
    ds_read_b64_tr_b16 v[46:47], v16 offset:8704
    ds_read_b64_tr_b16 v[48:49], v16 offset:10240
    ds_read_b64_tr_b16 v[50:51], v16 offset:10752
    s_waitcnt vmcnt(4) lgkmcnt(0)
    s_barrier
    v_add_u32 v18, 98304, v15
    ds_write_b128 v18, v[36:39] offset:0
    ds_write_b128 v18, v[40:43] offset:1024
    ds_write_b128 v18, v[44:47] offset:8192
    ds_write_b128 v18, v[48:51] offset:9216
    v_add_u32 v16, 114688, v14
    ds_read_b64_tr_b16 v[20:21], v16 offset:0
    ds_read_b64_tr_b16 v[22:23], v16 offset:512
    ds_read_b64_tr_b16 v[24:25], v16 offset:2048
    ds_read_b64_tr_b16 v[26:27], v16 offset:2560
    ds_read_b64_tr_b16 v[28:29], v16 offset:8192
    ds_read_b64_tr_b16 v[30:31], v16 offset:8704
    ds_read_b64_tr_b16 v[32:33], v16 offset:10240
    ds_read_b64_tr_b16 v[34:35], v16 offset:10752
    s_waitcnt vmcnt(0) lgkmcnt(0)
    s_barrier
    v_add_u32 v18, 114688, v15
    ds_write_b128 v18, v[20:23] offset:0
    ds_write_b128 v18, v[24:27] offset:1024
    ds_write_b128 v18, v[28:31] offset:8192
    ds_write_b128 v18, v[32:35] offset:9216
    ds_read_b64_tr_b16 v[36:37], v62 offset:0
    ds_read_b64_tr_b16 v[38:39], v62 offset:256
    ds_read_b64_tr_b16 v[40:41], v62 offset:1024
    ds_read_b64_tr_b16 v[42:43], v62 offset:1280
    ds_read_b64_tr_b16 v[44:45], v63 offset:0
    ds_read_b64_tr_b16 v[46:47], v63 offset:256
    ds_read_b64_tr_b16 v[48:49], v63 offset:1024
    ds_read_b64_tr_b16 v[50:51], v63 offset:1280
    s_waitcnt lgkmcnt(0)
    s_barrier
    ds_write_b128 v64, v[36:39] offset:0
    ds_write_b128 v64, v[40:43] offset:1024
    ds_write_b128 v64, v[44:47] offset:2048
    ds_write_b128 v64, v[48:51] offset:3072
    s_mov_b32 s60, s56
    s_mov_b32 s61, s57
    s_mov_b32 s62, 9216
    s_mov_b32 s63, 0x20000
    v_and_b32 v5, 1, v2
    v_lshlrev_b32 v5, 3, v5
    v_lshrrev_b32 v6, 1, v2
    v_lshl_add_u32 v7, v6, 2, v5
    v_and_b32 v5, 7, v0
    v_mul_u32_u24 v6, 1152, v5
    v_add_u32 v6, v6, v7
    v_lshl_add_u32 v66, v5, 4, v7
    s_lshl_b32 s31, s28, 4
    buffer_load_dword v65, v6, s[60:63], s31 offen
    v_mov_b32 v67, 0
    buffer_load_dword v68, v67, s[12:15], 0 offen offset:128 sc1
    s_cmp_lg_u32 s66, 0
    s_cselect_b32 s18, 0, 1
    s_cselect_b32 s67, 1, 63
    s_cselect_b32 s46, 0x800000, 0x800000
    s_cselect_b32 s31, 0, 524288
    s_add_u32 s46, s46, s31
    s_cmp_lg_u32 s66, 0
    s_cselect_b32 s90, 1, 1
    s_cselect_b32 s31, 16384, 0
    s_sub_u32 s20, 0x100000, s31
    s_lshl_b32 s31, s16, 13
    s_mul_i32 s38, s18, 262144
    s_add_u32 s31, s31, s38
    s_add_u32 s24, s31, 0x2000000
    s_add_u32 s21, s31, 0x1040000
    s_add_u32 s22, s31, 0x1000000
    s_add_u32 s23, s22, 4096
    s_lshl_b32 s31, s16, 12
    s_add_u32 s25, s31, 0x4000000
    s_add_u32 s26, s31, 0x4800000
    s_lshl_b32 s30, s28, 7
    s_mul_i32 s101, s16, 288
    s_mul_i32 s41, s18, 9216
    s_add_u32 s41, s41, 0x110000
    s_lshl_b32 s42, s16, 7
    s_add_u32 s42, s42, 0x208000
    s_lshl_b32 s43, s16, 9
    s_add_u32 s43, s43, 0x200000
    s_mov_b32 s45, 0
    v_add_u32 v78, 65536, v73
    v_add_u32 v79, 131072, v73
    s_waitcnt lgkmcnt(0)
    s_barrier
    s_cmp_eq_u32 s17, 1
    s_cbranch_scc1 REC_W1
    s_cmp_eq_u32 s17, 2
    s_cbranch_scc1 REC_W2
    s_cmp_eq_u32 s17, 3
    s_cbranch_scc1 REC_W3
REC_W0:
    ds_read_b128 v[0:3], v73 offset:49152
    ds_read_b128 v[4:7], v73 offset:50176
    ds_read_b128 v[8:11], v73 offset:57344
    ds_read_b128 v[12:15], v73 offset:58368
    ds_read_b128 v[16:19], v78 offset:32768
    ds_read_b128 v[20:23], v78 offset:33792
    ds_read_b128 v[24:27], v78 offset:40960
    ds_read_b128 v[28:31], v78 offset:41984
    s_waitcnt lgkmcnt(0)
    ds_write_b128 v73, a[80:83] offset:49152
    ds_write_b128 v73, a[84:87] offset:50176
    ds_write_b128 v73, a[0:3] offset:57344
    ds_write_b128 v73, a[4:7] offset:58368
    ds_write_b128 v78, a[64:67] offset:32768
    ds_write_b128 v78, a[68:71] offset:33792
    ds_write_b128 v78, a[160:163] offset:40960
    ds_write_b128 v78, a[164:167] offset:41984
    s_waitcnt lgkmcnt(0)
    v_accvgpr_write_b32 a80, v0
    v_accvgpr_write_b32 a81, v1
    v_accvgpr_write_b32 a82, v2
    v_accvgpr_write_b32 a83, v3
    v_accvgpr_write_b32 a84, v4
    v_accvgpr_write_b32 a85, v5
    v_accvgpr_write_b32 a86, v6
    v_accvgpr_write_b32 a87, v7
    v_accvgpr_write_b32 a0, v8
    v_accvgpr_write_b32 a1, v9
    v_accvgpr_write_b32 a2, v10
    v_accvgpr_write_b32 a3, v11
    v_accvgpr_write_b32 a4, v12
    v_accvgpr_write_b32 a5, v13
    v_accvgpr_write_b32 a6, v14
    v_accvgpr_write_b32 a7, v15
    v_accvgpr_write_b32 a64, v16
    v_accvgpr_write_b32 a65, v17
    v_accvgpr_write_b32 a66, v18
    v_accvgpr_write_b32 a67, v19
    v_accvgpr_write_b32 a68, v20
    v_accvgpr_write_b32 a69, v21
    v_accvgpr_write_b32 a70, v22
    v_accvgpr_write_b32 a71, v23
    v_accvgpr_write_b32 a160, v24
    v_accvgpr_write_b32 a161, v25
    v_accvgpr_write_b32 a162, v26
    v_accvgpr_write_b32 a163, v27
    v_accvgpr_write_b32 a164, v28
    v_accvgpr_write_b32 a165, v29
    v_accvgpr_write_b32 a166, v30
    v_accvgpr_write_b32 a167, v31
RWI_1:
    s_waitcnt vmcnt(0)
    v_readfirstlane_b32 s64, v68
    s_nop 0
    s_cmp_ge_u32 s64, 256
    s_cbranch_scc1 RWO_2
    buffer_load_dword v68, v67, s[12:15], 0 offen offset:128 sc1
    s_sub_u32 s19, s19, 1
    s_cbranch_scc1 REC_FAIL
    s_branch RWI_1
RWO_2:
    s_cmp_ge_u32 s28, 72
    s_cbranch_scc1 NOPUB0_3
    s_cmp_lg_u32 s18, 0
    s_cbranch_scc1 NOPUB0_3
    s_waitcnt vmcnt(0)
    v_cmp_eq_u32 vcc, 0xffbfffbf, v65
    v_mov_b32 v67, 0xffffffff
    s_nop 0
    v_cndmask_b32 v65, v65, v67, vcc
    s_add_u32 s64, s30, s20
    s_mov_b64 exec, s[32:33]
    buffer_store_dword v65, v66, s[4:7], s64 offen sc1
    s_mov_b64 exec, -1
NOPUB0_3:
    s_barrier
    s_cmp_lg_u32 s66, 0
    s_cbranch_scc1 W0sc1_PRE
    s_mov_b32 s58, 0x20e000
CEN_4:
    s_mov_b64 exec, 1
    v_mov_b32 v77, 256
    buffer_load_dword v60, v73, s[12:15], 0 offen sc1
    s_mov_b64 exec, -1
    s_waitcnt vmcnt(0)
    v_readfirstlane_b32 s56, v77
    v_readfirstlane_b32 s57, v60
    s_nop 0
    s_min_u32 s57, s57, 32
    s_cmp_ge_u32 s57, 32
    s_cbranch_scc1 CENF_5
    s_sub_u32 s19, s19, 1
    s_cbranch_scc1 REC_FAIL
    s_cmp_lt_u32 s56, 256
    s_cbranch_scc1 CEN_4
    s_branch W0sc1_PRE
CENF_5:
W0_PRE:
    v_add_u32 v78, 65536, v73
    v_add_u32 v79, 131072, v73
    s_add_u32 s31, s24, 4096
    s_add_u32 s38, s20, 4096
    s_add_u32 s39, s20, 8192
    s_barrier
    s_waitcnt vmcnt(0)
    buffer_load_dwordx4 v[20:23], v73, s[4:7], s38 offen offset:1024 sc1
    buffer_load_dwordx4 v[24:27], v73, s[4:7], s38 offen offset:2048 sc1
    ds_read_b128 v[64:67], v73 offset:49152
    ds_read_b128 v[68:71], v73 offset:50176
    v_mov_b32 v36, 0
    v_mov_b32 v37, 0
    v_mov_b32 v38, 0
    v_mov_b32 v39, 0
    v_mov_b32 v40, 0
    v_mov_b32 v41, 0
    v_mov_b32 v42, 0
    v_mov_b32 v43, 0
    v_mov_b32 v44, 0
    v_mov_b32 v45, 0
    v_mov_b32 v46, 0
    v_mov_b32 v47, 0
    v_mov_b32 v48, 0
    v_mov_b32 v49, 0
    v_mov_b32 v50, 0
    v_mov_b32 v51, 0
    buffer_load_dwordx4 v[20:23], v73, s[4:7], s38 offen offset:1024 sc1
    buffer_load_dwordx4 v[24:27], v73, s[4:7], s38 offen offset:2048 sc1
W0_CHK1:
    s_waitcnt vmcnt(2)
    v_max3_u32 v32, v20, v21, v22
    v_max_u32 v32, v32, v23
    v_max3_u32 v33, v24, v25, v26
    v_max_u32 v33, v33, v27
    v_cmp_eq_u32 s[48:49], s47, v32
    v_cmp_eq_u32 s[50:51], s47, v33
    s_nop 0
    s_or_b64 s[56:57], s[48:49], s[50:51]
    s_cbranch_scc1 W0_RETRY1
    ds_write_b128 v73, v[20:23] offset:5120
    ds_write_b128 v73, v[24:27] offset:6144
    s_waitcnt lgkmcnt(2)
    v_smfmac_f32_16x16x64_bf16 v[36:39], v[20:23], v[64:71], v72
    v_smfmac_f32_16x16x64_bf16 v[40:43], v[20:23], a[88:95], v72
    ds_read_b128 v[64:67], v73 offset:57344
    ds_read_b128 v[68:71], v73 offset:58368
    v_smfmac_f32_16x16x64_bf16 v[36:39], v[24:27], a[96:103], v72
    v_smfmac_f32_16x16x64_bf16 v[40:43], v[24:27], a[104:111], v72
    s_waitcnt lgkmcnt(2)
    s_barrier
    ds_read_b128 v[0:3], v73 offset:0
    ds_read_b128 v[4:7], v73 offset:1024
    ds_read_b128 v[8:11], v73 offset:2048
    ds_read_b128 v[12:15], v73 offset:3072
    ds_read_b128 v[16:19], v73 offset:4096
    ds_read_b128 v[28:31], v73 offset:7168
    ds_read_b128 v[32:35], v73 offset:8192
    v_smfmac_f32_16x16x64_bf16 v[44:47], v[20:23], a[224:231], v72
    v_smfmac_f32_16x16x64_bf16 v[48:51], v[20:23], a[232:239], v72
    v_smfmac_f32_16x16x64_bf16 v[44:47], v[24:27], a[240:247], v72
    v_smfmac_f32_16x16x64_bf16 v[48:51], v[24:27], a[248:255], v72
    s_waitcnt lgkmcnt(6)
    v_smfmac_f32_16x16x64_bf16 v[36:39], v[0:3], v[64:71], v72
    v_smfmac_f32_16x16x64_bf16 v[40:43], v[0:3], a[8:15], v72
    ds_read_b128 v[64:67], v78 offset:32768
    ds_read_b128 v[68:71], v78 offset:33792
    s_waitcnt lgkmcnt(7)
    v_smfmac_f32_16x16x64_bf16 v[36:39], v[4:7], a[16:23], v72
    buffer_load_dwordx4 v[52:55], v73, s[4:7], s24 offen offset:0 sc1
    v_smfmac_f32_16x16x64_bf16 v[40:43], v[4:7], a[24:31], v72
    buffer_load_dwordx4 v[56:59], v73, s[4:7], s24 offen offset:1024 sc1
    s_waitcnt lgkmcnt(6)
    v_smfmac_f32_16x16x64_bf16 v[36:39], v[8:11], a[32:39], v72
    buffer_load_dwordx4 v[60:63], v73, s[4:7], s31 offen offset:2048 sc1
    v_smfmac_f32_16x16x64_bf16 v[40:43], v[8:11], a[40:47], v72
    s_waitcnt lgkmcnt(5)
    v_smfmac_f32_16x16x64_bf16 v[36:39], v[12:15], a[48:55], v72
    v_smfmac_f32_16x16x64_bf16 v[40:43], v[12:15], a[56:63], v72
    s_waitcnt lgkmcnt(0)
    v_smfmac_f32_16x16x64_bf16 v[36:39], v[16:19], v[64:71], v72
    v_smfmac_f32_16x16x64_bf16 v[40:43], v[16:19], a[72:79], v72
    ds_read_b128 v[64:67], v78 offset:40960
    ds_read_b128 v[68:71], v78 offset:41984
    v_smfmac_f32_16x16x64_bf16 v[36:39], v[28:31], a[112:119], v72
    v_smfmac_f32_16x16x64_bf16 v[40:43], v[28:31], a[120:127], v72
    v_smfmac_f32_16x16x64_bf16 v[36:39], v[32:35], a[128:135], v72
    v_smfmac_f32_16x16x64_bf16 v[40:43], v[32:35], a[136:143], v72
    s_add_u32 s24, s24, 262144
    v_smfmac_f32_16x16x64_bf16 v[44:47], v[0:3], a[144:151], v72
    v_smfmac_f32_16x16x64_bf16 v[48:51], v[0:3], a[152:159], v72
    s_nop 4
    v_permlane32_swap_b32 v36, v40
    v_permlane32_swap_b32 v37, v41
    v_permlane32_swap_b32 v38, v42
    s_waitcnt lgkmcnt(0)
    v_smfmac_f32_16x16x64_bf16 v[44:47], v[4:7], v[64:71], v72
    v_permlane32_swap_b32 v39, v43
    v_add_f32 v36, v36, v40
    v_add_f32 v37, v37, v41
    v_smfmac_f32_16x16x64_bf16 v[48:51], v[4:7], a[168:175], v72
    v_add_f32 v38, v38, v42
    v_add_f32 v39, v39, v43
    v_cvt_pk_bf16_f32 v36, v36, v37
    v_smfmac_f32_16x16x64_bf16 v[44:47], v[8:11], a[176:183], v72
    v_cvt_pk_bf16_f32 v37, v38, v39
    ds_write_b64 v75, v[36:37] offset:9216
    ds_read_b128 v[64:67], v73 offset:22528
    ds_read_b128 v[68:71], v73 offset:23552
    v_smfmac_f32_16x16x64_bf16 v[48:51], v[8:11], a[184:191], v72
    v_mov_b64 v[38:39], 0
    v_smfmac_f32_16x16x64_bf16 v[44:47], v[12:15], a[192:199], v72
    v_mov_b64 v[40:41], 0
    v_smfmac_f32_16x16x64_bf16 v[48:51], v[12:15], a[200:207], v72
    v_mov_b64 v[42:43], 0
    s_waitcnt lgkmcnt(2)
    s_barrier
    v_smfmac_f32_16x16x64_bf16 v[44:47], v[16:19], a[208:215], v72
    v_mov_b64 v[36:37], 0
    v_smfmac_f32_16x16x64_bf16 v[48:51], v[16:19], a[216:223], v72
    v_smfmac_f32_16x16x64_bf16 v[44:47], v[28:31], v[80:87], v72
    v_smfmac_f32_16x16x64_bf16 v[48:51], v[28:31], v[88:95], v72
    v_smfmac_f32_16x16x64_bf16 v[44:47], v[32:35], v[96:103], v72
    v_smfmac_f32_16x16x64_bf16 v[48:51], v[32:35], v[104:111], v72
    v_smfmac_f32_16x16x64_bf16 v[36:39], v[0:3], v[112:119], v72
    v_smfmac_f32_16x16x64_bf16 v[40:43], v[0:3], v[120:127], v72
    s_nop 5
    v_permlane32_swap_b32 v44, v48
    v_permlane32_swap_b32 v45, v49
    v_permlane32_swap_b32 v46, v50
    v_permlane32_swap_b32 v47, v51
    v_add_f32 v44, v44, v48
    v_add_f32 v45, v45, v49
    v_add_f32 v46, v46, v50
    v_add_f32 v47, v47, v51
    v_cvt_pk_bf16_f32 v44, v44, v45
    v_cvt_pk_bf16_f32 v45, v46, v47
    ds_write_b64 v75, v[44:45] offset:11264
    v_mov_b64 v[48:49], 0
    v_mov_b64 v[50:51], 0
    v_smfmac_f32_16x16x64_bf16 v[36:39], v[4:7], v[128:135], v72
    s_waitcnt lgkmcnt(1)
    v_smfmac_f32_16x16x64_bf16 v[48:51], v[0:3], v[64:71], v72
    v_smfmac_f32_16x16x64_bf16 v[40:43], v[4:7], v[136:143], v72
    s_waitcnt lgkmcnt(0)
    s_barrier
    ds_read_b128 v[64:67], v73 offset:38912
    ds_read_b128 v[68:71], v73 offset:39936
    v_smfmac_f32_16x16x64_bf16 v[36:39], v[8:11], v[144:151], v72
    v_smfmac_f32_16x16x64_bf16 v[40:43], v[8:11], v[152:159], v72
    v_smfmac_f32_16x16x64_bf16 v[36:39], v[12:15], v[160:167], v72
    s_waitcnt lgkmcnt(0)
    v_smfmac_f32_16x16x64_bf16 v[48:51], v[4:7], v[64:71], v72
    v_smfmac_f32_16x16x64_bf16 v[40:43], v[12:15], v[168:175], v72
    ds_read_b128 v[64:67], v73 offset:55296
    ds_read_b128 v[68:71], v73 offset:56320
    ds_read_b128 v[0:3], v78 offset:6144
    ds_read_b128 v[4:7], v78 offset:7168
    v_smfmac_f32_16x16x64_bf16 v[36:39], v[16:19], v[176:183], v72
    v_smfmac_f32_16x16x64_bf16 v[40:43], v[16:19], v[184:191], v72
    v_smfmac_f32_16x16x64_bf16 v[36:39], v[20:23], v[192:199], v72
    s_waitcnt lgkmcnt(2)
    v_smfmac_f32_16x16x64_bf16 v[48:51], v[8:11], v[64:71], v72
    s_waitcnt lgkmcnt(0)
    v_smfmac_f32_16x16x64_bf16 v[48:51], v[12:15], v[0:7], v72
    v_smfmac_f32_16x16x64_bf16 v[40:43], v[20:23], v[200:207], v72
    ds_read_b128 v[64:67], v78 offset:22528
    ds_read_b128 v[68:71], v78 offset:23552
    ds_read_b128 v[0:3], v78 offset:38912
    ds_read_b128 v[4:7], v78 offset:39936
    ds_read_b128 v[8:11], v78 offset:55296
    ds_read_b128 v[12:15], v78 offset:56320
    v_smfmac_f32_16x16x64_bf16 v[36:39], v[24:27], v[208:215], v72
    v_smfmac_f32_16x16x64_bf16 v[40:43], v[24:27], v[216:223], v72
    v_smfmac_f32_16x16x64_bf16 v[36:39], v[28:31], v[224:231], v72
    s_waitcnt lgkmcnt(4)
    v_smfmac_f32_16x16x64_bf16 v[48:51], v[16:19], v[64:71], v72
    s_waitcnt lgkmcnt(2)
    v_smfmac_f32_16x16x64_bf16 v[48:51], v[20:23], v[0:7], v72
    ds_read_b128 v[64:67], v79 offset:6144
    ds_read_b128 v[68:71], v79 offset:7168
    s_waitcnt lgkmcnt(2)
    v_smfmac_f32_16x16x64_bf16 v[48:51], v[24:27], v[8:15], v72
    ds_read_b128 v[0:3], v79 offset:18432
    ds_read_b128 v[4:7], v79 offset:19456
    v_smfmac_f32_16x16x64_bf16 v[40:43], v[28:31], v[232:239], v72
    v_smfmac_f32_16x16x64_bf16 v[36:39], v[32:35], v[240:247], v72
    v_smfmac_f32_16x16x64_bf16 v[40:43], v[32:35], v[248:255], v72
    s_waitcnt lgkmcnt(2)
    v_smfmac_f32_16x16x64_bf16 v[48:51], v[28:31], v[64:71], v72
    s_waitcnt lgkmcnt(0)
    v_smfmac_f32_16x16x64_bf16 v[48:51], v[32:35], v[0:7], v72
    ds_read_b128 v[8:11], v73 offset:16384
    ds_read_b128 v[12:15], v73 offset:17408
    ds_read_b128 v[16:19], v73 offset:24576
    ds_read_b128 v[20:23], v73 offset:25600
    v_cvt_pk_bf16_f32 v36, v36, v37
    v_cvt_pk_bf16_f32 v37, v38, v39
    v_cvt_pk_bf16_f32 v40, v40, v41
    v_cvt_pk_bf16_f32 v41, v42, v43
    v_cvt_pk_bf16_f32 v48, v48, v49
    v_cvt_pk_bf16_f32 v49, v50, v51
    ds_read_b128 v[24:27], v73 offset:32768
    ds_read_b128 v[28:31], v73 offset:33792
    ds_read_b128 v[64:67], v73 offset:40960
    ds_read_b128 v[68:71], v73 offset:41984
    v_lshrrev_b32 v77, 1, v76
    s_waitcnt vmcnt(0)
    s_barrier
    ds_read_b128 v[44:47], v76 offset:11264
    ds_read_b64 v[38:39], v77 offset:11776
    s_waitcnt lgkmcnt(1)
    v_mfma_f32_16x16x32_bf16 v[0:3], v[52:55], v[44:47], 0
    v_mfma_f32_16x16x32_bf16 v[4:7], v[56:59], v[44:47], 0
    v_mfma_f32_16x16x32_bf16 v[32:35], v[60:63], v[44:47], 0
    s_waitcnt lgkmcnt(0)
    s_nop 2
    v_mfma_f32_16x16x16_bf16 v[0:3], v[36:37], v[38:39], v[0:3]
    s_nop 2
    v_mfma_f32_16x16x16_bf16 v[4:7], v[40:41], v[38:39], v[4:7]
    s_nop 2
    v_mfma_f32_16x16x16_bf16 v[32:35], v[48:49], v[38:39], v[32:35]
    s_nop 5
    v_cvt_pk_bf16_f32 v0, v0, v1
    v_cvt_pk_bf16_f32 v1, v2, v3
    s_nop 4
    v_cvt_pk_bf16_f32 v2, v4, v5
    v_cvt_pk_bf16_f32 v3, v6, v7
    ds_write_b128 v76, v[0:3] offset:9216
    s_nop 2
    v_cvt_pk_bf16_f32 v32, v32, v33
    v_cvt_pk_bf16_f32 v33, v34, v35
    ds_write_b64 v76, v[32:33] offset:10752
    v_mov_b64 v[4:5], 0
    v_mov_b64 v[6:7], 0
    v_mov_b64 v[60:61], 0
    v_mov_b64 v[62:63], 0
    s_mul_i32 s27, s16, 9344
    s_add_u32 s27, s27, s46
    s_add_u32 s31, s27, 4096
    s_add_u32 s38, s27, 7168
    s_waitcnt lgkmcnt(0)
    s_barrier
    ds_read_b128 v[36:39], v76 offset:9216
    ds_read_b128 v[40:43], v76 offset:9728
    ds_read_b128 v[44:47], v76 offset:10240
    ds_read_b128 v[48:51], v76 offset:10752
    ds_read_b128 v[52:55], v78 offset:0
    ds_read_b128 v[56:59], v78 offset:1024
    v_mov_b64 v[0:1], 0
    v_mov_b64 v[2:3], 0
    v_mov_b64 v[32:33], 0
    v_mov_b64 v[34:35], 0
    s_waitcnt lgkmcnt(5)
    v_smfmac_f32_16x16x64_bf16 v[0:3], v[36:39], v[8:15], v72
    s_waitcnt lgkmcnt(4)
    v_smfmac_f32_16x16x64_bf16 v[0:3], v[40:43], v[16:23], v72
    ds_read_b128 v[8:11], v78 offset:8192
    ds_read_b128 v[12:15], v78 offset:9216
    s_waitcnt lgkmcnt(5)
    v_smfmac_f32_16x16x64_bf16 v[0:3], v[44:47], v[24:31], v72
    ds_read_b128 v[16:19], v78 offset:16384
    ds_read_b128 v[20:23], v78 offset:17408
    s_waitcnt lgkmcnt(6)
    v_smfmac_f32_16x16x64_bf16 v[0:3], v[48:51], v[64:71], v72
    ds_read_b128 v[24:27], v78 offset:24576
    ds_read_b128 v[28:31], v78 offset:25600
    v_smfmac_f32_16x16x64_bf16 v[4:7], v[36:39], a[80:87], v72
    ds_read_b128 v[64:67], v78 offset:49152
    ds_read_b128 v[68:71], v78 offset:50176
    v_smfmac_f32_16x16x64_bf16 v[4:7], v[40:43], a[0:7], v72
    s_waitcnt lgkmcnt(8)
    v_smfmac_f32_16x16x64_bf16 v[4:7], v[44:47], v[52:59], v72
    v_cvt_pk_bf16_f32 v0, v0, v1
    v_cvt_pk_bf16_f32 v1, v2, v3
    s_waitcnt lgkmcnt(6)
    v_smfmac_f32_16x16x64_bf16 v[4:7], v[48:51], v[8:15], v72
    ds_read_b128 v[52:55], v78 offset:57344
    ds_read_b128 v[56:59], v78 offset:58368
    v_and_or_b32 v0, v0, -2, s90
    buffer_store_dwordx2 v[0:1], v75, s[4:7], s27 offen offset:0
    s_waitcnt lgkmcnt(6)
    v_smfmac_f32_16x16x64_bf16 v[32:35], v[36:39], v[16:23], v72
    ds_read_b128 v[8:11], v79 offset:0
    ds_read_b128 v[12:15], v79 offset:1024
    s_waitcnt lgkmcnt(6)
    v_smfmac_f32_16x16x64_bf16 v[32:35], v[40:43], v[24:31], v72
    ds_read_b128 v[16:19], v79 offset:8192
    ds_read_b128 v[20:23], v79 offset:9216
    v_smfmac_f32_16x16x64_bf16 v[32:35], v[44:47], a[64:71], v72
    v_cvt_pk_bf16_f32 v4, v4, v5
    v_cvt_pk_bf16_f32 v5, v6, v7
    v_smfmac_f32_16x16x64_bf16 v[32:35], v[48:51], a[160:167], v72
    v_and_or_b32 v4, v4, -2, s90
    buffer_store_dwordx2 v[4:5], v75, s[4:7], s27 offen offset:2048
    s_waitcnt lgkmcnt(6)
    v_smfmac_f32_16x16x64_bf16 v[60:63], v[36:39], v[64:71], v72
    s_waitcnt lgkmcnt(4)
    v_smfmac_f32_16x16x64_bf16 v[60:63], v[40:43], v[52:59], v72
    s_waitcnt lgkmcnt(2)
    v_smfmac_f32_16x16x64_bf16 v[60:63], v[44:47], v[8:15], v72
    v_cvt_pk_bf16_f32 v32, v32, v33
    v_cvt_pk_bf16_f32 v33, v34, v35
    s_waitcnt lgkmcnt(0)
    v_smfmac_f32_16x16x64_bf16 v[60:63], v[48:51], v[16:23], v72
    v_and_or_b32 v32, v32, -2, s90
    buffer_store_dwordx2 v[32:33], v75, s[4:7], s31 offen offset:0
    s_nop 5
    v_cvt_pk_bf16_f32 v60, v60, v61
    v_cvt_pk_bf16_f32 v61, v62, v63
    v_and_or_b32 v60, v60, -2, s90
    buffer_store_dwordx2 v[60:61], v75, s[4:7], s31 offen offset:2048
    s_add_u32 s40, s20, 16384
    s_cmp_eq_u32 s40, 0x110000
    s_cselect_b32 s40, 0x100000, s40
    v_lshrrev_b32 v77, 7, v73
    v_mul_u32_u24 v77, 9344, v77
    v_and_b32 v37, 0x70, v73
    v_add_u32 v36, v77, v37
    s_add_u32 s29, s30, s46
    s_add_u32 s31, s29, 74752
    s_add_u32 s38, s29, 149504
    s_add_u32 s39, s29, 224256
    s_waitcnt vmcnt(1)
    buffer_load_dwordx4 v[16:19], v36, s[4:7], s29 offen sc1
    buffer_load_dwordx4 v[20:23], v36, s[4:7], s31 offen sc1
    buffer_load_dwordx4 v[24:27], v36, s[4:7], s38 offen sc1
    buffer_load_dwordx4 v[28:31], v36, s[4:7], s39 offen sc1
    v_bfe_u32 v77, v73, 4, 4
    v_and_b32 v78, 1, v77
    v_lshlrev_b32 v78, 4, v78
    v_mov_b32 v79, 0x3f80
    v_lshlrev_b32 v78, v78, v79
    v_lshrrev_b32 v77, 1, v77
    v_cmp_eq_u32 vcc, 0, v77
    s_nop 1
    v_cndmask_b32 v32, 0, v78, vcc
    v_cmp_eq_u32 vcc, 1, v77
    s_nop 1
    v_cndmask_b32 v33, 0, v78, vcc
    v_cmp_eq_u32 vcc, 2, v77
    s_nop 1
    v_cndmask_b32 v34, 0, v78, vcc
    v_cmp_eq_u32 vcc, 3, v77
    s_nop 1
    v_cndmask_b32 v35, 0, v78, vcc
    v_bfe_u32 v79, v73, 8, 1
    v_lshl_add_u32 v37, v79, 3, v37
    v_bfe_u32 v79, v73, 9, 1
    v_lshl_add_u32 v37, v79, 2, v37
    s_add_u32 s58, s40, s30
    s_add_u32 s100, s20, s30
    v_mov_b32 v8, 0xffbfffbf
    buffer_load_dwordx4 v[16:19], v36, s[4:7], s29 offen sc1
    buffer_load_dwordx4 v[20:23], v36, s[4:7], s31 offen sc1
    buffer_load_dwordx4 v[24:27], v36, s[4:7], s38 offen sc1
    buffer_load_dwordx4 v[28:31], v36, s[4:7], s39 offen sc1
    s_branch W0_RED1A
W0_REDA:
    v_and_b32 v44, 1, v44
    v_cmp_ne_u32 s[48:49], 0, v44
    v_and_b32 v45, 1, v45
    v_cmp_ne_u32 s[50:51], 0, v45
    v_and_b32 v46, 1, v46
    v_cmp_ne_u32 s[52:53], 0, v46
    v_and_b32 v47, 1, v47
    v_cmp_ne_u32 s[54:55], 0, v47
    s_mov_b64 exec, s[48:49]
    buffer_load_dwordx4 v[16:19], v36, s[4:7], s29 offen sc1
    s_mov_b64 exec, s[50:51]
    buffer_load_dwordx4 v[20:23], v36, s[4:7], s31 offen sc1
    s_mov_b64 exec, s[52:53]
    buffer_load_dwordx4 v[24:27], v36, s[4:7], s38 offen sc1
    s_mov_b64 exec, s[54:55]
    buffer_load_dwordx4 v[28:31], v36, s[4:7], s39 offen sc1
    s_mov_b64 exec, -1
    s_sub_u32 s19, s19, 1
    s_cbranch_scc1 REC_FAIL
W0_RED1A:
    s_waitcnt vmcnt(4)
    v_bitop3_b32 v44, v16, v18, s90 bitop3:0x7e
    v_bitop3_b32 v45, v20, v22, s90 bitop3:0x7e
    v_bitop3_b32 v46, v24, v26, s90 bitop3:0x7e
    v_bitop3_b32 v47, v28, v30, s90 bitop3:0x7e
    v_or3_b32 v48, v44, v45, v46
    v_or_b32 v48, v48, v47
    v_and_b32 v48, 1, v48
    v_cmp_ne_u32 vcc, 0, v48
    v_mfma_f32_16x16x32_bf16 v[40:43], v[16:19], v[32:35], 0
    s_cbranch_vccnz W0_REDA
    v_mfma_f32_16x16x32_bf16 v[40:43], v[20:23], v[32:35], v[40:43]
    v_mfma_f32_16x16x32_bf16 v[40:43], v[24:27], v[32:35], v[40:43]
    v_mfma_f32_16x16x32_bf16 v[40:43], v[28:31], v[32:35], v[40:43]
    s_nop 7
    v_permlane32_swap_b32 v40, v42
    v_permlane32_swap_b32 v41, v43
    v_pk_add_f32 v[40:41], v[40:41], v[42:43]
    v_cvt_pk_bf16_f32 v40, v40, v41
    s_mov_b64 exec, s[32:33]
    buffer_store_dword v40, v37, s[4:7], s58 offen
    buffer_store_dword v8, v37, s[4:7], s100 offen
    s_cmp_lt_u32 s18, 62
    s_cbranch_scc1 NOH_6
    s_add_u32 s59, s30, 0x19dc00
    buffer_store_dword v40, v37, s[4:7], s59 offen sc1
NOH_6:
    s_mov_b64 exec, -1
W0_NORED:
    s_mov_b32 s20, s40
    s_xor_b32 s46, s46, 0x80000
    s_and_b32 s31, s18, 1
    s_xor_b32 s90, s90, s31
    s_add_u32 s18, s18, 1
    s_cmp_lt_u32 s18, s67
    s_cbranch_scc1 W0_PRE
    s_branch REC_EXIT
W0_RETRY1:
    s_mov_b64 exec, s[48:49]
    buffer_load_dwordx4 v[20:23], v73, s[4:7], s38 offen offset:1024 sc1
    s_mov_b64 exec, s[50:51]
    buffer_load_dwordx4 v[24:27], v73, s[4:7], s38 offen offset:2048 sc1
    s_mov_b64 exec, -1
    s_sub_u32 s19, s19, 1
    s_cbranch_scc1 REC_FAIL
    s_branch W0_CHK1
W0sc1_PRE:
    v_add_u32 v78, 65536, v73
    v_add_u32 v79, 131072, v73
    s_add_u32 s31, s24, 4096
    s_add_u32 s38, s20, 4096
    s_add_u32 s39, s20, 8192
    s_barrier
    s_waitcnt vmcnt(0)
    buffer_load_dwordx4 v[20:23], v73, s[4:7], s38 offen offset:1024 sc1
    buffer_load_dwordx4 v[24:27], v73, s[4:7], s38 offen offset:2048 sc1
    ds_read_b128 v[64:67], v73 offset:49152
    ds_read_b128 v[68:71], v73 offset:50176
    v_mov_b32 v36, 0
    v_mov_b32 v37, 0
    v_mov_b32 v38, 0
    v_mov_b32 v39, 0
    v_mov_b32 v40, 0
    v_mov_b32 v41, 0
    v_mov_b32 v42, 0
    v_mov_b32 v43, 0
    v_mov_b32 v44, 0
    v_mov_b32 v45, 0
    v_mov_b32 v46, 0
    v_mov_b32 v47, 0
    v_mov_b32 v48, 0
    v_mov_b32 v49, 0
    v_mov_b32 v50, 0
    v_mov_b32 v51, 0
    buffer_load_dwordx4 v[20:23], v73, s[4:7], s38 offen offset:1024 sc1
    buffer_load_dwordx4 v[24:27], v73, s[4:7], s38 offen offset:2048 sc1
W0sc1_CHK1:
    s_waitcnt vmcnt(2)
    v_max3_u32 v32, v20, v21, v22
    v_max_u32 v32, v32, v23
    v_max3_u32 v33, v24, v25, v26
    v_max_u32 v33, v33, v27
    v_cmp_eq_u32 s[48:49], s47, v32
    v_cmp_eq_u32 s[50:51], s47, v33
    s_nop 0
    s_or_b64 s[56:57], s[48:49], s[50:51]
    s_cbranch_scc1 W0sc1_RETRY1
    ds_write_b128 v73, v[20:23] offset:5120
    ds_write_b128 v73, v[24:27] offset:6144
    s_waitcnt lgkmcnt(2)
    v_smfmac_f32_16x16x64_bf16 v[36:39], v[20:23], v[64:71], v72
    v_smfmac_f32_16x16x64_bf16 v[40:43], v[20:23], a[88:95], v72
    ds_read_b128 v[64:67], v73 offset:57344
    ds_read_b128 v[68:71], v73 offset:58368
    v_smfmac_f32_16x16x64_bf16 v[36:39], v[24:27], a[96:103], v72
    v_smfmac_f32_16x16x64_bf16 v[40:43], v[24:27], a[104:111], v72
    s_waitcnt lgkmcnt(2)
    s_barrier
    ds_read_b128 v[0:3], v73 offset:0
    ds_read_b128 v[4:7], v73 offset:1024
    ds_read_b128 v[8:11], v73 offset:2048
    ds_read_b128 v[12:15], v73 offset:3072
    ds_read_b128 v[16:19], v73 offset:4096
    ds_read_b128 v[28:31], v73 offset:7168
    ds_read_b128 v[32:35], v73 offset:8192
    v_smfmac_f32_16x16x64_bf16 v[44:47], v[20:23], a[224:231], v72
    v_smfmac_f32_16x16x64_bf16 v[48:51], v[20:23], a[232:239], v72
    v_smfmac_f32_16x16x64_bf16 v[44:47], v[24:27], a[240:247], v72
    v_smfmac_f32_16x16x64_bf16 v[48:51], v[24:27], a[248:255], v72
    s_waitcnt lgkmcnt(6)
    v_smfmac_f32_16x16x64_bf16 v[36:39], v[0:3], v[64:71], v72
    v_smfmac_f32_16x16x64_bf16 v[40:43], v[0:3], a[8:15], v72
    ds_read_b128 v[64:67], v78 offset:32768
    ds_read_b128 v[68:71], v78 offset:33792
    s_waitcnt lgkmcnt(7)
    v_smfmac_f32_16x16x64_bf16 v[36:39], v[4:7], a[16:23], v72
    buffer_load_dwordx4 v[52:55], v73, s[4:7], s24 offen offset:0 sc1
    v_smfmac_f32_16x16x64_bf16 v[40:43], v[4:7], a[24:31], v72
    buffer_load_dwordx4 v[56:59], v73, s[4:7], s24 offen offset:1024 sc1
    s_waitcnt lgkmcnt(6)
    v_smfmac_f32_16x16x64_bf16 v[36:39], v[8:11], a[32:39], v72
    buffer_load_dwordx4 v[60:63], v73, s[4:7], s31 offen offset:2048 sc1
    v_smfmac_f32_16x16x64_bf16 v[40:43], v[8:11], a[40:47], v72
    s_waitcnt lgkmcnt(5)
    v_smfmac_f32_16x16x64_bf16 v[36:39], v[12:15], a[48:55], v72
    v_smfmac_f32_16x16x64_bf16 v[40:43], v[12:15], a[56:63], v72
    s_waitcnt lgkmcnt(0)
    v_smfmac_f32_16x16x64_bf16 v[36:39], v[16:19], v[64:71], v72
    v_smfmac_f32_16x16x64_bf16 v[40:43], v[16:19], a[72:79], v72
    ds_read_b128 v[64:67], v78 offset:40960
    ds_read_b128 v[68:71], v78 offset:41984
    v_smfmac_f32_16x16x64_bf16 v[36:39], v[28:31], a[112:119], v72
    v_smfmac_f32_16x16x64_bf16 v[40:43], v[28:31], a[120:127], v72
    v_smfmac_f32_16x16x64_bf16 v[36:39], v[32:35], a[128:135], v72
    v_smfmac_f32_16x16x64_bf16 v[40:43], v[32:35], a[136:143], v72
    s_add_u32 s24, s24, 262144
    v_smfmac_f32_16x16x64_bf16 v[44:47], v[0:3], a[144:151], v72
    v_smfmac_f32_16x16x64_bf16 v[48:51], v[0:3], a[152:159], v72
    s_nop 4
    v_permlane32_swap_b32 v36, v40
    v_permlane32_swap_b32 v37, v41
    v_permlane32_swap_b32 v38, v42
    s_waitcnt lgkmcnt(0)
    v_smfmac_f32_16x16x64_bf16 v[44:47], v[4:7], v[64:71], v72
    v_permlane32_swap_b32 v39, v43
    v_add_f32 v36, v36, v40
    v_add_f32 v37, v37, v41
    v_smfmac_f32_16x16x64_bf16 v[48:51], v[4:7], a[168:175], v72
    v_add_f32 v38, v38, v42
    v_add_f32 v39, v39, v43
    v_cvt_pk_bf16_f32 v36, v36, v37
    v_smfmac_f32_16x16x64_bf16 v[44:47], v[8:11], a[176:183], v72
    v_cvt_pk_bf16_f32 v37, v38, v39
    ds_write_b64 v75, v[36:37] offset:9216
    ds_read_b128 v[64:67], v73 offset:22528
    ds_read_b128 v[68:71], v73 offset:23552
    v_smfmac_f32_16x16x64_bf16 v[48:51], v[8:11], a[184:191], v72
    v_mov_b64 v[38:39], 0
    v_smfmac_f32_16x16x64_bf16 v[44:47], v[12:15], a[192:199], v72
    v_mov_b64 v[40:41], 0
    v_smfmac_f32_16x16x64_bf16 v[48:51], v[12:15], a[200:207], v72
    v_mov_b64 v[42:43], 0
    s_waitcnt lgkmcnt(2)
    s_barrier
    v_smfmac_f32_16x16x64_bf16 v[44:47], v[16:19], a[208:215], v72
    v_mov_b64 v[36:37], 0
    v_smfmac_f32_16x16x64_bf16 v[48:51], v[16:19], a[216:223], v72
    v_smfmac_f32_16x16x64_bf16 v[44:47], v[28:31], v[80:87], v72
    v_smfmac_f32_16x16x64_bf16 v[48:51], v[28:31], v[88:95], v72
    v_smfmac_f32_16x16x64_bf16 v[44:47], v[32:35], v[96:103], v72
    v_smfmac_f32_16x16x64_bf16 v[48:51], v[32:35], v[104:111], v72
    v_smfmac_f32_16x16x64_bf16 v[36:39], v[0:3], v[112:119], v72
    v_smfmac_f32_16x16x64_bf16 v[40:43], v[0:3], v[120:127], v72
    s_nop 5
    v_permlane32_swap_b32 v44, v48
    v_permlane32_swap_b32 v45, v49
    v_permlane32_swap_b32 v46, v50
    v_permlane32_swap_b32 v47, v51
    v_add_f32 v44, v44, v48
    v_add_f32 v45, v45, v49
    v_add_f32 v46, v46, v50
    v_add_f32 v47, v47, v51
    v_cvt_pk_bf16_f32 v44, v44, v45
    v_cvt_pk_bf16_f32 v45, v46, v47
    ds_write_b64 v75, v[44:45] offset:11264
    v_mov_b64 v[48:49], 0
    v_mov_b64 v[50:51], 0
    v_smfmac_f32_16x16x64_bf16 v[36:39], v[4:7], v[128:135], v72
    s_waitcnt lgkmcnt(1)
    v_smfmac_f32_16x16x64_bf16 v[48:51], v[0:3], v[64:71], v72
    v_smfmac_f32_16x16x64_bf16 v[40:43], v[4:7], v[136:143], v72
    s_waitcnt lgkmcnt(0)
    s_barrier
    ds_read_b128 v[64:67], v73 offset:38912
    ds_read_b128 v[68:71], v73 offset:39936
    v_smfmac_f32_16x16x64_bf16 v[36:39], v[8:11], v[144:151], v72
    v_smfmac_f32_16x16x64_bf16 v[40:43], v[8:11], v[152:159], v72
    v_smfmac_f32_16x16x64_bf16 v[36:39], v[12:15], v[160:167], v72
    s_waitcnt lgkmcnt(0)
    v_smfmac_f32_16x16x64_bf16 v[48:51], v[4:7], v[64:71], v72
    v_smfmac_f32_16x16x64_bf16 v[40:43], v[12:15], v[168:175], v72
    ds_read_b128 v[64:67], v73 offset:55296
    ds_read_b128 v[68:71], v73 offset:56320
    ds_read_b128 v[0:3], v78 offset:6144
    ds_read_b128 v[4:7], v78 offset:7168
    v_smfmac_f32_16x16x64_bf16 v[36:39], v[16:19], v[176:183], v72
    v_smfmac_f32_16x16x64_bf16 v[40:43], v[16:19], v[184:191], v72
    v_smfmac_f32_16x16x64_bf16 v[36:39], v[20:23], v[192:199], v72
    s_waitcnt lgkmcnt(2)
    v_smfmac_f32_16x16x64_bf16 v[48:51], v[8:11], v[64:71], v72
    s_waitcnt lgkmcnt(0)
    v_smfmac_f32_16x16x64_bf16 v[48:51], v[12:15], v[0:7], v72
    v_smfmac_f32_16x16x64_bf16 v[40:43], v[20:23], v[200:207], v72
    ds_read_b128 v[64:67], v78 offset:22528
    ds_read_b128 v[68:71], v78 offset:23552
    ds_read_b128 v[0:3], v78 offset:38912
    ds_read_b128 v[4:7], v78 offset:39936
    ds_read_b128 v[8:11], v78 offset:55296
    ds_read_b128 v[12:15], v78 offset:56320
    v_smfmac_f32_16x16x64_bf16 v[36:39], v[24:27], v[208:215], v72
    v_smfmac_f32_16x16x64_bf16 v[40:43], v[24:27], v[216:223], v72
    v_smfmac_f32_16x16x64_bf16 v[36:39], v[28:31], v[224:231], v72
    s_waitcnt lgkmcnt(4)
    v_smfmac_f32_16x16x64_bf16 v[48:51], v[16:19], v[64:71], v72
    s_waitcnt lgkmcnt(2)
    v_smfmac_f32_16x16x64_bf16 v[48:51], v[20:23], v[0:7], v72
    ds_read_b128 v[64:67], v79 offset:6144
    ds_read_b128 v[68:71], v79 offset:7168
    s_waitcnt lgkmcnt(2)
    v_smfmac_f32_16x16x64_bf16 v[48:51], v[24:27], v[8:15], v72
    ds_read_b128 v[0:3], v79 offset:18432
    ds_read_b128 v[4:7], v79 offset:19456
    v_smfmac_f32_16x16x64_bf16 v[40:43], v[28:31], v[232:239], v72
    v_smfmac_f32_16x16x64_bf16 v[36:39], v[32:35], v[240:247], v72
    v_smfmac_f32_16x16x64_bf16 v[40:43], v[32:35], v[248:255], v72
    s_waitcnt lgkmcnt(2)
    v_smfmac_f32_16x16x64_bf16 v[48:51], v[28:31], v[64:71], v72
    s_waitcnt lgkmcnt(0)
    v_smfmac_f32_16x16x64_bf16 v[48:51], v[32:35], v[0:7], v72
    ds_read_b128 v[8:11], v73 offset:16384
    ds_read_b128 v[12:15], v73 offset:17408
    ds_read_b128 v[16:19], v73 offset:24576
    ds_read_b128 v[20:23], v73 offset:25600
    v_cvt_pk_bf16_f32 v36, v36, v37
    v_cvt_pk_bf16_f32 v37, v38, v39
    v_cvt_pk_bf16_f32 v40, v40, v41
    v_cvt_pk_bf16_f32 v41, v42, v43
    v_cvt_pk_bf16_f32 v48, v48, v49
    v_cvt_pk_bf16_f32 v49, v50, v51
    ds_read_b128 v[24:27], v73 offset:32768
    ds_read_b128 v[28:31], v73 offset:33792
    ds_read_b128 v[64:67], v73 offset:40960
    ds_read_b128 v[68:71], v73 offset:41984
    v_lshrrev_b32 v77, 1, v76
    s_waitcnt vmcnt(0)
    s_barrier
    ds_read_b128 v[44:47], v76 offset:11264
    ds_read_b64 v[38:39], v77 offset:11776
    s_waitcnt lgkmcnt(1)
    v_mfma_f32_16x16x32_bf16 v[0:3], v[52:55], v[44:47], 0
    v_mfma_f32_16x16x32_bf16 v[4:7], v[56:59], v[44:47], 0
    v_mfma_f32_16x16x32_bf16 v[32:35], v[60:63], v[44:47], 0
    s_waitcnt lgkmcnt(0)
    s_nop 2
    v_mfma_f32_16x16x16_bf16 v[0:3], v[36:37], v[38:39], v[0:3]
    s_nop 2
    v_mfma_f32_16x16x16_bf16 v[4:7], v[40:41], v[38:39], v[4:7]
    s_nop 2
    v_mfma_f32_16x16x16_bf16 v[32:35], v[48:49], v[38:39], v[32:35]
    s_nop 5
    v_cvt_pk_bf16_f32 v0, v0, v1
    v_cvt_pk_bf16_f32 v1, v2, v3
    s_nop 4
    v_cvt_pk_bf16_f32 v2, v4, v5
    v_cvt_pk_bf16_f32 v3, v6, v7
    ds_write_b128 v76, v[0:3] offset:9216
    s_nop 2
    v_cvt_pk_bf16_f32 v32, v32, v33
    v_cvt_pk_bf16_f32 v33, v34, v35
    ds_write_b64 v76, v[32:33] offset:10752
    v_mov_b64 v[4:5], 0
    v_mov_b64 v[6:7], 0
    v_mov_b64 v[60:61], 0
    v_mov_b64 v[62:63], 0
    s_mul_i32 s27, s16, 9344
    s_add_u32 s27, s27, s46
    s_add_u32 s31, s27, 4096
    s_add_u32 s38, s27, 7168
    s_waitcnt lgkmcnt(0)
    s_barrier
    ds_read_b128 v[36:39], v76 offset:9216
    ds_read_b128 v[40:43], v76 offset:9728
    ds_read_b128 v[44:47], v76 offset:10240
    ds_read_b128 v[48:51], v76 offset:10752
    ds_read_b128 v[52:55], v78 offset:0
    ds_read_b128 v[56:59], v78 offset:1024
    v_mov_b64 v[0:1], 0
    v_mov_b64 v[2:3], 0
    v_mov_b64 v[32:33], 0
    v_mov_b64 v[34:35], 0
    s_waitcnt lgkmcnt(5)
    v_smfmac_f32_16x16x64_bf16 v[0:3], v[36:39], v[8:15], v72
    s_waitcnt lgkmcnt(4)
    v_smfmac_f32_16x16x64_bf16 v[0:3], v[40:43], v[16:23], v72
    ds_read_b128 v[8:11], v78 offset:8192
    ds_read_b128 v[12:15], v78 offset:9216
    s_waitcnt lgkmcnt(5)
    v_smfmac_f32_16x16x64_bf16 v[0:3], v[44:47], v[24:31], v72
    ds_read_b128 v[16:19], v78 offset:16384
    ds_read_b128 v[20:23], v78 offset:17408
    s_waitcnt lgkmcnt(6)
    v_smfmac_f32_16x16x64_bf16 v[0:3], v[48:51], v[64:71], v72
    ds_read_b128 v[24:27], v78 offset:24576
    ds_read_b128 v[28:31], v78 offset:25600
    v_smfmac_f32_16x16x64_bf16 v[4:7], v[36:39], a[80:87], v72
    ds_read_b128 v[64:67], v78 offset:49152
    ds_read_b128 v[68:71], v78 offset:50176
    v_smfmac_f32_16x16x64_bf16 v[4:7], v[40:43], a[0:7], v72
    s_waitcnt lgkmcnt(8)
    v_smfmac_f32_16x16x64_bf16 v[4:7], v[44:47], v[52:59], v72
    v_cvt_pk_bf16_f32 v0, v0, v1
    v_cvt_pk_bf16_f32 v1, v2, v3
    s_waitcnt lgkmcnt(6)
    v_smfmac_f32_16x16x64_bf16 v[4:7], v[48:51], v[8:15], v72
    ds_read_b128 v[52:55], v78 offset:57344
    ds_read_b128 v[56:59], v78 offset:58368
    v_and_or_b32 v0, v0, -2, s90
    buffer_store_dwordx2 v[0:1], v75, s[4:7], s27 offen offset:0 sc1
    s_waitcnt lgkmcnt(6)
    v_smfmac_f32_16x16x64_bf16 v[32:35], v[36:39], v[16:23], v72
    ds_read_b128 v[8:11], v79 offset:0
    ds_read_b128 v[12:15], v79 offset:1024
    s_waitcnt lgkmcnt(6)
    v_smfmac_f32_16x16x64_bf16 v[32:35], v[40:43], v[24:31], v72
    ds_read_b128 v[16:19], v79 offset:8192
    ds_read_b128 v[20:23], v79 offset:9216
    v_smfmac_f32_16x16x64_bf16 v[32:35], v[44:47], a[64:71], v72
    v_cvt_pk_bf16_f32 v4, v4, v5
    v_cvt_pk_bf16_f32 v5, v6, v7
    v_smfmac_f32_16x16x64_bf16 v[32:35], v[48:51], a[160:167], v72
    v_and_or_b32 v4, v4, -2, s90
    buffer_store_dwordx2 v[4:5], v75, s[4:7], s27 offen offset:2048 sc1
    s_waitcnt lgkmcnt(6)
    v_smfmac_f32_16x16x64_bf16 v[60:63], v[36:39], v[64:71], v72
    s_waitcnt lgkmcnt(4)
    v_smfmac_f32_16x16x64_bf16 v[60:63], v[40:43], v[52:59], v72
    s_waitcnt lgkmcnt(2)
    v_smfmac_f32_16x16x64_bf16 v[60:63], v[44:47], v[8:15], v72
    v_cvt_pk_bf16_f32 v32, v32, v33
    v_cvt_pk_bf16_f32 v33, v34, v35
    s_waitcnt lgkmcnt(0)
    v_smfmac_f32_16x16x64_bf16 v[60:63], v[48:51], v[16:23], v72
    v_and_or_b32 v32, v32, -2, s90
    buffer_store_dwordx2 v[32:33], v75, s[4:7], s31 offen offset:0 sc1
    s_nop 5
    v_cvt_pk_bf16_f32 v60, v60, v61
    v_cvt_pk_bf16_f32 v61, v62, v63
    v_and_or_b32 v60, v60, -2, s90
    buffer_store_dwordx2 v[60:61], v75, s[4:7], s31 offen offset:2048 sc1
    s_add_u32 s40, s20, 16384
    s_cmp_eq_u32 s40, 0x110000
    s_cselect_b32 s40, 0x100000, s40
    v_lshrrev_b32 v77, 7, v73
    v_mul_u32_u24 v77, 9344, v77
    v_and_b32 v37, 0x70, v73
    v_add_u32 v36, v77, v37
    s_add_u32 s29, s30, s46
    s_add_u32 s31, s29, 74752
    s_add_u32 s38, s29, 149504
    s_add_u32 s39, s29, 224256
    s_waitcnt vmcnt(1)
    buffer_load_dwordx4 v[16:19], v36, s[4:7], s29 offen sc1
    buffer_load_dwordx4 v[20:23], v36, s[4:7], s31 offen sc1
    buffer_load_dwordx4 v[24:27], v36, s[4:7], s38 offen sc1
    buffer_load_dwordx4 v[28:31], v36, s[4:7], s39 offen sc1
    v_bfe_u32 v77, v73, 4, 4
    v_and_b32 v78, 1, v77
    v_lshlrev_b32 v78, 4, v78
    v_mov_b32 v79, 0x3f80
    v_lshlrev_b32 v78, v78, v79
    v_lshrrev_b32 v77, 1, v77
    v_cmp_eq_u32 vcc, 0, v77
    s_nop 1
    v_cndmask_b32 v32, 0, v78, vcc
    v_cmp_eq_u32 vcc, 1, v77
    s_nop 1
    v_cndmask_b32 v33, 0, v78, vcc
    v_cmp_eq_u32 vcc, 2, v77
    s_nop 1
    v_cndmask_b32 v34, 0, v78, vcc
    v_cmp_eq_u32 vcc, 3, v77
    s_nop 1
    v_cndmask_b32 v35, 0, v78, vcc
    v_bfe_u32 v79, v73, 8, 1
    v_lshl_add_u32 v37, v79, 3, v37
    v_bfe_u32 v79, v73, 9, 1
    v_lshl_add_u32 v37, v79, 2, v37
    s_add_u32 s58, s40, s30
    s_add_u32 s100, s20, s30
    v_mov_b32 v8, 0xffbfffbf
    buffer_load_dwordx4 v[16:19], v36, s[4:7], s29 offen sc1
    buffer_load_dwordx4 v[20:23], v36, s[4:7], s31 offen sc1
    buffer_load_dwordx4 v[24:27], v36, s[4:7], s38 offen sc1
    buffer_load_dwordx4 v[28:31], v36, s[4:7], s39 offen sc1
    s_branch W0sc1_RED1A
W0sc1_REDA:
    v_and_b32 v44, 1, v44
    v_cmp_ne_u32 s[48:49], 0, v44
    v_and_b32 v45, 1, v45
    v_cmp_ne_u32 s[50:51], 0, v45
    v_and_b32 v46, 1, v46
    v_cmp_ne_u32 s[52:53], 0, v46
    v_and_b32 v47, 1, v47
    v_cmp_ne_u32 s[54:55], 0, v47
    s_mov_b64 exec, s[48:49]
    buffer_load_dwordx4 v[16:19], v36, s[4:7], s29 offen sc1
    s_mov_b64 exec, s[50:51]
    buffer_load_dwordx4 v[20:23], v36, s[4:7], s31 offen sc1
    s_mov_b64 exec, s[52:53]
    buffer_load_dwordx4 v[24:27], v36, s[4:7], s38 offen sc1
    s_mov_b64 exec, s[54:55]
    buffer_load_dwordx4 v[28:31], v36, s[4:7], s39 offen sc1
    s_mov_b64 exec, -1
    s_sub_u32 s19, s19, 1
    s_cbranch_scc1 REC_FAIL
W0sc1_RED1A:
    s_waitcnt vmcnt(4)
    v_bitop3_b32 v44, v16, v18, s90 bitop3:0x7e
    v_bitop3_b32 v45, v20, v22, s90 bitop3:0x7e
    v_bitop3_b32 v46, v24, v26, s90 bitop3:0x7e
    v_bitop3_b32 v47, v28, v30, s90 bitop3:0x7e
    v_or3_b32 v48, v44, v45, v46
    v_or_b32 v48, v48, v47
    v_and_b32 v48, 1, v48
    v_cmp_ne_u32 vcc, 0, v48
    v_mfma_f32_16x16x32_bf16 v[40:43], v[16:19], v[32:35], 0
    s_cbranch_vccnz W0sc1_REDA
    v_mfma_f32_16x16x32_bf16 v[40:43], v[20:23], v[32:35], v[40:43]
    v_mfma_f32_16x16x32_bf16 v[40:43], v[24:27], v[32:35], v[40:43]
    v_mfma_f32_16x16x32_bf16 v[40:43], v[28:31], v[32:35], v[40:43]
    s_nop 7
    v_permlane32_swap_b32 v40, v42
    v_permlane32_swap_b32 v41, v43
    v_pk_add_f32 v[40:41], v[40:41], v[42:43]
    v_cvt_pk_bf16_f32 v40, v40, v41
    s_mov_b64 exec, s[32:33]
    buffer_store_dword v40, v37, s[4:7], s58 offen sc1
    buffer_store_dword v8, v37, s[4:7], s100 offen sc1
    s_cmp_lt_u32 s18, 62
    s_cbranch_scc1 NOH_7
    s_add_u32 s59, s30, 0x19dc00
    buffer_store_dword v40, v37, s[4:7], s59 offen sc1
NOH_7:
    s_mov_b64 exec, -1
W0sc1_NORED:
    s_mov_b32 s20, s40
    s_xor_b32 s46, s46, 0x80000
    s_and_b32 s31, s18, 1
    s_xor_b32 s90, s90, s31
    s_add_u32 s18, s18, 1
    s_cmp_lt_u32 s18, s67
    s_cbranch_scc1 W0sc1_PRE
    s_branch REC_EXIT
W0sc1_RETRY1:
    s_mov_b64 exec, s[48:49]
    buffer_load_dwordx4 v[20:23], v73, s[4:7], s38 offen offset:1024 sc1
    s_mov_b64 exec, s[50:51]
    buffer_load_dwordx4 v[24:27], v73, s[4:7], s38 offen offset:2048 sc1
    s_mov_b64 exec, -1
    s_sub_u32 s19, s19, 1
    s_cbranch_scc1 REC_FAIL
    s_branch W0sc1_CHK1
REC_W1:
    ds_read_b128 v[0:3], v73 offset:51200
    ds_read_b128 v[4:7], v73 offset:52224
    ds_read_b128 v[8:11], v73 offset:59392
    ds_read_b128 v[12:15], v73 offset:60416
    ds_read_b128 v[16:19], v78 offset:34816
    ds_read_b128 v[20:23], v78 offset:35840
    ds_read_b128 v[24:27], v78 offset:43008
    ds_read_b128 v[28:31], v78 offset:44032
    s_waitcnt lgkmcnt(0)
    ds_write_b128 v73, a[112:115] offset:51200
    ds_write_b128 v73, a[116:119] offset:52224
    ds_write_b128 v73, a[0:3] offset:59392
    ds_write_b128 v73, a[4:7] offset:60416
    ds_write_b128 v78, a[64:67] offset:34816
    ds_write_b128 v78, a[68:71] offset:35840
    ds_write_b128 v78, a[160:163] offset:43008
    ds_write_b128 v78, a[164:167] offset:44032
    s_waitcnt lgkmcnt(0)
    v_accvgpr_write_b32 a112, v0
    v_accvgpr_write_b32 a113, v1
    v_accvgpr_write_b32 a114, v2
    v_accvgpr_write_b32 a115, v3
    v_accvgpr_write_b32 a116, v4
    v_accvgpr_write_b32 a117, v5
    v_accvgpr_write_b32 a118, v6
    v_accvgpr_write_b32 a119, v7
    v_accvgpr_write_b32 a0, v8
    v_accvgpr_write_b32 a1, v9
    v_accvgpr_write_b32 a2, v10
    v_accvgpr_write_b32 a3, v11
    v_accvgpr_write_b32 a4, v12
    v_accvgpr_write_b32 a5, v13
    v_accvgpr_write_b32 a6, v14
    v_accvgpr_write_b32 a7, v15
    v_accvgpr_write_b32 a64, v16
    v_accvgpr_write_b32 a65, v17
    v_accvgpr_write_b32 a66, v18
    v_accvgpr_write_b32 a67, v19
    v_accvgpr_write_b32 a68, v20
    v_accvgpr_write_b32 a69, v21
    v_accvgpr_write_b32 a70, v22
    v_accvgpr_write_b32 a71, v23
    v_accvgpr_write_b32 a160, v24
    v_accvgpr_write_b32 a161, v25
    v_accvgpr_write_b32 a162, v26
    v_accvgpr_write_b32 a163, v27
    v_accvgpr_write_b32 a164, v28
    v_accvgpr_write_b32 a165, v29
    v_accvgpr_write_b32 a166, v30
    v_accvgpr_write_b32 a167, v31
RWI_8:
    s_waitcnt vmcnt(0)
    v_readfirstlane_b32 s64, v68
    s_nop 0
    s_cmp_ge_u32 s64, 256
    s_cbranch_scc1 RWO_9
    buffer_load_dword v68, v67, s[12:15], 0 offen offset:128 sc1
    s_sub_u32 s19, s19, 1
    s_cbranch_scc1 REC_FAIL
    s_branch RWI_8
RWO_9:
    s_cmp_ge_u32 s28, 72
    s_cbranch_scc1 NOPUB0_10
    s_cmp_lg_u32 s18, 0
    s_cbranch_scc1 NOPUB0_10
    s_waitcnt vmcnt(0)
    v_cmp_eq_u32 vcc, 0xffbfffbf, v65
    v_mov_b32 v67, 0xffffffff
    s_nop 0
    v_cndmask_b32 v65, v65, v67, vcc
    s_add_u32 s64, s30, s20
    s_mov_b64 exec, s[32:33]
    buffer_store_dword v65, v66, s[4:7], s64 offen sc1
    s_mov_b64 exec, -1
NOPUB0_10:
    s_barrier
    s_cmp_lg_u32 s66, 0
    s_cbranch_scc1 W1sc1_PRE
    s_mov_b32 s58, 0x20e000
CEN_11:
    s_mov_b64 exec, 1
    v_mov_b32 v77, 256
    buffer_load_dword v60, v73, s[12:15], 0 offen sc1
    s_mov_b64 exec, -1
    s_waitcnt vmcnt(0)
    v_readfirstlane_b32 s56, v77
    v_readfirstlane_b32 s57, v60
    s_nop 0
    s_min_u32 s57, s57, 32
    s_cmp_ge_u32 s57, 32
    s_cbranch_scc1 CENF_12
    s_sub_u32 s19, s19, 1
    s_cbranch_scc1 REC_FAIL
    s_cmp_lt_u32 s56, 256
    s_cbranch_scc1 CEN_11
    s_branch W1sc1_PRE
CENF_12:
W1_PRE:
    v_add_u32 v78, 65536, v73
    v_add_u32 v79, 131072, v73
    s_add_u32 s31, s24, 4096
    s_add_u32 s38, s20, 4096
    s_add_u32 s39, s20, 8192
    s_barrier
    s_waitcnt vmcnt(0)
    buffer_load_dwordx4 v[28:31], v73, s[4:7], s38 offen offset:3072 sc1
    buffer_load_dwordx4 v[32:35], v73, s[4:7], s39 offen offset:0 sc1
    ds_read_b128 v[64:67], v73 offset:51200
    ds_read_b128 v[68:71], v73 offset:52224
    v_mov_b32 v36, 0
    v_mov_b32 v37, 0
    v_mov_b32 v38, 0
    v_mov_b32 v39, 0
    v_mov_b32 v40, 0
    v_mov_b32 v41, 0
    v_mov_b32 v42, 0
    v_mov_b32 v43, 0
    v_mov_b32 v44, 0
    v_mov_b32 v45, 0
    v_mov_b32 v46, 0
    v_mov_b32 v47, 0
    v_mov_b32 v48, 0
    v_mov_b32 v49, 0
    v_mov_b32 v50, 0
    v_mov_b32 v51, 0
    buffer_load_dwordx4 v[28:31], v73, s[4:7], s38 offen offset:3072 sc1
    buffer_load_dwordx4 v[32:35], v73, s[4:7], s39 offen offset:0 sc1
W1_CHK1:
    s_waitcnt vmcnt(2)
    v_max3_u32 v24, v28, v29, v30
    v_max_u32 v24, v24, v31
    v_max3_u32 v25, v32, v33, v34
    v_max_u32 v25, v25, v35
    v_cmp_eq_u32 s[48:49], s47, v24
    v_cmp_eq_u32 s[50:51], s47, v25
    s_nop 0
    s_or_b64 s[56:57], s[48:49], s[50:51]
    s_cbranch_scc1 W1_RETRY1
    ds_write_b128 v73, v[28:31] offset:7168
    ds_write_b128 v73, v[32:35] offset:8192
    s_waitcnt lgkmcnt(2)
    v_smfmac_f32_16x16x64_bf16 v[36:39], v[28:31], v[64:71], v72
    v_smfmac_f32_16x16x64_bf16 v[40:43], v[28:31], a[120:127], v72
    ds_read_b128 v[64:67], v73 offset:59392
    ds_read_b128 v[68:71], v73 offset:60416
    v_smfmac_f32_16x16x64_bf16 v[36:39], v[32:35], a[128:135], v72
    v_smfmac_f32_16x16x64_bf16 v[40:43], v[32:35], a[136:143], v72
    s_waitcnt lgkmcnt(2)
    s_barrier
    ds_read_b128 v[0:3], v73 offset:0
    ds_read_b128 v[4:7], v73 offset:1024
    ds_read_b128 v[8:11], v73 offset:2048
    ds_read_b128 v[12:15], v73 offset:3072
    ds_read_b128 v[16:19], v73 offset:4096
    ds_read_b128 v[20:23], v73 offset:5120
    ds_read_b128 v[24:27], v73 offset:6144
    v_smfmac_f32_16x16x64_bf16 v[44:47], v[28:31], v[80:87], v72
    v_smfmac_f32_16x16x64_bf16 v[48:51], v[28:31], v[88:95], v72
    v_smfmac_f32_16x16x64_bf16 v[44:47], v[32:35], v[96:103], v72
    v_smfmac_f32_16x16x64_bf16 v[48:51], v[32:35], v[104:111], v72
    s_waitcnt lgkmcnt(6)
    v_smfmac_f32_16x16x64_bf16 v[36:39], v[0:3], v[64:71], v72
    v_smfmac_f32_16x16x64_bf16 v[40:43], v[0:3], a[8:15], v72
    ds_read_b128 v[64:67], v78 offset:34816
    ds_read_b128 v[68:71], v78 offset:35840
    s_waitcnt lgkmcnt(7)
    v_smfmac_f32_16x16x64_bf16 v[36:39], v[4:7], a[16:23], v72
    buffer_load_dwordx4 v[52:55], v73, s[4:7], s24 offen offset:2048 sc1
    v_smfmac_f32_16x16x64_bf16 v[40:43], v[4:7], a[24:31], v72
    buffer_load_dwordx4 v[56:59], v73, s[4:7], s24 offen offset:3072 sc1
    s_waitcnt lgkmcnt(6)
    v_smfmac_f32_16x16x64_bf16 v[36:39], v[8:11], a[32:39], v72
    buffer_load_dwordx4 v[60:63], v73, s[4:7], s31 offen offset:3072 sc1
    v_smfmac_f32_16x16x64_bf16 v[40:43], v[8:11], a[40:47], v72
    s_waitcnt lgkmcnt(5)
    v_smfmac_f32_16x16x64_bf16 v[36:39], v[12:15], a[48:55], v72
    v_smfmac_f32_16x16x64_bf16 v[40:43], v[12:15], a[56:63], v72
    s_waitcnt lgkmcnt(0)
    v_smfmac_f32_16x16x64_bf16 v[36:39], v[16:19], v[64:71], v72
    v_smfmac_f32_16x16x64_bf16 v[40:43], v[16:19], a[72:79], v72
    ds_read_b128 v[64:67], v78 offset:43008
    ds_read_b128 v[68:71], v78 offset:44032
    v_smfmac_f32_16x16x64_bf16 v[36:39], v[20:23], a[80:87], v72
    v_smfmac_f32_16x16x64_bf16 v[40:43], v[20:23], a[88:95], v72
    v_smfmac_f32_16x16x64_bf16 v[36:39], v[24:27], a[96:103], v72
    v_smfmac_f32_16x16x64_bf16 v[40:43], v[24:27], a[104:111], v72
    s_add_u32 s24, s24, 262144
    v_smfmac_f32_16x16x64_bf16 v[44:47], v[0:3], a[144:151], v72
    v_smfmac_f32_16x16x64_bf16 v[48:51], v[0:3], a[152:159], v72
    s_nop 4
    v_permlane32_swap_b32 v36, v40
    v_permlane32_swap_b32 v37, v41
    v_permlane32_swap_b32 v38, v42
    s_waitcnt lgkmcnt(0)
    v_smfmac_f32_16x16x64_bf16 v[44:47], v[4:7], v[64:71], v72
    v_permlane32_swap_b32 v39, v43
    v_add_f32 v36, v36, v40
    v_add_f32 v37, v37, v41
    v_smfmac_f32_16x16x64_bf16 v[48:51], v[4:7], a[168:175], v72
    v_add_f32 v38, v38, v42
    v_add_f32 v39, v39, v43
    v_cvt_pk_bf16_f32 v36, v36, v37
    v_smfmac_f32_16x16x64_bf16 v[44:47], v[8:11], a[176:183], v72
    v_cvt_pk_bf16_f32 v37, v38, v39
    ds_write_b64 v75, v[36:37] offset:9728
    ds_read_b128 v[64:67], v73 offset:30720
    ds_read_b128 v[68:71], v73 offset:31744
    v_smfmac_f32_16x16x64_bf16 v[48:51], v[8:11], a[184:191], v72
    v_mov_b64 v[38:39], 0
    v_smfmac_f32_16x16x64_bf16 v[44:47], v[12:15], a[192:199], v72
    v_mov_b64 v[40:41], 0
    v_smfmac_f32_16x16x64_bf16 v[48:51], v[12:15], a[200:207], v72
    v_mov_b64 v[42:43], 0
    s_waitcnt lgkmcnt(2)
    s_barrier
    v_smfmac_f32_16x16x64_bf16 v[44:47], v[16:19], a[208:215], v72
    v_mov_b64 v[36:37], 0
    v_smfmac_f32_16x16x64_bf16 v[48:51], v[16:19], a[216:223], v72
    v_smfmac_f32_16x16x64_bf16 v[44:47], v[20:23], a[224:231], v72
    v_smfmac_f32_16x16x64_bf16 v[48:51], v[20:23], a[232:239], v72
    v_smfmac_f32_16x16x64_bf16 v[44:47], v[24:27], a[240:247], v72
    v_smfmac_f32_16x16x64_bf16 v[48:51], v[24:27], a[248:255], v72
    v_smfmac_f32_16x16x64_bf16 v[36:39], v[0:3], v[112:119], v72
    v_smfmac_f32_16x16x64_bf16 v[40:43], v[0:3], v[120:127], v72
    s_nop 5
    v_permlane32_swap_b32 v44, v48
    v_permlane32_swap_b32 v45, v49
    v_permlane32_swap_b32 v46, v50
    v_permlane32_swap_b32 v47, v51
    v_add_f32 v44, v44, v48
    v_add_f32 v45, v45, v49
    v_add_f32 v46, v46, v50
    v_add_f32 v47, v47, v51
    v_cvt_pk_bf16_f32 v44, v44, v45
    v_cvt_pk_bf16_f32 v45, v46, v47
    ds_write_b64 v75, v[44:45] offset:11776
    v_mov_b64 v[48:49], 0
    v_mov_b64 v[50:51], 0
    v_smfmac_f32_16x16x64_bf16 v[36:39], v[4:7], v[128:135], v72
    s_waitcnt lgkmcnt(1)
    v_smfmac_f32_16x16x64_bf16 v[48:51], v[0:3], v[64:71], v72
    v_smfmac_f32_16x16x64_bf16 v[40:43], v[4:7], v[136:143], v72
    s_waitcnt lgkmcnt(0)
    s_barrier
    ds_read_b128 v[64:67], v73 offset:47104
    ds_read_b128 v[68:71], v73 offset:48128
    v_smfmac_f32_16x16x64_bf16 v[36:39], v[8:11], v[144:151], v72
    v_smfmac_f32_16x16x64_bf16 v[40:43], v[8:11], v[152:159], v72
    v_smfmac_f32_16x16x64_bf16 v[36:39], v[12:15], v[160:167], v72
    s_waitcnt lgkmcnt(0)
    v_smfmac_f32_16x16x64_bf16 v[48:51], v[4:7], v[64:71], v72
    v_smfmac_f32_16x16x64_bf16 v[40:43], v[12:15], v[168:175], v72
    ds_read_b128 v[64:67], v73 offset:63488
    ds_read_b128 v[68:71], v73 offset:64512
    ds_read_b128 v[0:3], v78 offset:14336
    ds_read_b128 v[4:7], v78 offset:15360
    v_smfmac_f32_16x16x64_bf16 v[36:39], v[16:19], v[176:183], v72
    v_smfmac_f32_16x16x64_bf16 v[40:43], v[16:19], v[184:191], v72
    v_smfmac_f32_16x16x64_bf16 v[36:39], v[20:23], v[192:199], v72
    s_waitcnt lgkmcnt(2)
    v_smfmac_f32_16x16x64_bf16 v[48:51], v[8:11], v[64:71], v72
    s_waitcnt lgkmcnt(0)
    v_smfmac_f32_16x16x64_bf16 v[48:51], v[12:15], v[0:7], v72
    v_smfmac_f32_16x16x64_bf16 v[40:43], v[20:23], v[200:207], v72
    ds_read_b128 v[64:67], v78 offset:30720
    ds_read_b128 v[68:71], v78 offset:31744
    ds_read_b128 v[0:3], v78 offset:47104
    ds_read_b128 v[4:7], v78 offset:48128
    ds_read_b128 v[8:11], v78 offset:63488
    ds_read_b128 v[12:15], v78 offset:64512
    v_smfmac_f32_16x16x64_bf16 v[36:39], v[24:27], v[208:215], v72
    v_smfmac_f32_16x16x64_bf16 v[40:43], v[24:27], v[216:223], v72
    v_smfmac_f32_16x16x64_bf16 v[36:39], v[28:31], v[224:231], v72
    s_waitcnt lgkmcnt(4)
    v_smfmac_f32_16x16x64_bf16 v[48:51], v[16:19], v[64:71], v72
    s_waitcnt lgkmcnt(2)
    v_smfmac_f32_16x16x64_bf16 v[48:51], v[20:23], v[0:7], v72
    ds_read_b128 v[64:67], v79 offset:14336
    ds_read_b128 v[68:71], v79 offset:15360
    s_waitcnt lgkmcnt(2)
    v_smfmac_f32_16x16x64_bf16 v[48:51], v[24:27], v[8:15], v72
    ds_read_b128 v[0:3], v79 offset:22528
    ds_read_b128 v[4:7], v79 offset:23552
    v_smfmac_f32_16x16x64_bf16 v[40:43], v[28:31], v[232:239], v72
    v_smfmac_f32_16x16x64_bf16 v[36:39], v[32:35], v[240:247], v72
    v_smfmac_f32_16x16x64_bf16 v[40:43], v[32:35], v[248:255], v72
    s_waitcnt lgkmcnt(2)
    v_smfmac_f32_16x16x64_bf16 v[48:51], v[28:31], v[64:71], v72
    s_waitcnt lgkmcnt(0)
    v_smfmac_f32_16x16x64_bf16 v[48:51], v[32:35], v[0:7], v72
    ds_read_b128 v[8:11], v73 offset:18432
    ds_read_b128 v[12:15], v73 offset:19456
    ds_read_b128 v[16:19], v73 offset:26624
    ds_read_b128 v[20:23], v73 offset:27648
    v_cvt_pk_bf16_f32 v36, v36, v37
    v_cvt_pk_bf16_f32 v37, v38, v39
    v_cvt_pk_bf16_f32 v40, v40, v41
    v_cvt_pk_bf16_f32 v41, v42, v43
    v_cvt_pk_bf16_f32 v48, v48, v49
    v_cvt_pk_bf16_f32 v49, v50, v51
    ds_read_b128 v[24:27], v73 offset:34816
    ds_read_b128 v[28:31], v73 offset:35840
    ds_read_b128 v[64:67], v73 offset:43008
    ds_read_b128 v[68:71], v73 offset:44032
    v_lshrrev_b32 v77, 1, v76
    s_waitcnt vmcnt(0)
    s_barrier
    ds_read_b128 v[44:47], v76 offset:11264
    ds_read_b64 v[38:39], v77 offset:11776
    s_waitcnt lgkmcnt(1)
    v_mfma_f32_16x16x32_bf16 v[0:3], v[52:55], v[44:47], 0
    v_mfma_f32_16x16x32_bf16 v[4:7], v[56:59], v[44:47], 0
    v_mfma_f32_16x16x32_bf16 v[32:35], v[60:63], v[44:47], 0
    s_waitcnt lgkmcnt(0)
    s_nop 2
    v_mfma_f32_16x16x16_bf16 v[0:3], v[36:37], v[38:39], v[0:3]
    s_nop 2
    v_mfma_f32_16x16x16_bf16 v[4:7], v[40:41], v[38:39], v[4:7]
    s_nop 2
    v_mfma_f32_16x16x16_bf16 v[32:35], v[48:49], v[38:39], v[32:35]
    s_nop 5
    v_cvt_pk_bf16_f32 v0, v0, v1
    v_cvt_pk_bf16_f32 v1, v2, v3
    s_nop 4
    v_cvt_pk_bf16_f32 v2, v4, v5
    v_cvt_pk_bf16_f32 v3, v6, v7
    ds_write_b128 v76, v[0:3] offset:9728
    s_nop 2
    v_cvt_pk_bf16_f32 v32, v32, v33
    v_cvt_pk_bf16_f32 v33, v34, v35
    ds_write_b64 v76, v[32:33] offset:10760
    v_mov_b64 v[4:5], 0
    v_mov_b64 v[6:7], 0
    v_mov_b64 v[60:61], 0
    v_mov_b64 v[62:63], 0
    s_mul_i32 s27, s16, 9344
    s_add_u32 s27, s27, s46
    s_add_u32 s31, s27, 4096
    s_add_u32 s38, s27, 7168
    s_waitcnt lgkmcnt(0)
    s_barrier
    ds_read_b128 v[36:39], v76 offset:9216
    ds_read_b128 v[40:43], v76 offset:9728
    ds_read_b128 v[44:47], v76 offset:10240
    ds_read_b128 v[48:51], v76 offset:10752
    ds_read_b128 v[52:55], v78 offset:2048
    ds_read_b128 v[56:59], v78 offset:3072
    v_mov_b64 v[0:1], 0
    v_mov_b64 v[2:3], 0
    v_mov_b64 v[32:33], 0
    v_mov_b64 v[34:35], 0
    s_waitcnt lgkmcnt(5)
    v_smfmac_f32_16x16x64_bf16 v[0:3], v[36:39], v[8:15], v72
    s_waitcnt lgkmcnt(4)
    v_smfmac_f32_16x16x64_bf16 v[0:3], v[40:43], v[16:23], v72
    ds_read_b128 v[8:11], v78 offset:10240
    ds_read_b128 v[12:15], v78 offset:11264
    s_waitcnt lgkmcnt(5)
    v_smfmac_f32_16x16x64_bf16 v[0:3], v[44:47], v[24:31], v72
    ds_read_b128 v[16:19], v78 offset:18432
    ds_read_b128 v[20:23], v78 offset:19456
    s_waitcnt lgkmcnt(6)
    v_smfmac_f32_16x16x64_bf16 v[0:3], v[48:51], v[64:71], v72
    ds_read_b128 v[24:27], v78 offset:26624
    ds_read_b128 v[28:31], v78 offset:27648
    v_smfmac_f32_16x16x64_bf16 v[4:7], v[36:39], a[112:119], v72
    ds_read_b128 v[64:67], v78 offset:51200
    ds_read_b128 v[68:71], v78 offset:52224
    v_smfmac_f32_16x16x64_bf16 v[4:7], v[40:43], a[0:7], v72
    s_waitcnt lgkmcnt(8)
    v_smfmac_f32_16x16x64_bf16 v[4:7], v[44:47], v[52:59], v72
    v_cvt_pk_bf16_f32 v0, v0, v1
    v_cvt_pk_bf16_f32 v1, v2, v3
    s_waitcnt lgkmcnt(6)
    v_smfmac_f32_16x16x64_bf16 v[4:7], v[48:51], v[8:15], v72
    ds_read_b128 v[52:55], v78 offset:59392
    ds_read_b128 v[56:59], v78 offset:60416
    v_and_or_b32 v0, v0, -2, s90
    buffer_store_dwordx2 v[0:1], v75, s[4:7], s27 offen offset:512
    s_waitcnt lgkmcnt(6)
    v_smfmac_f32_16x16x64_bf16 v[32:35], v[36:39], v[16:23], v72
    ds_read_b128 v[8:11], v79 offset:2048
    ds_read_b128 v[12:15], v79 offset:3072
    s_waitcnt lgkmcnt(6)
    v_smfmac_f32_16x16x64_bf16 v[32:35], v[40:43], v[24:31], v72
    ds_read_b128 v[16:19], v79 offset:10240
    ds_read_b128 v[20:23], v79 offset:11264
    v_smfmac_f32_16x16x64_bf16 v[32:35], v[44:47], a[64:71], v72
    v_cvt_pk_bf16_f32 v4, v4, v5
    v_cvt_pk_bf16_f32 v5, v6, v7
    v_smfmac_f32_16x16x64_bf16 v[32:35], v[48:51], a[160:167], v72
    v_and_or_b32 v4, v4, -2, s90
    buffer_store_dwordx2 v[4:5], v75, s[4:7], s27 offen offset:2560
    s_waitcnt lgkmcnt(6)
    v_smfmac_f32_16x16x64_bf16 v[60:63], v[36:39], v[64:71], v72
    s_waitcnt lgkmcnt(4)
    v_smfmac_f32_16x16x64_bf16 v[60:63], v[40:43], v[52:59], v72
    s_waitcnt lgkmcnt(2)
    v_smfmac_f32_16x16x64_bf16 v[60:63], v[44:47], v[8:15], v72
    v_cvt_pk_bf16_f32 v32, v32, v33
    v_cvt_pk_bf16_f32 v33, v34, v35
    s_waitcnt lgkmcnt(0)
    v_smfmac_f32_16x16x64_bf16 v[60:63], v[48:51], v[16:23], v72
    v_and_or_b32 v32, v32, -2, s90
    buffer_store_dwordx2 v[32:33], v75, s[4:7], s31 offen offset:512
    s_nop 5
    v_cvt_pk_bf16_f32 v60, v60, v61
    v_cvt_pk_bf16_f32 v61, v62, v63
    v_and_or_b32 v60, v60, -2, s90
    buffer_store_dwordx2 v[60:61], v75, s[4:7], s31 offen offset:2560
    s_add_u32 s40, s20, 16384
    s_cmp_eq_u32 s40, 0x110000
    s_cselect_b32 s40, 0x100000, s40
    v_lshrrev_b32 v77, 7, v73
    v_mul_u32_u24 v77, 9344, v77
    v_and_b32 v37, 0x70, v73
    v_add_u32 v36, v77, v37
    s_add_u32 s29, s30, s46
    s_add_u32 s31, s29, 74752
    s_add_u32 s38, s29, 149504
    s_add_u32 s39, s29, 224256
    s_waitcnt vmcnt(0)
    buffer_load_dwordx4 v[16:19], v36, s[4:7], s29 offen sc1
    buffer_load_dwordx4 v[20:23], v36, s[4:7], s31 offen sc1
    buffer_load_dwordx4 v[24:27], v36, s[4:7], s38 offen sc1
    buffer_load_dwordx4 v[28:31], v36, s[4:7], s39 offen sc1
    v_bfe_u32 v77, v73, 4, 4
    v_and_b32 v78, 1, v77
    v_lshlrev_b32 v78, 4, v78
    v_mov_b32 v79, 0x3f80
    v_lshlrev_b32 v78, v78, v79
    v_lshrrev_b32 v77, 1, v77
    v_cmp_eq_u32 vcc, 0, v77
    s_nop 1
    v_cndmask_b32 v32, 0, v78, vcc
    v_cmp_eq_u32 vcc, 1, v77
    s_nop 1
    v_cndmask_b32 v33, 0, v78, vcc
    v_cmp_eq_u32 vcc, 2, v77
    s_nop 1
    v_cndmask_b32 v34, 0, v78, vcc
    v_cmp_eq_u32 vcc, 3, v77
    s_nop 1
    v_cndmask_b32 v35, 0, v78, vcc
    v_bfe_u32 v79, v73, 8, 1
    v_lshl_add_u32 v37, v79, 3, v37
    v_bfe_u32 v79, v73, 9, 1
    v_lshl_add_u32 v37, v79, 2, v37
    s_add_u32 s58, s40, s30
    s_add_u32 s100, s20, s30
    v_mov_b32 v8, 0xffbfffbf
    buffer_load_dwordx4 v[16:19], v36, s[4:7], s29 offen sc1
    buffer_load_dwordx4 v[20:23], v36, s[4:7], s31 offen sc1
    buffer_load_dwordx4 v[24:27], v36, s[4:7], s38 offen sc1
    buffer_load_dwordx4 v[28:31], v36, s[4:7], s39 offen sc1
    s_branch W1_RED1A
W1_REDA:
    v_and_b32 v44, 1, v44
    v_cmp_ne_u32 s[48:49], 0, v44
    v_and_b32 v45, 1, v45
    v_cmp_ne_u32 s[50:51], 0, v45
    v_and_b32 v46, 1, v46
    v_cmp_ne_u32 s[52:53], 0, v46
    v_and_b32 v47, 1, v47
    v_cmp_ne_u32 s[54:55], 0, v47
    s_mov_b64 exec, s[48:49]
    buffer_load_dwordx4 v[16:19], v36, s[4:7], s29 offen sc1
    s_mov_b64 exec, s[50:51]
    buffer_load_dwordx4 v[20:23], v36, s[4:7], s31 offen sc1
    s_mov_b64 exec, s[52:53]
    buffer_load_dwordx4 v[24:27], v36, s[4:7], s38 offen sc1
    s_mov_b64 exec, s[54:55]
    buffer_load_dwordx4 v[28:31], v36, s[4:7], s39 offen sc1
    s_mov_b64 exec, -1
    s_sub_u32 s19, s19, 1
    s_cbranch_scc1 REC_FAIL
W1_RED1A:
    s_waitcnt vmcnt(4)
    v_bitop3_b32 v44, v16, v18, s90 bitop3:0x7e
    v_bitop3_b32 v45, v20, v22, s90 bitop3:0x7e
    v_bitop3_b32 v46, v24, v26, s90 bitop3:0x7e
    v_bitop3_b32 v47, v28, v30, s90 bitop3:0x7e
    v_or3_b32 v48, v44, v45, v46
    v_or_b32 v48, v48, v47
    v_and_b32 v48, 1, v48
    v_cmp_ne_u32 vcc, 0, v48
    v_mfma_f32_16x16x32_bf16 v[40:43], v[16:19], v[32:35], 0
    s_cbranch_vccnz W1_REDA
    v_mfma_f32_16x16x32_bf16 v[40:43], v[20:23], v[32:35], v[40:43]
    v_mfma_f32_16x16x32_bf16 v[40:43], v[24:27], v[32:35], v[40:43]
    v_mfma_f32_16x16x32_bf16 v[40:43], v[28:31], v[32:35], v[40:43]
    s_nop 7
    v_permlane32_swap_b32 v40, v42
    v_permlane32_swap_b32 v41, v43
    v_pk_add_f32 v[40:41], v[40:41], v[42:43]
    v_cvt_pk_bf16_f32 v40, v40, v41
    s_mov_b64 exec, s[32:33]
    buffer_store_dword v40, v37, s[4:7], s58 offen
    buffer_store_dword v8, v37, s[4:7], s100 offen
    s_cmp_lt_u32 s18, 62
    s_cbranch_scc1 NOH_13
    s_add_u32 s59, s30, 0x19dc00
    buffer_store_dword v40, v37, s[4:7], s59 offen sc1
NOH_13:
    s_mov_b64 exec, -1
W1_NORED:
    s_mov_b32 s20, s40
    s_xor_b32 s46, s46, 0x80000
    s_and_b32 s31, s18, 1
    s_xor_b32 s90, s90, s31
    s_add_u32 s18, s18, 1
    s_cmp_lt_u32 s18, s67
    s_cbranch_scc1 W1_PRE
    s_branch REC_EXIT
W1_RETRY1:
    s_mov_b64 exec, s[48:49]
    buffer_load_dwordx4 v[28:31], v73, s[4:7], s38 offen offset:3072 sc1
    s_mov_b64 exec, s[50:51]
    buffer_load_dwordx4 v[32:35], v73, s[4:7], s39 offen offset:0 sc1
    s_mov_b64 exec, -1
    s_sub_u32 s19, s19, 1
    s_cbranch_scc1 REC_FAIL
    s_branch W1_CHK1
W1sc1_PRE:
    v_add_u32 v78, 65536, v73
    v_add_u32 v79, 131072, v73
    s_add_u32 s31, s24, 4096
    s_add_u32 s38, s20, 4096
    s_add_u32 s39, s20, 8192
    s_barrier
    s_waitcnt vmcnt(0)
    buffer_load_dwordx4 v[28:31], v73, s[4:7], s38 offen offset:3072 sc1
    buffer_load_dwordx4 v[32:35], v73, s[4:7], s39 offen offset:0 sc1
    ds_read_b128 v[64:67], v73 offset:51200
    ds_read_b128 v[68:71], v73 offset:52224
    v_mov_b32 v36, 0
    v_mov_b32 v37, 0
    v_mov_b32 v38, 0
    v_mov_b32 v39, 0
    v_mov_b32 v40, 0
    v_mov_b32 v41, 0
    v_mov_b32 v42, 0
    v_mov_b32 v43, 0
    v_mov_b32 v44, 0
    v_mov_b32 v45, 0
    v_mov_b32 v46, 0
    v_mov_b32 v47, 0
    v_mov_b32 v48, 0
    v_mov_b32 v49, 0
    v_mov_b32 v50, 0
    v_mov_b32 v51, 0
    buffer_load_dwordx4 v[28:31], v73, s[4:7], s38 offen offset:3072 sc1
    buffer_load_dwordx4 v[32:35], v73, s[4:7], s39 offen offset:0 sc1
W1sc1_CHK1:
    s_waitcnt vmcnt(2)
    v_max3_u32 v24, v28, v29, v30
    v_max_u32 v24, v24, v31
    v_max3_u32 v25, v32, v33, v34
    v_max_u32 v25, v25, v35
    v_cmp_eq_u32 s[48:49], s47, v24
    v_cmp_eq_u32 s[50:51], s47, v25
    s_nop 0
    s_or_b64 s[56:57], s[48:49], s[50:51]
    s_cbranch_scc1 W1sc1_RETRY1
    ds_write_b128 v73, v[28:31] offset:7168
    ds_write_b128 v73, v[32:35] offset:8192
    s_waitcnt lgkmcnt(2)
    v_smfmac_f32_16x16x64_bf16 v[36:39], v[28:31], v[64:71], v72
    v_smfmac_f32_16x16x64_bf16 v[40:43], v[28:31], a[120:127], v72
    ds_read_b128 v[64:67], v73 offset:59392
    ds_read_b128 v[68:71], v73 offset:60416
    v_smfmac_f32_16x16x64_bf16 v[36:39], v[32:35], a[128:135], v72
    v_smfmac_f32_16x16x64_bf16 v[40:43], v[32:35], a[136:143], v72
    s_waitcnt lgkmcnt(2)
    s_barrier
    ds_read_b128 v[0:3], v73 offset:0
    ds_read_b128 v[4:7], v73 offset:1024
    ds_read_b128 v[8:11], v73 offset:2048
    ds_read_b128 v[12:15], v73 offset:3072
    ds_read_b128 v[16:19], v73 offset:4096
    ds_read_b128 v[20:23], v73 offset:5120
    ds_read_b128 v[24:27], v73 offset:6144
    v_smfmac_f32_16x16x64_bf16 v[44:47], v[28:31], v[80:87], v72
    v_smfmac_f32_16x16x64_bf16 v[48:51], v[28:31], v[88:95], v72
    v_smfmac_f32_16x16x64_bf16 v[44:47], v[32:35], v[96:103], v72
    v_smfmac_f32_16x16x64_bf16 v[48:51], v[32:35], v[104:111], v72
    s_waitcnt lgkmcnt(6)
    v_smfmac_f32_16x16x64_bf16 v[36:39], v[0:3], v[64:71], v72
    v_smfmac_f32_16x16x64_bf16 v[40:43], v[0:3], a[8:15], v72
    ds_read_b128 v[64:67], v78 offset:34816
    ds_read_b128 v[68:71], v78 offset:35840
    s_waitcnt lgkmcnt(7)
    v_smfmac_f32_16x16x64_bf16 v[36:39], v[4:7], a[16:23], v72
    buffer_load_dwordx4 v[52:55], v73, s[4:7], s24 offen offset:2048 sc1
    v_smfmac_f32_16x16x64_bf16 v[40:43], v[4:7], a[24:31], v72
    buffer_load_dwordx4 v[56:59], v73, s[4:7], s24 offen offset:3072 sc1
    s_waitcnt lgkmcnt(6)
    v_smfmac_f32_16x16x64_bf16 v[36:39], v[8:11], a[32:39], v72
    buffer_load_dwordx4 v[60:63], v73, s[4:7], s31 offen offset:3072 sc1
    v_smfmac_f32_16x16x64_bf16 v[40:43], v[8:11], a[40:47], v72
    s_waitcnt lgkmcnt(5)
    v_smfmac_f32_16x16x64_bf16 v[36:39], v[12:15], a[48:55], v72
    v_smfmac_f32_16x16x64_bf16 v[40:43], v[12:15], a[56:63], v72
    s_waitcnt lgkmcnt(0)
    v_smfmac_f32_16x16x64_bf16 v[36:39], v[16:19], v[64:71], v72
    v_smfmac_f32_16x16x64_bf16 v[40:43], v[16:19], a[72:79], v72
    ds_read_b128 v[64:67], v78 offset:43008
    ds_read_b128 v[68:71], v78 offset:44032
    v_smfmac_f32_16x16x64_bf16 v[36:39], v[20:23], a[80:87], v72
    v_smfmac_f32_16x16x64_bf16 v[40:43], v[20:23], a[88:95], v72
    v_smfmac_f32_16x16x64_bf16 v[36:39], v[24:27], a[96:103], v72
    v_smfmac_f32_16x16x64_bf16 v[40:43], v[24:27], a[104:111], v72
    s_add_u32 s24, s24, 262144
    v_smfmac_f32_16x16x64_bf16 v[44:47], v[0:3], a[144:151], v72
    v_smfmac_f32_16x16x64_bf16 v[48:51], v[0:3], a[152:159], v72
    s_nop 4
    v_permlane32_swap_b32 v36, v40
    v_permlane32_swap_b32 v37, v41
    v_permlane32_swap_b32 v38, v42
    s_waitcnt lgkmcnt(0)
    v_smfmac_f32_16x16x64_bf16 v[44:47], v[4:7], v[64:71], v72
    v_permlane32_swap_b32 v39, v43
    v_add_f32 v36, v36, v40
    v_add_f32 v37, v37, v41
    v_smfmac_f32_16x16x64_bf16 v[48:51], v[4:7], a[168:175], v72
    v_add_f32 v38, v38, v42
    v_add_f32 v39, v39, v43
    v_cvt_pk_bf16_f32 v36, v36, v37
    v_smfmac_f32_16x16x64_bf16 v[44:47], v[8:11], a[176:183], v72
    v_cvt_pk_bf16_f32 v37, v38, v39
    ds_write_b64 v75, v[36:37] offset:9728
    ds_read_b128 v[64:67], v73 offset:30720
    ds_read_b128 v[68:71], v73 offset:31744
    v_smfmac_f32_16x16x64_bf16 v[48:51], v[8:11], a[184:191], v72
    v_mov_b64 v[38:39], 0
    v_smfmac_f32_16x16x64_bf16 v[44:47], v[12:15], a[192:199], v72
    v_mov_b64 v[40:41], 0
    v_smfmac_f32_16x16x64_bf16 v[48:51], v[12:15], a[200:207], v72
    v_mov_b64 v[42:43], 0
    s_waitcnt lgkmcnt(2)
    s_barrier
    v_smfmac_f32_16x16x64_bf16 v[44:47], v[16:19], a[208:215], v72
    v_mov_b64 v[36:37], 0
    v_smfmac_f32_16x16x64_bf16 v[48:51], v[16:19], a[216:223], v72
    v_smfmac_f32_16x16x64_bf16 v[44:47], v[20:23], a[224:231], v72
    v_smfmac_f32_16x16x64_bf16 v[48:51], v[20:23], a[232:239], v72
    v_smfmac_f32_16x16x64_bf16 v[44:47], v[24:27], a[240:247], v72
    v_smfmac_f32_16x16x64_bf16 v[48:51], v[24:27], a[248:255], v72
    v_smfmac_f32_16x16x64_bf16 v[36:39], v[0:3], v[112:119], v72
    v_smfmac_f32_16x16x64_bf16 v[40:43], v[0:3], v[120:127], v72
    s_nop 5
    v_permlane32_swap_b32 v44, v48
    v_permlane32_swap_b32 v45, v49
    v_permlane32_swap_b32 v46, v50
    v_permlane32_swap_b32 v47, v51
    v_add_f32 v44, v44, v48
    v_add_f32 v45, v45, v49
    v_add_f32 v46, v46, v50
    v_add_f32 v47, v47, v51
    v_cvt_pk_bf16_f32 v44, v44, v45
    v_cvt_pk_bf16_f32 v45, v46, v47
    ds_write_b64 v75, v[44:45] offset:11776
    v_mov_b64 v[48:49], 0
    v_mov_b64 v[50:51], 0
    v_smfmac_f32_16x16x64_bf16 v[36:39], v[4:7], v[128:135], v72
    s_waitcnt lgkmcnt(1)
    v_smfmac_f32_16x16x64_bf16 v[48:51], v[0:3], v[64:71], v72
    v_smfmac_f32_16x16x64_bf16 v[40:43], v[4:7], v[136:143], v72
    s_waitcnt lgkmcnt(0)
    s_barrier
    ds_read_b128 v[64:67], v73 offset:47104
    ds_read_b128 v[68:71], v73 offset:48128
    v_smfmac_f32_16x16x64_bf16 v[36:39], v[8:11], v[144:151], v72
    v_smfmac_f32_16x16x64_bf16 v[40:43], v[8:11], v[152:159], v72
    v_smfmac_f32_16x16x64_bf16 v[36:39], v[12:15], v[160:167], v72
    s_waitcnt lgkmcnt(0)
    v_smfmac_f32_16x16x64_bf16 v[48:51], v[4:7], v[64:71], v72
    v_smfmac_f32_16x16x64_bf16 v[40:43], v[12:15], v[168:175], v72
    ds_read_b128 v[64:67], v73 offset:63488
    ds_read_b128 v[68:71], v73 offset:64512
    ds_read_b128 v[0:3], v78 offset:14336
    ds_read_b128 v[4:7], v78 offset:15360
    v_smfmac_f32_16x16x64_bf16 v[36:39], v[16:19], v[176:183], v72
    v_smfmac_f32_16x16x64_bf16 v[40:43], v[16:19], v[184:191], v72
    v_smfmac_f32_16x16x64_bf16 v[36:39], v[20:23], v[192:199], v72
    s_waitcnt lgkmcnt(2)
    v_smfmac_f32_16x16x64_bf16 v[48:51], v[8:11], v[64:71], v72
    s_waitcnt lgkmcnt(0)
    v_smfmac_f32_16x16x64_bf16 v[48:51], v[12:15], v[0:7], v72
    v_smfmac_f32_16x16x64_bf16 v[40:43], v[20:23], v[200:207], v72
    ds_read_b128 v[64:67], v78 offset:30720
    ds_read_b128 v[68:71], v78 offset:31744
    ds_read_b128 v[0:3], v78 offset:47104
    ds_read_b128 v[4:7], v78 offset:48128
    ds_read_b128 v[8:11], v78 offset:63488
    ds_read_b128 v[12:15], v78 offset:64512
    v_smfmac_f32_16x16x64_bf16 v[36:39], v[24:27], v[208:215], v72
    v_smfmac_f32_16x16x64_bf16 v[40:43], v[24:27], v[216:223], v72
    v_smfmac_f32_16x16x64_bf16 v[36:39], v[28:31], v[224:231], v72
    s_waitcnt lgkmcnt(4)
    v_smfmac_f32_16x16x64_bf16 v[48:51], v[16:19], v[64:71], v72
    s_waitcnt lgkmcnt(2)
    v_smfmac_f32_16x16x64_bf16 v[48:51], v[20:23], v[0:7], v72
    ds_read_b128 v[64:67], v79 offset:14336
    ds_read_b128 v[68:71], v79 offset:15360
    s_waitcnt lgkmcnt(2)
    v_smfmac_f32_16x16x64_bf16 v[48:51], v[24:27], v[8:15], v72
    ds_read_b128 v[0:3], v79 offset:22528
    ds_read_b128 v[4:7], v79 offset:23552
    v_smfmac_f32_16x16x64_bf16 v[40:43], v[28:31], v[232:239], v72
    v_smfmac_f32_16x16x64_bf16 v[36:39], v[32:35], v[240:247], v72
    v_smfmac_f32_16x16x64_bf16 v[40:43], v[32:35], v[248:255], v72
    s_waitcnt lgkmcnt(2)
    v_smfmac_f32_16x16x64_bf16 v[48:51], v[28:31], v[64:71], v72
    s_waitcnt lgkmcnt(0)
    v_smfmac_f32_16x16x64_bf16 v[48:51], v[32:35], v[0:7], v72
    ds_read_b128 v[8:11], v73 offset:18432
    ds_read_b128 v[12:15], v73 offset:19456
    ds_read_b128 v[16:19], v73 offset:26624
    ds_read_b128 v[20:23], v73 offset:27648
    v_cvt_pk_bf16_f32 v36, v36, v37
    v_cvt_pk_bf16_f32 v37, v38, v39
    v_cvt_pk_bf16_f32 v40, v40, v41
    v_cvt_pk_bf16_f32 v41, v42, v43
    v_cvt_pk_bf16_f32 v48, v48, v49
    v_cvt_pk_bf16_f32 v49, v50, v51
    ds_read_b128 v[24:27], v73 offset:34816
    ds_read_b128 v[28:31], v73 offset:35840
    ds_read_b128 v[64:67], v73 offset:43008
    ds_read_b128 v[68:71], v73 offset:44032
    v_lshrrev_b32 v77, 1, v76
    s_waitcnt vmcnt(0)
    s_barrier
    ds_read_b128 v[44:47], v76 offset:11264
    ds_read_b64 v[38:39], v77 offset:11776
    s_waitcnt lgkmcnt(1)
    v_mfma_f32_16x16x32_bf16 v[0:3], v[52:55], v[44:47], 0
    v_mfma_f32_16x16x32_bf16 v[4:7], v[56:59], v[44:47], 0
    v_mfma_f32_16x16x32_bf16 v[32:35], v[60:63], v[44:47], 0
    s_waitcnt lgkmcnt(0)
    s_nop 2
    v_mfma_f32_16x16x16_bf16 v[0:3], v[36:37], v[38:39], v[0:3]
    s_nop 2
    v_mfma_f32_16x16x16_bf16 v[4:7], v[40:41], v[38:39], v[4:7]
    s_nop 2
    v_mfma_f32_16x16x16_bf16 v[32:35], v[48:49], v[38:39], v[32:35]
    s_nop 5
    v_cvt_pk_bf16_f32 v0, v0, v1
    v_cvt_pk_bf16_f32 v1, v2, v3
    s_nop 4
    v_cvt_pk_bf16_f32 v2, v4, v5
    v_cvt_pk_bf16_f32 v3, v6, v7
    ds_write_b128 v76, v[0:3] offset:9728
    s_nop 2
    v_cvt_pk_bf16_f32 v32, v32, v33
    v_cvt_pk_bf16_f32 v33, v34, v35
    ds_write_b64 v76, v[32:33] offset:10760
    v_mov_b64 v[4:5], 0
    v_mov_b64 v[6:7], 0
    v_mov_b64 v[60:61], 0
    v_mov_b64 v[62:63], 0
    s_mul_i32 s27, s16, 9344
    s_add_u32 s27, s27, s46
    s_add_u32 s31, s27, 4096
    s_add_u32 s38, s27, 7168
    s_waitcnt lgkmcnt(0)
    s_barrier
    ds_read_b128 v[36:39], v76 offset:9216
    ds_read_b128 v[40:43], v76 offset:9728
    ds_read_b128 v[44:47], v76 offset:10240
    ds_read_b128 v[48:51], v76 offset:10752
    ds_read_b128 v[52:55], v78 offset:2048
    ds_read_b128 v[56:59], v78 offset:3072
    v_mov_b64 v[0:1], 0
    v_mov_b64 v[2:3], 0
    v_mov_b64 v[32:33], 0
    v_mov_b64 v[34:35], 0
    s_waitcnt lgkmcnt(5)
    v_smfmac_f32_16x16x64_bf16 v[0:3], v[36:39], v[8:15], v72
    s_waitcnt lgkmcnt(4)
    v_smfmac_f32_16x16x64_bf16 v[0:3], v[40:43], v[16:23], v72
    ds_read_b128 v[8:11], v78 offset:10240
    ds_read_b128 v[12:15], v78 offset:11264
    s_waitcnt lgkmcnt(5)
    v_smfmac_f32_16x16x64_bf16 v[0:3], v[44:47], v[24:31], v72
    ds_read_b128 v[16:19], v78 offset:18432
    ds_read_b128 v[20:23], v78 offset:19456
    s_waitcnt lgkmcnt(6)
    v_smfmac_f32_16x16x64_bf16 v[0:3], v[48:51], v[64:71], v72
    ds_read_b128 v[24:27], v78 offset:26624
    ds_read_b128 v[28:31], v78 offset:27648
    v_smfmac_f32_16x16x64_bf16 v[4:7], v[36:39], a[112:119], v72
    ds_read_b128 v[64:67], v78 offset:51200
    ds_read_b128 v[68:71], v78 offset:52224
    v_smfmac_f32_16x16x64_bf16 v[4:7], v[40:43], a[0:7], v72
    s_waitcnt lgkmcnt(8)
    v_smfmac_f32_16x16x64_bf16 v[4:7], v[44:47], v[52:59], v72
    v_cvt_pk_bf16_f32 v0, v0, v1
    v_cvt_pk_bf16_f32 v1, v2, v3
    s_waitcnt lgkmcnt(6)
    v_smfmac_f32_16x16x64_bf16 v[4:7], v[48:51], v[8:15], v72
    ds_read_b128 v[52:55], v78 offset:59392
    ds_read_b128 v[56:59], v78 offset:60416
    v_and_or_b32 v0, v0, -2, s90
    buffer_store_dwordx2 v[0:1], v75, s[4:7], s27 offen offset:512 sc1
    s_waitcnt lgkmcnt(6)
    v_smfmac_f32_16x16x64_bf16 v[32:35], v[36:39], v[16:23], v72
    ds_read_b128 v[8:11], v79 offset:2048
    ds_read_b128 v[12:15], v79 offset:3072
    s_waitcnt lgkmcnt(6)
    v_smfmac_f32_16x16x64_bf16 v[32:35], v[40:43], v[24:31], v72
    ds_read_b128 v[16:19], v79 offset:10240
    ds_read_b128 v[20:23], v79 offset:11264
    v_smfmac_f32_16x16x64_bf16 v[32:35], v[44:47], a[64:71], v72
    v_cvt_pk_bf16_f32 v4, v4, v5
    v_cvt_pk_bf16_f32 v5, v6, v7
    v_smfmac_f32_16x16x64_bf16 v[32:35], v[48:51], a[160:167], v72
    v_and_or_b32 v4, v4, -2, s90
    buffer_store_dwordx2 v[4:5], v75, s[4:7], s27 offen offset:2560 sc1
    s_waitcnt lgkmcnt(6)
    v_smfmac_f32_16x16x64_bf16 v[60:63], v[36:39], v[64:71], v72
    s_waitcnt lgkmcnt(4)
    v_smfmac_f32_16x16x64_bf16 v[60:63], v[40:43], v[52:59], v72
    s_waitcnt lgkmcnt(2)
    v_smfmac_f32_16x16x64_bf16 v[60:63], v[44:47], v[8:15], v72
    v_cvt_pk_bf16_f32 v32, v32, v33
    v_cvt_pk_bf16_f32 v33, v34, v35
    s_waitcnt lgkmcnt(0)
    v_smfmac_f32_16x16x64_bf16 v[60:63], v[48:51], v[16:23], v72
    v_and_or_b32 v32, v32, -2, s90
    buffer_store_dwordx2 v[32:33], v75, s[4:7], s31 offen offset:512 sc1
    s_nop 5
    v_cvt_pk_bf16_f32 v60, v60, v61
    v_cvt_pk_bf16_f32 v61, v62, v63
    v_and_or_b32 v60, v60, -2, s90
    buffer_store_dwordx2 v[60:61], v75, s[4:7], s31 offen offset:2560 sc1
    s_add_u32 s40, s20, 16384
    s_cmp_eq_u32 s40, 0x110000
    s_cselect_b32 s40, 0x100000, s40
    v_lshrrev_b32 v77, 7, v73
    v_mul_u32_u24 v77, 9344, v77
    v_and_b32 v37, 0x70, v73
    v_add_u32 v36, v77, v37
    s_add_u32 s29, s30, s46
    s_add_u32 s31, s29, 74752
    s_add_u32 s38, s29, 149504
    s_add_u32 s39, s29, 224256
    s_waitcnt vmcnt(0)
    buffer_load_dwordx4 v[16:19], v36, s[4:7], s29 offen sc1
    buffer_load_dwordx4 v[20:23], v36, s[4:7], s31 offen sc1
    buffer_load_dwordx4 v[24:27], v36, s[4:7], s38 offen sc1
    buffer_load_dwordx4 v[28:31], v36, s[4:7], s39 offen sc1
    v_bfe_u32 v77, v73, 4, 4
    v_and_b32 v78, 1, v77
    v_lshlrev_b32 v78, 4, v78
    v_mov_b32 v79, 0x3f80
    v_lshlrev_b32 v78, v78, v79
    v_lshrrev_b32 v77, 1, v77
    v_cmp_eq_u32 vcc, 0, v77
    s_nop 1
    v_cndmask_b32 v32, 0, v78, vcc
    v_cmp_eq_u32 vcc, 1, v77
    s_nop 1
    v_cndmask_b32 v33, 0, v78, vcc
    v_cmp_eq_u32 vcc, 2, v77
    s_nop 1
    v_cndmask_b32 v34, 0, v78, vcc
    v_cmp_eq_u32 vcc, 3, v77
    s_nop 1
    v_cndmask_b32 v35, 0, v78, vcc
    v_bfe_u32 v79, v73, 8, 1
    v_lshl_add_u32 v37, v79, 3, v37
    v_bfe_u32 v79, v73, 9, 1
    v_lshl_add_u32 v37, v79, 2, v37
    s_add_u32 s58, s40, s30
    s_add_u32 s100, s20, s30
    v_mov_b32 v8, 0xffbfffbf
    buffer_load_dwordx4 v[16:19], v36, s[4:7], s29 offen sc1
    buffer_load_dwordx4 v[20:23], v36, s[4:7], s31 offen sc1
    buffer_load_dwordx4 v[24:27], v36, s[4:7], s38 offen sc1
    buffer_load_dwordx4 v[28:31], v36, s[4:7], s39 offen sc1
    s_branch W1sc1_RED1A
W1sc1_REDA:
    v_and_b32 v44, 1, v44
    v_cmp_ne_u32 s[48:49], 0, v44
    v_and_b32 v45, 1, v45
    v_cmp_ne_u32 s[50:51], 0, v45
    v_and_b32 v46, 1, v46
    v_cmp_ne_u32 s[52:53], 0, v46
    v_and_b32 v47, 1, v47
    v_cmp_ne_u32 s[54:55], 0, v47
    s_mov_b64 exec, s[48:49]
    buffer_load_dwordx4 v[16:19], v36, s[4:7], s29 offen sc1
    s_mov_b64 exec, s[50:51]
    buffer_load_dwordx4 v[20:23], v36, s[4:7], s31 offen sc1
    s_mov_b64 exec, s[52:53]
    buffer_load_dwordx4 v[24:27], v36, s[4:7], s38 offen sc1
    s_mov_b64 exec, s[54:55]
    buffer_load_dwordx4 v[28:31], v36, s[4:7], s39 offen sc1
    s_mov_b64 exec, -1
    s_sub_u32 s19, s19, 1
    s_cbranch_scc1 REC_FAIL
W1sc1_RED1A:
    s_waitcnt vmcnt(4)
    v_bitop3_b32 v44, v16, v18, s90 bitop3:0x7e
    v_bitop3_b32 v45, v20, v22, s90 bitop3:0x7e
    v_bitop3_b32 v46, v24, v26, s90 bitop3:0x7e
    v_bitop3_b32 v47, v28, v30, s90 bitop3:0x7e
    v_or3_b32 v48, v44, v45, v46
    v_or_b32 v48, v48, v47
    v_and_b32 v48, 1, v48
    v_cmp_ne_u32 vcc, 0, v48
    v_mfma_f32_16x16x32_bf16 v[40:43], v[16:19], v[32:35], 0
    s_cbranch_vccnz W1sc1_REDA
    v_mfma_f32_16x16x32_bf16 v[40:43], v[20:23], v[32:35], v[40:43]
    v_mfma_f32_16x16x32_bf16 v[40:43], v[24:27], v[32:35], v[40:43]
    v_mfma_f32_16x16x32_bf16 v[40:43], v[28:31], v[32:35], v[40:43]
    s_nop 7
    v_permlane32_swap_b32 v40, v42
    v_permlane32_swap_b32 v41, v43
    v_pk_add_f32 v[40:41], v[40:41], v[42:43]
    v_cvt_pk_bf16_f32 v40, v40, v41
    s_mov_b64 exec, s[32:33]
    buffer_store_dword v40, v37, s[4:7], s58 offen sc1
    buffer_store_dword v8, v37, s[4:7], s100 offen sc1
    s_cmp_lt_u32 s18, 62
    s_cbranch_scc1 NOH_14
    s_add_u32 s59, s30, 0x19dc00
    buffer_store_dword v40, v37, s[4:7], s59 offen sc1
NOH_14:
    s_mov_b64 exec, -1
W1sc1_NORED:
    s_mov_b32 s20, s40
    s_xor_b32 s46, s46, 0x80000
    s_and_b32 s31, s18, 1
    s_xor_b32 s90, s90, s31
    s_add_u32 s18, s18, 1
    s_cmp_lt_u32 s18, s67
    s_cbranch_scc1 W1sc1_PRE
    s_branch REC_EXIT
W1sc1_RETRY1:
    s_mov_b64 exec, s[48:49]
    buffer_load_dwordx4 v[28:31], v73, s[4:7], s38 offen offset:3072 sc1
    s_mov_b64 exec, s[50:51]
    buffer_load_dwordx4 v[32:35], v73, s[4:7], s39 offen offset:0 sc1
    s_mov_b64 exec, -1
    s_sub_u32 s19, s19, 1
    s_cbranch_scc1 REC_FAIL
    s_branch W1sc1_CHK1
REC_W2:
    ds_read_b128 v[0:3], v73 offset:53248
    ds_read_b128 v[4:7], v73 offset:54272
    ds_read_b128 v[8:11], v73 offset:61440
    ds_read_b128 v[12:15], v73 offset:62464
    ds_read_b128 v[16:19], v78 offset:36864
    ds_read_b128 v[20:23], v78 offset:37888
    ds_read_b128 v[24:27], v78 offset:45056
    ds_read_b128 v[28:31], v78 offset:46080
    s_waitcnt lgkmcnt(0)
    ds_write_b128 v73, a[48:51] offset:53248
    ds_write_b128 v73, a[52:55] offset:54272
    ds_write_b128 v73, a[0:3] offset:61440
    ds_write_b128 v73, a[4:7] offset:62464
    ds_write_b128 v78, a[96:99] offset:36864
    ds_write_b128 v78, a[100:103] offset:37888
    ds_write_b128 v78, a[160:163] offset:45056
    ds_write_b128 v78, a[164:167] offset:46080
    s_waitcnt lgkmcnt(0)
    v_accvgpr_write_b32 a48, v0
    v_accvgpr_write_b32 a49, v1
    v_accvgpr_write_b32 a50, v2
    v_accvgpr_write_b32 a51, v3
    v_accvgpr_write_b32 a52, v4
    v_accvgpr_write_b32 a53, v5
    v_accvgpr_write_b32 a54, v6
    v_accvgpr_write_b32 a55, v7
    v_accvgpr_write_b32 a0, v8
    v_accvgpr_write_b32 a1, v9
    v_accvgpr_write_b32 a2, v10
    v_accvgpr_write_b32 a3, v11
    v_accvgpr_write_b32 a4, v12
    v_accvgpr_write_b32 a5, v13
    v_accvgpr_write_b32 a6, v14
    v_accvgpr_write_b32 a7, v15
    v_accvgpr_write_b32 a96, v16
    v_accvgpr_write_b32 a97, v17
    v_accvgpr_write_b32 a98, v18
    v_accvgpr_write_b32 a99, v19
    v_accvgpr_write_b32 a100, v20
    v_accvgpr_write_b32 a101, v21
    v_accvgpr_write_b32 a102, v22
    v_accvgpr_write_b32 a103, v23
    v_accvgpr_write_b32 a160, v24
    v_accvgpr_write_b32 a161, v25
    v_accvgpr_write_b32 a162, v26
    v_accvgpr_write_b32 a163, v27
    v_accvgpr_write_b32 a164, v28
    v_accvgpr_write_b32 a165, v29
    v_accvgpr_write_b32 a166, v30
    v_accvgpr_write_b32 a167, v31
RWI_15:
    s_waitcnt vmcnt(0)
    v_readfirstlane_b32 s64, v68
    s_nop 0
    s_cmp_ge_u32 s64, 256
    s_cbranch_scc1 RWO_16
    buffer_load_dword v68, v67, s[12:15], 0 offen offset:128 sc1
    s_sub_u32 s19, s19, 1
    s_cbranch_scc1 REC_FAIL
    s_branch RWI_15
RWO_16:
    s_cmp_ge_u32 s28, 72
    s_cbranch_scc1 NOPUB0_17
    s_cmp_lg_u32 s18, 0
    s_cbranch_scc1 NOPUB0_17
    s_waitcnt vmcnt(0)
    v_cmp_eq_u32 vcc, 0xffbfffbf, v65
    v_mov_b32 v67, 0xffffffff
    s_nop 0
    v_cndmask_b32 v65, v65, v67, vcc
    s_add_u32 s64, s30, s20
    s_mov_b64 exec, s[32:33]
    buffer_store_dword v65, v66, s[4:7], s64 offen sc1
    s_mov_b64 exec, -1
NOPUB0_17:
    s_cmp_ge_u32 s18, 64
    s_cbranch_scc1 KVOK_18
KVP_19:
    s_cmp_gt_u32 s45, s18
    s_cbranch_scc1 KVOK_18
    v_lshlrev_b32 v77, 3, v73
    s_mov_b64 exec, 15
    buffer_load_dword v77, v77, s[4:7], s43 offen sc1
    s_mov_b64 exec, -1
    s_waitcnt vmcnt(0)
    v_readlane_b32 s56, v77, 0
    v_readlane_b32 s57, v77, 1
    s_nop 0
    s_min_u32 s56, s56, s57
    v_readlane_b32 s57, v77, 2
    s_nop 0
    s_min_u32 s56, s56, s57
    v_readlane_b32 s57, v77, 3
    s_nop 0
    s_min_u32 s56, s56, s57
    s_lshl_b32 s45, s56, 2
    s_sub_u32 s19, s19, 1
    s_cbranch_scc1 REC_FAIL
    s_branch KVP_19
KVOK_18:
    s_barrier
    s_cmp_lg_u32 s66, 0
    s_cbranch_scc1 W2sc1_PRE
    s_mov_b32 s58, 0x20e000
CEN_20:
    s_mov_b64 exec, 1
    v_mov_b32 v77, 256
    buffer_load_dword v60, v73, s[12:15], 0 offen sc1
    s_mov_b64 exec, -1
    s_waitcnt vmcnt(0)
    v_readfirstlane_b32 s56, v77
    v_readfirstlane_b32 s57, v60
    s_nop 0
    s_min_u32 s57, s57, 32
    s_cmp_ge_u32 s57, 32
    s_cbranch_scc1 CENF_21
    s_sub_u32 s19, s19, 1
    s_cbranch_scc1 REC_FAIL
    s_cmp_lt_u32 s56, 256
    s_cbranch_scc1 CEN_20
    s_branch W2sc1_PRE
CENF_21:
W2_PRE:
    v_add_u32 v78, 65536, v73
    v_add_u32 v79, 131072, v73
    s_add_u32 s31, s24, 4096
    s_add_u32 s38, s20, 4096
    s_add_u32 s39, s20, 8192
    s_barrier
    s_waitcnt vmcnt(0)
    buffer_load_dwordx4 v[12:15], v73, s[4:7], s20 offen offset:3072 sc1
    buffer_load_dwordx4 v[16:19], v73, s[4:7], s38 offen offset:0 sc1
    ds_read_b128 v[64:67], v73 offset:53248
    ds_read_b128 v[68:71], v73 offset:54272
    v_mov_b32 v36, 0
    v_mov_b32 v37, 0
    v_mov_b32 v38, 0
    v_mov_b32 v39, 0
    v_mov_b32 v40, 0
    v_mov_b32 v41, 0
    v_mov_b32 v42, 0
    v_mov_b32 v43, 0
    v_mov_b32 v44, 0
    v_mov_b32 v45, 0
    v_mov_b32 v46, 0
    v_mov_b32 v47, 0
    v_mov_b32 v48, 0
    v_mov_b32 v49, 0
    v_mov_b32 v50, 0
    v_mov_b32 v51, 0
    buffer_load_dwordx4 v[12:15], v73, s[4:7], s20 offen offset:3072 sc1
    buffer_load_dwordx4 v[16:19], v73, s[4:7], s38 offen offset:0 sc1
W2_CHK1:
    s_waitcnt vmcnt(2)
    v_max3_u32 v32, v12, v13, v14
    v_max_u32 v32, v32, v15
    v_max3_u32 v33, v16, v17, v18
    v_max_u32 v33, v33, v19
    v_cmp_eq_u32 s[48:49], s47, v32
    v_cmp_eq_u32 s[50:51], s47, v33
    s_nop 0
    s_or_b64 s[56:57], s[48:49], s[50:51]
    s_cbranch_scc1 W2_RETRY1
    ds_write_b128 v73, v[12:15] offset:3072
    ds_write_b128 v73, v[16:19] offset:4096
    s_waitcnt lgkmcnt(2)
    v_smfmac_f32_16x16x64_bf16 v[36:39], v[12:15], v[64:71], v72
    v_smfmac_f32_16x16x64_bf16 v[40:43], v[12:15], a[56:63], v72
    ds_read_b128 v[64:67], v73 offset:61440
    ds_read_b128 v[68:71], v73 offset:62464
    v_smfmac_f32_16x16x64_bf16 v[36:39], v[16:19], a[64:71], v72
    v_smfmac_f32_16x16x64_bf16 v[40:43], v[16:19], a[72:79], v72
    s_waitcnt lgkmcnt(2)
    s_barrier
    ds_read_b128 v[0:3], v73 offset:0
    ds_read_b128 v[4:7], v73 offset:1024
    ds_read_b128 v[8:11], v73 offset:2048
    ds_read_b128 v[20:23], v73 offset:5120
    ds_read_b128 v[24:27], v73 offset:6144
    ds_read_b128 v[28:31], v73 offset:7168
    ds_read_b128 v[32:35], v73 offset:8192
    v_smfmac_f32_16x16x64_bf16 v[44:47], v[12:15], a[192:199], v72
    v_smfmac_f32_16x16x64_bf16 v[48:51], v[12:15], a[200:207], v72
    v_smfmac_f32_16x16x64_bf16 v[44:47], v[16:19], a[208:215], v72
    v_smfmac_f32_16x16x64_bf16 v[48:51], v[16:19], a[216:223], v72
    s_waitcnt lgkmcnt(6)
    v_smfmac_f32_16x16x64_bf16 v[36:39], v[0:3], v[64:71], v72
    v_smfmac_f32_16x16x64_bf16 v[40:43], v[0:3], a[8:15], v72
    ds_read_b128 v[64:67], v78 offset:36864
    ds_read_b128 v[68:71], v78 offset:37888
    s_waitcnt lgkmcnt(7)
    v_smfmac_f32_16x16x64_bf16 v[36:39], v[4:7], a[16:23], v72
    buffer_load_dwordx4 v[52:55], v73, s[4:7], s31 offen offset:0 sc1
    v_smfmac_f32_16x16x64_bf16 v[40:43], v[4:7], a[24:31], v72
    buffer_load_dwordx4 v[56:59], v73, s[4:7], s31 offen offset:1024 sc1
    s_waitcnt lgkmcnt(6)
    v_smfmac_f32_16x16x64_bf16 v[36:39], v[8:11], a[32:39], v72
    v_smfmac_f32_16x16x64_bf16 v[40:43], v[8:11], a[40:47], v72
    s_waitcnt lgkmcnt(5)
    v_smfmac_f32_16x16x64_bf16 v[36:39], v[20:23], a[80:87], v72
    v_smfmac_f32_16x16x64_bf16 v[40:43], v[20:23], a[88:95], v72
    s_waitcnt lgkmcnt(0)
    v_smfmac_f32_16x16x64_bf16 v[36:39], v[24:27], v[64:71], v72
    v_smfmac_f32_16x16x64_bf16 v[40:43], v[24:27], a[104:111], v72
    ds_read_b128 v[64:67], v78 offset:45056
    ds_read_b128 v[68:71], v78 offset:46080
    v_smfmac_f32_16x16x64_bf16 v[36:39], v[28:31], a[112:119], v72
    v_smfmac_f32_16x16x64_bf16 v[40:43], v[28:31], a[120:127], v72
    v_smfmac_f32_16x16x64_bf16 v[36:39], v[32:35], a[128:135], v72
    v_smfmac_f32_16x16x64_bf16 v[40:43], v[32:35], a[136:143], v72
    s_add_u32 s24, s24, 262144
    v_smfmac_f32_16x16x64_bf16 v[44:47], v[0:3], a[144:151], v72
    v_smfmac_f32_16x16x64_bf16 v[48:51], v[0:3], a[152:159], v72
    s_nop 4
    v_permlane32_swap_b32 v36, v40
    v_permlane32_swap_b32 v37, v41
    v_permlane32_swap_b32 v38, v42
    s_waitcnt lgkmcnt(0)
    v_smfmac_f32_16x16x64_bf16 v[44:47], v[4:7], v[64:71], v72
    v_permlane32_swap_b32 v39, v43
    v_add_f32 v36, v36, v40
    v_add_f32 v37, v37, v41
    v_smfmac_f32_16x16x64_bf16 v[48:51], v[4:7], a[168:175], v72
    v_add_f32 v38, v38, v42
    v_add_f32 v39, v39, v43
    v_cvt_pk_bf16_f32 v36, v36, v37
    v_smfmac_f32_16x16x64_bf16 v[44:47], v[8:11], a[176:183], v72
    v_cvt_pk_bf16_f32 v37, v38, v39
    ds_write_b64 v75, v[36:37] offset:10240
    v_smfmac_f32_16x16x64_bf16 v[48:51], v[8:11], a[184:191], v72
    v_mov_b64 v[38:39], 0
    v_smfmac_f32_16x16x64_bf16 v[44:47], v[20:23], a[224:231], v72
    v_mov_b64 v[40:41], 0
    v_smfmac_f32_16x16x64_bf16 v[48:51], v[20:23], a[232:239], v72
    v_mov_b64 v[42:43], 0
    s_waitcnt lgkmcnt(0)
    s_barrier
    v_smfmac_f32_16x16x64_bf16 v[44:47], v[24:27], a[240:247], v72
    v_mov_b64 v[36:37], 0
    v_smfmac_f32_16x16x64_bf16 v[48:51], v[24:27], a[248:255], v72
    v_smfmac_f32_16x16x64_bf16 v[44:47], v[28:31], v[80:87], v72
    v_smfmac_f32_16x16x64_bf16 v[48:51], v[28:31], v[88:95], v72
    v_smfmac_f32_16x16x64_bf16 v[44:47], v[32:35], v[96:103], v72
    v_smfmac_f32_16x16x64_bf16 v[48:51], v[32:35], v[104:111], v72
    v_smfmac_f32_16x16x64_bf16 v[36:39], v[0:3], v[112:119], v72
    v_smfmac_f32_16x16x64_bf16 v[40:43], v[0:3], v[120:127], v72
    s_nop 5
    v_permlane32_swap_b32 v44, v48
    v_permlane32_swap_b32 v45, v49
    v_permlane32_swap_b32 v46, v50
    v_permlane32_swap_b32 v47, v51
    v_add_f32 v44, v44, v48
    v_add_f32 v45, v45, v49
    v_add_f32 v46, v46, v50
    v_add_f32 v47, v47, v51
    v_cvt_pk_bf16_f32 v44, v44, v45
    v_cvt_pk_bf16_f32 v45, v46, v47
    ds_write_b64 v75, v[44:45] offset:12288
    v_smfmac_f32_16x16x64_bf16 v[36:39], v[4:7], v[128:135], v72
    v_smfmac_f32_16x16x64_bf16 v[40:43], v[4:7], v[136:143], v72
    v_smfmac_f32_16x16x64_bf16 v[36:39], v[8:11], v[144:151], v72
    s_waitcnt lgkmcnt(0)
    s_barrier
    s_add_u32 s31, s18, 1
    s_cmp_ge_u32 s31, 64
    s_cbranch_scc1 KVOK_22
KVP_23:
    s_cmp_gt_u32 s45, s31
    s_cbranch_scc1 KVOK_22
    v_lshlrev_b32 v77, 3, v73
    s_mov_b64 exec, 15
    buffer_load_dword v77, v77, s[4:7], s43 offen sc1
    s_mov_b64 exec, -1
    s_waitcnt vmcnt(0)
    v_readlane_b32 s56, v77, 0
    v_readlane_b32 s57, v77, 1
    s_nop 0
    s_min_u32 s56, s56, s57
    v_readlane_b32 s57, v77, 2
    s_nop 0
    s_min_u32 s56, s56, s57
    v_readlane_b32 s57, v77, 3
    s_nop 0
    s_min_u32 s56, s56, s57
    s_lshl_b32 s45, s56, 2
    s_sub_u32 s19, s19, 1
    s_cbranch_scc1 REC_FAIL
    s_branch KVP_23
KVOK_22:
    v_lshlrev_b32 v77, 3, v73
    s_mov_b32 m0, 13312
    s_add_u32 s31, s21, 0x1000000
    buffer_load_dword v77, s[4:7], s21 offen lds
    buffer_load_dword v77, s[4:7], s31 offen lds
    s_add_u32 s21, s21, 262144
    v_add_u32 v77, s101, v73
    ds_read_b128 v[64:67], v77 offset:0
    v_smfmac_f32_16x16x64_bf16 v[40:43], v[8:11], v[152:159], v72
    v_smfmac_f32_16x16x64_bf16 v[36:39], v[12:15], v[160:167], v72
    v_smfmac_f32_16x16x64_bf16 v[40:43], v[12:15], v[168:175], v72
    v_smfmac_f32_16x16x64_bf16 v[36:39], v[16:19], v[176:183], v72
    v_smfmac_f32_16x16x64_bf16 v[40:43], v[16:19], v[184:191], v72
    s_waitcnt lgkmcnt(0)
    s_mov_b64 exec, 0x3ffff
    buffer_store_dwordx4 v[64:67], v77, s[4:7], s41 offen sc1
    s_mov_b64 exec, -1
    s_add_u32 s41, s41, 9216
    v_smfmac_f32_16x16x64_bf16 v[36:39], v[20:23], v[192:199], v72
    v_smfmac_f32_16x16x64_bf16 v[40:43], v[20:23], v[200:207], v72
    v_smfmac_f32_16x16x64_bf16 v[36:39], v[24:27], v[208:215], v72
    v_smfmac_f32_16x16x64_bf16 v[40:43], v[24:27], v[216:223], v72
    v_smfmac_f32_16x16x64_bf16 v[36:39], v[28:31], v[224:231], v72
    v_smfmac_f32_16x16x64_bf16 v[40:43], v[28:31], v[232:239], v72
    v_smfmac_f32_16x16x64_bf16 v[36:39], v[32:35], v[240:247], v72
    v_smfmac_f32_16x16x64_bf16 v[40:43], v[32:35], v[248:255], v72
    ds_read_b128 v[8:11], v73 offset:20480
    ds_read_b128 v[12:15], v73 offset:21504
    ds_read_b128 v[16:19], v73 offset:28672
    ds_read_b128 v[20:23], v73 offset:29696
    s_nop 2
    v_cvt_pk_bf16_f32 v36, v36, v37
    v_cvt_pk_bf16_f32 v37, v38, v39
    s_nop 1
    v_cvt_pk_bf16_f32 v40, v40, v41
    v_cvt_pk_bf16_f32 v41, v42, v43
    ds_read_b128 v[24:27], v73 offset:36864
    ds_read_b128 v[28:31], v73 offset:37888
    ds_read_b128 v[64:67], v73 offset:45056
    ds_read_b128 v[68:71], v73 offset:46080
    v_lshrrev_b32 v77, 1, v76
    s_waitcnt vmcnt(3)
    s_barrier
    ds_read_b128 v[44:47], v76 offset:11264
    ds_read_b64 v[38:39], v77 offset:11776
    s_waitcnt lgkmcnt(1)
    v_mfma_f32_16x16x32_bf16 v[0:3], v[52:55], v[44:47], 0
    v_mfma_f32_16x16x32_bf16 v[4:7], v[56:59], v[44:47], 0
    s_waitcnt lgkmcnt(0)
    s_nop 3
    v_mfma_f32_16x16x16_bf16 v[0:3], v[36:37], v[38:39], v[0:3]
    s_nop 3
    v_mfma_f32_16x16x16_bf16 v[4:7], v[40:41], v[38:39], v[4:7]
    s_nop 6
    v_cvt_pk_bf16_f32 v0, v0, v1
    v_cvt_pk_bf16_f32 v1, v2, v3
    s_nop 5
    v_cvt_pk_bf16_f32 v2, v4, v5
    v_cvt_pk_bf16_f32 v3, v6, v7
    ds_write_b128 v76, v[0:3] offset:10240
    v_mov_b64 v[4:5], 0
    v_mov_b64 v[6:7], 0
    v_mov_b64 v[60:61], 0
    v_mov_b64 v[62:63], 0
    s_mul_i32 s27, s16, 9344
    s_add_u32 s27, s27, s46
    s_add_u32 s31, s27, 4096
    s_add_u32 s38, s27, 7168
    s_waitcnt lgkmcnt(0)
    s_barrier
    ds_read_b128 v[36:39], v76 offset:9216
    ds_read_b128 v[40:43], v76 offset:9728
    ds_read_b128 v[44:47], v76 offset:10240
    ds_read_b128 v[48:51], v76 offset:10752
    ds_read_b128 v[52:55], v78 offset:4096
    ds_read_b128 v[56:59], v78 offset:5120
    v_mov_b64 v[0:1], 0
    v_mov_b64 v[2:3], 0
    v_mov_b64 v[32:33], 0
    v_mov_b64 v[34:35], 0
    s_waitcnt lgkmcnt(5)
    v_smfmac_f32_16x16x64_bf16 v[0:3], v[36:39], v[8:15], v72
    s_waitcnt lgkmcnt(4)
    v_smfmac_f32_16x16x64_bf16 v[0:3], v[40:43], v[16:23], v72
    ds_read_b128 v[8:11], v78 offset:12288
    ds_read_b128 v[12:15], v78 offset:13312
    s_waitcnt lgkmcnt(5)
    v_smfmac_f32_16x16x64_bf16 v[0:3], v[44:47], v[24:31], v72
    ds_read_b128 v[16:19], v78 offset:20480
    ds_read_b128 v[20:23], v78 offset:21504
    s_waitcnt lgkmcnt(6)
    v_smfmac_f32_16x16x64_bf16 v[0:3], v[48:51], v[64:71], v72
    ds_read_b128 v[24:27], v78 offset:28672
    ds_read_b128 v[28:31], v78 offset:29696
    v_smfmac_f32_16x16x64_bf16 v[4:7], v[36:39], a[48:55], v72
    ds_read_b128 v[64:67], v78 offset:53248
    ds_read_b128 v[68:71], v78 offset:54272
    v_smfmac_f32_16x16x64_bf16 v[4:7], v[40:43], a[0:7], v72
    s_waitcnt lgkmcnt(8)
    v_smfmac_f32_16x16x64_bf16 v[4:7], v[44:47], v[52:59], v72
    v_cvt_pk_bf16_f32 v0, v0, v1
    v_cvt_pk_bf16_f32 v1, v2, v3
    s_waitcnt lgkmcnt(6)
    v_smfmac_f32_16x16x64_bf16 v[4:7], v[48:51], v[8:15], v72
    ds_read_b128 v[52:55], v78 offset:61440
    ds_read_b128 v[56:59], v78 offset:62464
    v_and_or_b32 v0, v0, -2, s90
    buffer_store_dwordx2 v[0:1], v75, s[4:7], s27 offen offset:1024
    s_waitcnt lgkmcnt(6)
    v_smfmac_f32_16x16x64_bf16 v[32:35], v[36:39], v[16:23], v72
    ds_read_b128 v[8:11], v79 offset:4096
    ds_read_b128 v[12:15], v79 offset:5120
    v_mov_b64 v[0:1], 0
    v_mov_b64 v[2:3], 0
    s_waitcnt lgkmcnt(6)
    v_smfmac_f32_16x16x64_bf16 v[32:35], v[40:43], v[24:31], v72
    ds_read_b128 v[16:19], v79 offset:12288
    ds_read_b128 v[20:23], v79 offset:13312
    v_smfmac_f32_16x16x64_bf16 v[32:35], v[44:47], a[96:103], v72
    ds_read_b128 v[24:27], v79 offset:16384
    ds_read_b128 v[28:31], v79 offset:17408
    v_cvt_pk_bf16_f32 v4, v4, v5
    v_cvt_pk_bf16_f32 v5, v6, v7
    v_smfmac_f32_16x16x64_bf16 v[32:35], v[48:51], a[160:167], v72
    v_and_or_b32 v4, v4, -2, s90
    buffer_store_dwordx2 v[4:5], v75, s[4:7], s27 offen offset:3072
    s_waitcnt lgkmcnt(8)
    v_smfmac_f32_16x16x64_bf16 v[60:63], v[36:39], v[64:71], v72
    s_waitcnt lgkmcnt(6)
    v_smfmac_f32_16x16x64_bf16 v[60:63], v[40:43], v[52:59], v72
    ds_read_b128 v[64:67], v79 offset:20480
    ds_read_b128 v[68:71], v79 offset:21504
    s_waitcnt lgkmcnt(6)
    v_smfmac_f32_16x16x64_bf16 v[60:63], v[44:47], v[8:15], v72
    ds_read_b128 v[52:55], v79 offset:24576
    ds_read_b128 v[56:59], v79 offset:25600
    v_cvt_pk_bf16_f32 v32, v32, v33
    v_cvt_pk_bf16_f32 v33, v34, v35
    s_waitcnt lgkmcnt(6)
    v_smfmac_f32_16x16x64_bf16 v[60:63], v[48:51], v[16:23], v72
    ds_read_b128 v[8:11], v79 offset:28672
    ds_read_b128 v[12:15], v79 offset:29696
    v_and_or_b32 v32, v32, -2, s90
    buffer_store_dwordx2 v[32:33], v75, s[4:7], s31 offen offset:1024
    s_waitcnt lgkmcnt(6)
    v_smfmac_f32_16x16x64_bf16 v[0:3], v[36:39], v[24:31], v72
    s_waitcnt lgkmcnt(4)
    v_smfmac_f32_16x16x64_bf16 v[0:3], v[40:43], v[64:71], v72
    s_waitcnt lgkmcnt(2)
    v_smfmac_f32_16x16x64_bf16 v[0:3], v[44:47], v[52:59], v72
    v_cvt_pk_bf16_f32 v60, v60, v61
    v_cvt_pk_bf16_f32 v61, v62, v63
    s_waitcnt lgkmcnt(0)
    v_smfmac_f32_16x16x64_bf16 v[0:3], v[48:51], v[8:15], v72
    v_and_or_b32 v60, v60, -2, s90
    buffer_store_dwordx2 v[60:61], v75, s[4:7], s31 offen offset:3072
    s_nop 5
    v_cvt_pk_bf16_f32 v0, v0, v1
    v_cvt_pk_bf16_f32 v1, v2, v3
    v_and_or_b32 v0, v0, -2, s90
    buffer_store_dwordx2 v[0:1], v75, s[4:7], s38 offen offset:1024
    s_add_u32 s40, s20, 16384
    s_cmp_eq_u32 s40, 0x110000
    s_cselect_b32 s40, 0x100000, s40
    v_lshrrev_b32 v77, 5, v73
    v_mul_u32_u24 v77, 9344, v77
    v_and_b32 v37, 16, v73
    v_add_u32 v36, v77, v37
    s_lshl_b32 s31, s16, 5
    s_add_u32 s29, s31, s46
    s_add_u32 s29, s29, 8192
    v_bfe_u32 v77, v73, 4, 4
    v_and_b32 v78, 1, v77
    v_lshlrev_b32 v78, 4, v78
    v_mov_b32 v79, 0x3f80
    v_lshlrev_b32 v78, v78, v79
    v_lshrrev_b32 v77, 1, v77
    v_cmp_eq_u32 vcc, 0, v77
    s_nop 1
    v_cndmask_b32 v32, 0, v78, vcc
    v_cmp_eq_u32 vcc, 1, v77
    s_nop 1
    v_cndmask_b32 v33, 0, v78, vcc
    v_cmp_eq_u32 vcc, 2, v77
    s_nop 1
    v_cndmask_b32 v34, 0, v78, vcc
    v_cmp_eq_u32 vcc, 3, v77
    s_nop 1
    v_cndmask_b32 v35, 0, v78, vcc
    s_lshr_b32 s31, s16, 2
    s_lshl_b32 s31, s31, 7
    s_and_b32 s38, s16, 3
    s_lshl_b32 s38, s38, 2
    s_add_u32 s31, s31, s38
    s_add_u32 s31, s31, 8192
    s_add_u32 s58, s40, s31
    s_add_u32 s100, s20, s31
    s_add_u32 s59, s31, 0x19dc00
    v_mov_b32 v8, 0xffbfffbf
    s_waitcnt vmcnt(0)
W2_TRED:
    buffer_load_dwordx4 v[16:19], v36, s[4:7], s29 offen sc1
    s_sub_u32 s19, s19, 1
    s_cbranch_scc1 REC_FAIL
    s_waitcnt vmcnt(0)
    v_mfma_f32_16x16x32_bf16 v[40:43], v[16:19], v[32:35], 0
    v_bitop3_b32 v44, v16, v18, s90 bitop3:0x7e
    v_and_b32 v44, 1, v44
    v_cmp_ne_u32 vcc, 0, v44
    s_cbranch_vccnz W2_TRED
    s_nop 3
    v_pk_add_f32 v[40:41], v[40:41], v[42:43]
    v_mov_b64 v[42:43], v[40:41]
    s_nop 1
    v_permlane16_swap_b32 v40, v42
    v_permlane16_swap_b32 v41, v43
    v_pk_add_f32 v[40:41], v[40:41], v[42:43]
    v_mov_b64 v[42:43], v[40:41]
    s_nop 1
    v_permlane32_swap_b32 v40, v42
    v_permlane32_swap_b32 v41, v43
    v_pk_add_f32 v[40:41], v[40:41], v[42:43]
    v_cvt_pk_bf16_f32 v40, v40, v41
    s_mov_b64 exec, 0xff
    buffer_store_dword v40, v73, s[4:7], s58 offen
    buffer_store_dword v8, v73, s[4:7], s100 offen
    s_cmp_lt_u32 s18, 62
    s_cbranch_scc1 NOH_24
    buffer_store_dword v40, v73, s[4:7], s59 offen sc1
NOH_24:
    s_mov_b64 exec, -1
    s_mov_b32 s20, s40
    s_xor_b32 s46, s46, 0x80000
    s_and_b32 s31, s18, 1
    s_xor_b32 s90, s90, s31
    s_add_u32 s18, s18, 1
    s_cmp_lt_u32 s18, s67
    s_cbranch_scc1 W2_PRE
    s_branch REC_EXIT
W2_RETRY1:
    s_mov_b64 exec, s[48:49]
    buffer_load_dwordx4 v[12:15], v73, s[4:7], s20 offen offset:3072 sc1
    s_mov_b64 exec, s[50:51]
    buffer_load_dwordx4 v[16:19], v73, s[4:7], s38 offen offset:0 sc1
    s_mov_b64 exec, -1
    s_sub_u32 s19, s19, 1
    s_cbranch_scc1 REC_FAIL
    s_branch W2_CHK1
W2sc1_PRE:
    v_add_u32 v78, 65536, v73
    v_add_u32 v79, 131072, v73
    s_add_u32 s31, s24, 4096
    s_add_u32 s38, s20, 4096
    s_add_u32 s39, s20, 8192
    s_barrier
    s_waitcnt vmcnt(0)
    buffer_load_dwordx4 v[12:15], v73, s[4:7], s20 offen offset:3072 sc1
    buffer_load_dwordx4 v[16:19], v73, s[4:7], s38 offen offset:0 sc1
    ds_read_b128 v[64:67], v73 offset:53248
    ds_read_b128 v[68:71], v73 offset:54272
    v_mov_b32 v36, 0
    v_mov_b32 v37, 0
    v_mov_b32 v38, 0
    v_mov_b32 v39, 0
    v_mov_b32 v40, 0
    v_mov_b32 v41, 0
    v_mov_b32 v42, 0
    v_mov_b32 v43, 0
    v_mov_b32 v44, 0
    v_mov_b32 v45, 0
    v_mov_b32 v46, 0
    v_mov_b32 v47, 0
    v_mov_b32 v48, 0
    v_mov_b32 v49, 0
    v_mov_b32 v50, 0
    v_mov_b32 v51, 0
    buffer_load_dwordx4 v[12:15], v73, s[4:7], s20 offen offset:3072 sc1
    buffer_load_dwordx4 v[16:19], v73, s[4:7], s38 offen offset:0 sc1
W2sc1_CHK1:
    s_waitcnt vmcnt(2)
    v_max3_u32 v32, v12, v13, v14
    v_max_u32 v32, v32, v15
    v_max3_u32 v33, v16, v17, v18
    v_max_u32 v33, v33, v19
    v_cmp_eq_u32 s[48:49], s47, v32
    v_cmp_eq_u32 s[50:51], s47, v33
    s_nop 0
    s_or_b64 s[56:57], s[48:49], s[50:51]
    s_cbranch_scc1 W2sc1_RETRY1
    ds_write_b128 v73, v[12:15] offset:3072
    ds_write_b128 v73, v[16:19] offset:4096
    s_waitcnt lgkmcnt(2)
    v_smfmac_f32_16x16x64_bf16 v[36:39], v[12:15], v[64:71], v72
    v_smfmac_f32_16x16x64_bf16 v[40:43], v[12:15], a[56:63], v72
    ds_read_b128 v[64:67], v73 offset:61440
    ds_read_b128 v[68:71], v73 offset:62464
    v_smfmac_f32_16x16x64_bf16 v[36:39], v[16:19], a[64:71], v72
    v_smfmac_f32_16x16x64_bf16 v[40:43], v[16:19], a[72:79], v72
    s_waitcnt lgkmcnt(2)
    s_barrier
    ds_read_b128 v[0:3], v73 offset:0
    ds_read_b128 v[4:7], v73 offset:1024
    ds_read_b128 v[8:11], v73 offset:2048
    ds_read_b128 v[20:23], v73 offset:5120
    ds_read_b128 v[24:27], v73 offset:6144
    ds_read_b128 v[28:31], v73 offset:7168
    ds_read_b128 v[32:35], v73 offset:8192
    v_smfmac_f32_16x16x64_bf16 v[44:47], v[12:15], a[192:199], v72
    v_smfmac_f32_16x16x64_bf16 v[48:51], v[12:15], a[200:207], v72
    v_smfmac_f32_16x16x64_bf16 v[44:47], v[16:19], a[208:215], v72
    v_smfmac_f32_16x16x64_bf16 v[48:51], v[16:19], a[216:223], v72
    s_waitcnt lgkmcnt(6)
    v_smfmac_f32_16x16x64_bf16 v[36:39], v[0:3], v[64:71], v72
    v_smfmac_f32_16x16x64_bf16 v[40:43], v[0:3], a[8:15], v72
    ds_read_b128 v[64:67], v78 offset:36864
    ds_read_b128 v[68:71], v78 offset:37888
    s_waitcnt lgkmcnt(7)
    v_smfmac_f32_16x16x64_bf16 v[36:39], v[4:7], a[16:23], v72
    buffer_load_dwordx4 v[52:55], v73, s[4:7], s31 offen offset:0 sc1
    v_smfmac_f32_16x16x64_bf16 v[40:43], v[4:7], a[24:31], v72
    buffer_load_dwordx4 v[56:59], v73, s[4:7], s31 offen offset:1024 sc1
    s_waitcnt lgkmcnt(6)
    v_smfmac_f32_16x16x64_bf16 v[36:39], v[8:11], a[32:39], v72
    v_smfmac_f32_16x16x64_bf16 v[40:43], v[8:11], a[40:47], v72
    s_waitcnt lgkmcnt(5)
    v_smfmac_f32_16x16x64_bf16 v[36:39], v[20:23], a[80:87], v72
    v_smfmac_f32_16x16x64_bf16 v[40:43], v[20:23], a[88:95], v72
    s_waitcnt lgkmcnt(0)
    v_smfmac_f32_16x16x64_bf16 v[36:39], v[24:27], v[64:71], v72
    v_smfmac_f32_16x16x64_bf16 v[40:43], v[24:27], a[104:111], v72
    ds_read_b128 v[64:67], v78 offset:45056
    ds_read_b128 v[68:71], v78 offset:46080
    v_smfmac_f32_16x16x64_bf16 v[36:39], v[28:31], a[112:119], v72
    v_smfmac_f32_16x16x64_bf16 v[40:43], v[28:31], a[120:127], v72
    v_smfmac_f32_16x16x64_bf16 v[36:39], v[32:35], a[128:135], v72
    v_smfmac_f32_16x16x64_bf16 v[40:43], v[32:35], a[136:143], v72
    s_add_u32 s24, s24, 262144
    v_smfmac_f32_16x16x64_bf16 v[44:47], v[0:3], a[144:151], v72
    v_smfmac_f32_16x16x64_bf16 v[48:51], v[0:3], a[152:159], v72
    s_nop 4
    v_permlane32_swap_b32 v36, v40
    v_permlane32_swap_b32 v37, v41
    v_permlane32_swap_b32 v38, v42
    s_waitcnt lgkmcnt(0)
    v_smfmac_f32_16x16x64_bf16 v[44:47], v[4:7], v[64:71], v72
    v_permlane32_swap_b32 v39, v43
    v_add_f32 v36, v36, v40
    v_add_f32 v37, v37, v41
    v_smfmac_f32_16x16x64_bf16 v[48:51], v[4:7], a[168:175], v72
    v_add_f32 v38, v38, v42
    v_add_f32 v39, v39, v43
    v_cvt_pk_bf16_f32 v36, v36, v37
    v_smfmac_f32_16x16x64_bf16 v[44:47], v[8:11], a[176:183], v72
    v_cvt_pk_bf16_f32 v37, v38, v39
    ds_write_b64 v75, v[36:37] offset:10240
    v_smfmac_f32_16x16x64_bf16 v[48:51], v[8:11], a[184:191], v72
    v_mov_b64 v[38:39], 0
    v_smfmac_f32_16x16x64_bf16 v[44:47], v[20:23], a[224:231], v72
    v_mov_b64 v[40:41], 0
    v_smfmac_f32_16x16x64_bf16 v[48:51], v[20:23], a[232:239], v72
    v_mov_b64 v[42:43], 0
    s_waitcnt lgkmcnt(0)
    s_barrier
    v_smfmac_f32_16x16x64_bf16 v[44:47], v[24:27], a[240:247], v72
    v_mov_b64 v[36:37], 0
    v_smfmac_f32_16x16x64_bf16 v[48:51], v[24:27], a[248:255], v72
    v_smfmac_f32_16x16x64_bf16 v[44:47], v[28:31], v[80:87], v72
    v_smfmac_f32_16x16x64_bf16 v[48:51], v[28:31], v[88:95], v72
    v_smfmac_f32_16x16x64_bf16 v[44:47], v[32:35], v[96:103], v72
    v_smfmac_f32_16x16x64_bf16 v[48:51], v[32:35], v[104:111], v72
    v_smfmac_f32_16x16x64_bf16 v[36:39], v[0:3], v[112:119], v72
    v_smfmac_f32_16x16x64_bf16 v[40:43], v[0:3], v[120:127], v72
    s_nop 5
    v_permlane32_swap_b32 v44, v48
    v_permlane32_swap_b32 v45, v49
    v_permlane32_swap_b32 v46, v50
    v_permlane32_swap_b32 v47, v51
    v_add_f32 v44, v44, v48
    v_add_f32 v45, v45, v49
    v_add_f32 v46, v46, v50
    v_add_f32 v47, v47, v51
    v_cvt_pk_bf16_f32 v44, v44, v45
    v_cvt_pk_bf16_f32 v45, v46, v47
    ds_write_b64 v75, v[44:45] offset:12288
    v_smfmac_f32_16x16x64_bf16 v[36:39], v[4:7], v[128:135], v72
    v_smfmac_f32_16x16x64_bf16 v[40:43], v[4:7], v[136:143], v72
    v_smfmac_f32_16x16x64_bf16 v[36:39], v[8:11], v[144:151], v72
    s_waitcnt lgkmcnt(0)
    s_barrier
    s_add_u32 s31, s18, 1
    s_cmp_ge_u32 s31, 64
    s_cbranch_scc1 KVOK_25
KVP_26:
    s_cmp_gt_u32 s45, s31
    s_cbranch_scc1 KVOK_25
    v_lshlrev_b32 v77, 3, v73
    s_mov_b64 exec, 15
    buffer_load_dword v77, v77, s[4:7], s43 offen sc1
    s_mov_b64 exec, -1
    s_waitcnt vmcnt(0)
    v_readlane_b32 s56, v77, 0
    v_readlane_b32 s57, v77, 1
    s_nop 0
    s_min_u32 s56, s56, s57
    v_readlane_b32 s57, v77, 2
    s_nop 0
    s_min_u32 s56, s56, s57
    v_readlane_b32 s57, v77, 3
    s_nop 0
    s_min_u32 s56, s56, s57
    s_lshl_b32 s45, s56, 2
    s_sub_u32 s19, s19, 1
    s_cbranch_scc1 REC_FAIL
    s_branch KVP_26
KVOK_25:
    v_lshlrev_b32 v77, 3, v73
    s_mov_b32 m0, 13312
    s_add_u32 s31, s21, 0x1000000
    buffer_load_dword v77, s[4:7], s21 offen lds
    buffer_load_dword v77, s[4:7], s31 offen lds
    s_add_u32 s21, s21, 262144
    v_add_u32 v77, s101, v73
    ds_read_b128 v[64:67], v77 offset:0
    v_smfmac_f32_16x16x64_bf16 v[40:43], v[8:11], v[152:159], v72
    v_smfmac_f32_16x16x64_bf16 v[36:39], v[12:15], v[160:167], v72
    v_smfmac_f32_16x16x64_bf16 v[40:43], v[12:15], v[168:175], v72
    v_smfmac_f32_16x16x64_bf16 v[36:39], v[16:19], v[176:183], v72
    v_smfmac_f32_16x16x64_bf16 v[40:43], v[16:19], v[184:191], v72
    s_waitcnt lgkmcnt(0)
    s_mov_b64 exec, 0x3ffff
    buffer_store_dwordx4 v[64:67], v77, s[4:7], s41 offen sc1
    s_mov_b64 exec, -1
    s_add_u32 s41, s41, 9216
    v_smfmac_f32_16x16x64_bf16 v[36:39], v[20:23], v[192:199], v72
    v_smfmac_f32_16x16x64_bf16 v[40:43], v[20:23], v[200:207], v72
    v_smfmac_f32_16x16x64_bf16 v[36:39], v[24:27], v[208:215], v72
    v_smfmac_f32_16x16x64_bf16 v[40:43], v[24:27], v[216:223], v72
    v_smfmac_f32_16x16x64_bf16 v[36:39], v[28:31], v[224:231], v72
    v_smfmac_f32_16x16x64_bf16 v[40:43], v[28:31], v[232:239], v72
    v_smfmac_f32_16x16x64_bf16 v[36:39], v[32:35], v[240:247], v72
    v_smfmac_f32_16x16x64_bf16 v[40:43], v[32:35], v[248:255], v72
    ds_read_b128 v[8:11], v73 offset:20480
    ds_read_b128 v[12:15], v73 offset:21504
    ds_read_b128 v[16:19], v73 offset:28672
    ds_read_b128 v[20:23], v73 offset:29696
    s_nop 2
    v_cvt_pk_bf16_f32 v36, v36, v37
    v_cvt_pk_bf16_f32 v37, v38, v39
    s_nop 1
    v_cvt_pk_bf16_f32 v40, v40, v41
    v_cvt_pk_bf16_f32 v41, v42, v43
    ds_read_b128 v[24:27], v73 offset:36864
    ds_read_b128 v[28:31], v73 offset:37888
    ds_read_b128 v[64:67], v73 offset:45056
    ds_read_b128 v[68:71], v73 offset:46080
    v_lshrrev_b32 v77, 1, v76
    s_waitcnt vmcnt(3)
    s_barrier
    ds_read_b128 v[44:47], v76 offset:11264
    ds_read_b64 v[38:39], v77 offset:11776
    s_waitcnt lgkmcnt(1)
    v_mfma_f32_16x16x32_bf16 v[0:3], v[52:55], v[44:47], 0
    v_mfma_f32_16x16x32_bf16 v[4:7], v[56:59], v[44:47], 0
    s_waitcnt lgkmcnt(0)
    s_nop 3
    v_mfma_f32_16x16x16_bf16 v[0:3], v[36:37], v[38:39], v[0:3]
    s_nop 3
    v_mfma_f32_16x16x16_bf16 v[4:7], v[40:41], v[38:39], v[4:7]
    s_nop 6
    v_cvt_pk_bf16_f32 v0, v0, v1
    v_cvt_pk_bf16_f32 v1, v2, v3
    s_nop 5
    v_cvt_pk_bf16_f32 v2, v4, v5
    v_cvt_pk_bf16_f32 v3, v6, v7
    ds_write_b128 v76, v[0:3] offset:10240
    v_mov_b64 v[4:5], 0
    v_mov_b64 v[6:7], 0
    v_mov_b64 v[60:61], 0
    v_mov_b64 v[62:63], 0
    s_mul_i32 s27, s16, 9344
    s_add_u32 s27, s27, s46
    s_add_u32 s31, s27, 4096
    s_add_u32 s38, s27, 7168
    s_waitcnt lgkmcnt(0)
    s_barrier
    ds_read_b128 v[36:39], v76 offset:9216
    ds_read_b128 v[40:43], v76 offset:9728
    ds_read_b128 v[44:47], v76 offset:10240
    ds_read_b128 v[48:51], v76 offset:10752
    ds_read_b128 v[52:55], v78 offset:4096
    ds_read_b128 v[56:59], v78 offset:5120
    v_mov_b64 v[0:1], 0
    v_mov_b64 v[2:3], 0
    v_mov_b64 v[32:33], 0
    v_mov_b64 v[34:35], 0
    s_waitcnt lgkmcnt(5)
    v_smfmac_f32_16x16x64_bf16 v[0:3], v[36:39], v[8:15], v72
    s_waitcnt lgkmcnt(4)
    v_smfmac_f32_16x16x64_bf16 v[0:3], v[40:43], v[16:23], v72
    ds_read_b128 v[8:11], v78 offset:12288
    ds_read_b128 v[12:15], v78 offset:13312
    s_waitcnt lgkmcnt(5)
    v_smfmac_f32_16x16x64_bf16 v[0:3], v[44:47], v[24:31], v72
    ds_read_b128 v[16:19], v78 offset:20480
    ds_read_b128 v[20:23], v78 offset:21504
    s_waitcnt lgkmcnt(6)
    v_smfmac_f32_16x16x64_bf16 v[0:3], v[48:51], v[64:71], v72
    ds_read_b128 v[24:27], v78 offset:28672
    ds_read_b128 v[28:31], v78 offset:29696
    v_smfmac_f32_16x16x64_bf16 v[4:7], v[36:39], a[48:55], v72
    ds_read_b128 v[64:67], v78 offset:53248
    ds_read_b128 v[68:71], v78 offset:54272
    v_smfmac_f32_16x16x64_bf16 v[4:7], v[40:43], a[0:7], v72
    s_waitcnt lgkmcnt(8)
    v_smfmac_f32_16x16x64_bf16 v[4:7], v[44:47], v[52:59], v72
    v_cvt_pk_bf16_f32 v0, v0, v1
    v_cvt_pk_bf16_f32 v1, v2, v3
    s_waitcnt lgkmcnt(6)
    v_smfmac_f32_16x16x64_bf16 v[4:7], v[48:51], v[8:15], v72
    ds_read_b128 v[52:55], v78 offset:61440
    ds_read_b128 v[56:59], v78 offset:62464
    v_and_or_b32 v0, v0, -2, s90
    buffer_store_dwordx2 v[0:1], v75, s[4:7], s27 offen offset:1024 sc1
    s_waitcnt lgkmcnt(6)
    v_smfmac_f32_16x16x64_bf16 v[32:35], v[36:39], v[16:23], v72
    ds_read_b128 v[8:11], v79 offset:4096
    ds_read_b128 v[12:15], v79 offset:5120
    v_mov_b64 v[0:1], 0
    v_mov_b64 v[2:3], 0
    s_waitcnt lgkmcnt(6)
    v_smfmac_f32_16x16x64_bf16 v[32:35], v[40:43], v[24:31], v72
    ds_read_b128 v[16:19], v79 offset:12288
    ds_read_b128 v[20:23], v79 offset:13312
    v_smfmac_f32_16x16x64_bf16 v[32:35], v[44:47], a[96:103], v72
    ds_read_b128 v[24:27], v79 offset:16384
    ds_read_b128 v[28:31], v79 offset:17408
    v_cvt_pk_bf16_f32 v4, v4, v5
    v_cvt_pk_bf16_f32 v5, v6, v7
    v_smfmac_f32_16x16x64_bf16 v[32:35], v[48:51], a[160:167], v72
    v_and_or_b32 v4, v4, -2, s90
    buffer_store_dwordx2 v[4:5], v75, s[4:7], s27 offen offset:3072 sc1
    s_waitcnt lgkmcnt(8)
    v_smfmac_f32_16x16x64_bf16 v[60:63], v[36:39], v[64:71], v72
    s_waitcnt lgkmcnt(6)
    v_smfmac_f32_16x16x64_bf16 v[60:63], v[40:43], v[52:59], v72
    ds_read_b128 v[64:67], v79 offset:20480
    ds_read_b128 v[68:71], v79 offset:21504
    s_waitcnt lgkmcnt(6)
    v_smfmac_f32_16x16x64_bf16 v[60:63], v[44:47], v[8:15], v72
    ds_read_b128 v[52:55], v79 offset:24576
    ds_read_b128 v[56:59], v79 offset:25600
    v_cvt_pk_bf16_f32 v32, v32, v33
    v_cvt_pk_bf16_f32 v33, v34, v35
    s_waitcnt lgkmcnt(6)
    v_smfmac_f32_16x16x64_bf16 v[60:63], v[48:51], v[16:23], v72
    ds_read_b128 v[8:11], v79 offset:28672
    ds_read_b128 v[12:15], v79 offset:29696
    v_and_or_b32 v32, v32, -2, s90
    buffer_store_dwordx2 v[32:33], v75, s[4:7], s31 offen offset:1024 sc1
    s_waitcnt lgkmcnt(6)
    v_smfmac_f32_16x16x64_bf16 v[0:3], v[36:39], v[24:31], v72
    s_waitcnt lgkmcnt(4)
    v_smfmac_f32_16x16x64_bf16 v[0:3], v[40:43], v[64:71], v72
    s_waitcnt lgkmcnt(2)
    v_smfmac_f32_16x16x64_bf16 v[0:3], v[44:47], v[52:59], v72
    v_cvt_pk_bf16_f32 v60, v60, v61
    v_cvt_pk_bf16_f32 v61, v62, v63
    s_waitcnt lgkmcnt(0)
    v_smfmac_f32_16x16x64_bf16 v[0:3], v[48:51], v[8:15], v72
    v_and_or_b32 v60, v60, -2, s90
    buffer_store_dwordx2 v[60:61], v75, s[4:7], s31 offen offset:3072 sc1
    s_nop 5
    v_cvt_pk_bf16_f32 v0, v0, v1
    v_cvt_pk_bf16_f32 v1, v2, v3
    v_and_or_b32 v0, v0, -2, s90
    buffer_store_dwordx2 v[0:1], v75, s[4:7], s38 offen offset:1024 sc1
    s_add_u32 s40, s20, 16384
    s_cmp_eq_u32 s40, 0x110000
    s_cselect_b32 s40, 0x100000, s40
    v_lshrrev_b32 v77, 5, v73
    v_mul_u32_u24 v77, 9344, v77
    v_and_b32 v37, 16, v73
    v_add_u32 v36, v77, v37
    s_lshl_b32 s31, s16, 5
    s_add_u32 s29, s31, s46
    s_add_u32 s29, s29, 8192
    v_bfe_u32 v77, v73, 4, 4
    v_and_b32 v78, 1, v77
    v_lshlrev_b32 v78, 4, v78
    v_mov_b32 v79, 0x3f80
    v_lshlrev_b32 v78, v78, v79
    v_lshrrev_b32 v77, 1, v77
    v_cmp_eq_u32 vcc, 0, v77
    s_nop 1
    v_cndmask_b32 v32, 0, v78, vcc
    v_cmp_eq_u32 vcc, 1, v77
    s_nop 1
    v_cndmask_b32 v33, 0, v78, vcc
    v_cmp_eq_u32 vcc, 2, v77
    s_nop 1
    v_cndmask_b32 v34, 0, v78, vcc
    v_cmp_eq_u32 vcc, 3, v77
    s_nop 1
    v_cndmask_b32 v35, 0, v78, vcc
    s_lshr_b32 s31, s16, 2
    s_lshl_b32 s31, s31, 7
    s_and_b32 s38, s16, 3
    s_lshl_b32 s38, s38, 2
    s_add_u32 s31, s31, s38
    s_add_u32 s31, s31, 8192
    s_add_u32 s58, s40, s31
    s_add_u32 s100, s20, s31
    s_add_u32 s59, s31, 0x19dc00
    v_mov_b32 v8, 0xffbfffbf
    s_waitcnt vmcnt(0)
W2sc1_TRED:
    buffer_load_dwordx4 v[16:19], v36, s[4:7], s29 offen sc1
    s_sub_u32 s19, s19, 1
    s_cbranch_scc1 REC_FAIL
    s_waitcnt vmcnt(0)
    v_mfma_f32_16x16x32_bf16 v[40:43], v[16:19], v[32:35], 0
    v_bitop3_b32 v44, v16, v18, s90 bitop3:0x7e
    v_and_b32 v44, 1, v44
    v_cmp_ne_u32 vcc, 0, v44
    s_cbranch_vccnz W2sc1_TRED
    s_nop 3
    v_pk_add_f32 v[40:41], v[40:41], v[42:43]
    v_mov_b64 v[42:43], v[40:41]
    s_nop 1
    v_permlane16_swap_b32 v40, v42
    v_permlane16_swap_b32 v41, v43
    v_pk_add_f32 v[40:41], v[40:41], v[42:43]
    v_mov_b64 v[42:43], v[40:41]
    s_nop 1
    v_permlane32_swap_b32 v40, v42
    v_permlane32_swap_b32 v41, v43
    v_pk_add_f32 v[40:41], v[40:41], v[42:43]
    v_cvt_pk_bf16_f32 v40, v40, v41
    s_mov_b64 exec, 0xff
    buffer_store_dword v40, v73, s[4:7], s58 offen sc1
    buffer_store_dword v8, v73, s[4:7], s100 offen sc1
    s_cmp_lt_u32 s18, 62
    s_cbranch_scc1 NOH_27
    buffer_store_dword v40, v73, s[4:7], s59 offen sc1
NOH_27:
    s_mov_b64 exec, -1
    s_mov_b32 s20, s40
    s_xor_b32 s46, s46, 0x80000
    s_and_b32 s31, s18, 1
    s_xor_b32 s90, s90, s31
    s_add_u32 s18, s18, 1
    s_cmp_lt_u32 s18, s67
    s_cbranch_scc1 W2sc1_PRE
    s_branch REC_EXIT
W2sc1_RETRY1:
    s_mov_b64 exec, s[48:49]
    buffer_load_dwordx4 v[12:15], v73, s[4:7], s20 offen offset:3072 sc1
    s_mov_b64 exec, s[50:51]
    buffer_load_dwordx4 v[16:19], v73, s[4:7], s38 offen offset:0 sc1
    s_mov_b64 exec, -1
    s_sub_u32 s19, s19, 1
    s_cbranch_scc1 REC_FAIL
    s_branch W2sc1_CHK1
REC_W3:
    ds_read_b128 v[0:3], v73 offset:22528
    ds_read_b128 v[4:7], v73 offset:23552
    ds_read_b128 v[8:11], v73 offset:30720
    ds_read_b128 v[12:15], v73 offset:31744
    ds_read_b128 v[16:19], v73 offset:38912
    ds_read_b128 v[20:23], v73 offset:39936
    ds_read_b128 v[24:27], v73 offset:47104
    ds_read_b128 v[28:31], v73 offset:48128
    s_waitcnt lgkmcnt(0)
    ds_write_b128 v73, v[112:115] offset:22528
    ds_write_b128 v73, v[116:119] offset:23552
    ds_write_b128 v73, v[120:123] offset:30720
    ds_write_b128 v73, v[124:127] offset:31744
    ds_write_b128 v73, v[128:131] offset:38912
    ds_write_b128 v73, v[132:135] offset:39936
    ds_write_b128 v73, v[136:139] offset:47104
    ds_write_b128 v73, v[140:143] offset:48128
    s_waitcnt lgkmcnt(0)
    v_mov_b32 v112, v0
    v_mov_b32 v113, v1
    v_mov_b32 v114, v2
    v_mov_b32 v115, v3
    v_mov_b32 v116, v4
    v_mov_b32 v117, v5
    v_mov_b32 v118, v6
    v_mov_b32 v119, v7
    v_mov_b32 v120, v8
    v_mov_b32 v121, v9
    v_mov_b32 v122, v10
    v_mov_b32 v123, v11
    v_mov_b32 v124, v12
    v_mov_b32 v125, v13
    v_mov_b32 v126, v14
    v_mov_b32 v127, v15
    v_mov_b32 v128, v16
    v_mov_b32 v129, v17
    v_mov_b32 v130, v18
    v_mov_b32 v131, v19
    v_mov_b32 v132, v20
    v_mov_b32 v133, v21
    v_mov_b32 v134, v22
    v_mov_b32 v135, v23
    v_mov_b32 v136, v24
    v_mov_b32 v137, v25
    v_mov_b32 v138, v26
    v_mov_b32 v139, v27
    v_mov_b32 v140, v28
    v_mov_b32 v141, v29
    v_mov_b32 v142, v30
    v_mov_b32 v143, v31
    ds_read_b128 v[0:3], v73 offset:55296
    ds_read_b128 v[4:7], v73 offset:56320
    ds_read_b128 v[8:11], v73 offset:63488
    ds_read_b128 v[12:15], v73 offset:64512
    ds_read_b128 v[16:19], v78 offset:6144
    ds_read_b128 v[20:23], v78 offset:7168
    ds_read_b128 v[24:27], v78 offset:14336
    ds_read_b128 v[28:31], v78 offset:15360
    s_waitcnt lgkmcnt(0)
    ds_write_b128 v73, v[144:147] offset:55296
    ds_write_b128 v73, v[148:151] offset:56320
    ds_write_b128 v73, v[152:155] offset:63488
    ds_write_b128 v73, v[156:159] offset:64512
    ds_write_b128 v78, v[160:163] offset:6144
    ds_write_b128 v78, v[164:167] offset:7168
    ds_write_b128 v78, v[168:171] offset:14336
    ds_write_b128 v78, v[172:175] offset:15360
    s_waitcnt lgkmcnt(0)
    v_mov_b32 v144, v0
    v_mov_b32 v145, v1
    v_mov_b32 v146, v2
    v_mov_b32 v147, v3
    v_mov_b32 v148, v4
    v_mov_b32 v149, v5
    v_mov_b32 v150, v6
    v_mov_b32 v151, v7
    v_mov_b32 v152, v8
    v_mov_b32 v153, v9
    v_mov_b32 v154, v10
    v_mov_b32 v155, v11
    v_mov_b32 v156, v12
    v_mov_b32 v157, v13
    v_mov_b32 v158, v14
    v_mov_b32 v159, v15
    v_mov_b32 v160, v16
    v_mov_b32 v161, v17
    v_mov_b32 v162, v18
    v_mov_b32 v163, v19
    v_mov_b32 v164, v20
    v_mov_b32 v165, v21
    v_mov_b32 v166, v22
    v_mov_b32 v167, v23
    v_mov_b32 v168, v24
    v_mov_b32 v169, v25
    v_mov_b32 v170, v26
    v_mov_b32 v171, v27
    v_mov_b32 v172, v28
    v_mov_b32 v173, v29
    v_mov_b32 v174, v30
    v_mov_b32 v175, v31
    ds_read_b128 v[0:3], v78 offset:22528
    ds_read_b128 v[4:7], v78 offset:23552
    ds_read_b128 v[8:11], v78 offset:30720
    ds_read_b128 v[12:15], v78 offset:31744
    ds_read_b128 v[16:19], v78 offset:38912
    ds_read_b128 v[20:23], v78 offset:39936
    ds_read_b128 v[24:27], v78 offset:47104
    ds_read_b128 v[28:31], v78 offset:48128
    s_waitcnt lgkmcnt(0)
    ds_write_b128 v78, v[176:179] offset:22528
    ds_write_b128 v78, v[180:183] offset:23552
    ds_write_b128 v78, v[184:187] offset:30720
    ds_write_b128 v78, v[188:191] offset:31744
    ds_write_b128 v78, v[192:195] offset:38912
    ds_write_b128 v78, v[196:199] offset:39936
    ds_write_b128 v78, v[200:203] offset:47104
    ds_write_b128 v78, v[204:207] offset:48128
    s_waitcnt lgkmcnt(0)
    v_mov_b32 v176, v0
    v_mov_b32 v177, v1
    v_mov_b32 v178, v2
    v_mov_b32 v179, v3
    v_mov_b32 v180, v4
    v_mov_b32 v181, v5
    v_mov_b32 v182, v6
    v_mov_b32 v183, v7
    v_mov_b32 v184, v8
    v_mov_b32 v185, v9
    v_mov_b32 v186, v10
    v_mov_b32 v187, v11
    v_mov_b32 v188, v12
    v_mov_b32 v189, v13
    v_mov_b32 v190, v14
    v_mov_b32 v191, v15
    v_mov_b32 v192, v16
    v_mov_b32 v193, v17
    v_mov_b32 v194, v18
    v_mov_b32 v195, v19
    v_mov_b32 v196, v20
    v_mov_b32 v197, v21
    v_mov_b32 v198, v22
    v_mov_b32 v199, v23
    v_mov_b32 v200, v24
    v_mov_b32 v201, v25
    v_mov_b32 v202, v26
    v_mov_b32 v203, v27
    v_mov_b32 v204, v28
    v_mov_b32 v205, v29
    v_mov_b32 v206, v30
    v_mov_b32 v207, v31
    ds_read_b128 v[0:3], v78 offset:55296
    ds_read_b128 v[4:7], v78 offset:56320
    ds_read_b128 v[8:11], v78 offset:63488
    ds_read_b128 v[12:15], v78 offset:64512
    ds_read_b128 v[16:19], v79 offset:6144
    ds_read_b128 v[20:23], v79 offset:7168
    ds_read_b128 v[24:27], v79 offset:14336
    ds_read_b128 v[28:31], v79 offset:15360
    s_waitcnt lgkmcnt(0)
    ds_write_b128 v78, v[208:211] offset:55296
    ds_write_b128 v78, v[212:215] offset:56320
    ds_write_b128 v78, v[216:219] offset:63488
    ds_write_b128 v78, v[220:223] offset:64512
    ds_write_b128 v79, v[224:227] offset:6144
    ds_write_b128 v79, v[228:231] offset:7168
    ds_write_b128 v79, v[232:235] offset:14336
    ds_write_b128 v79, v[236:239] offset:15360
    s_waitcnt lgkmcnt(0)
    v_mov_b32 v208, v0
    v_mov_b32 v209, v1
    v_mov_b32 v210, v2
    v_mov_b32 v211, v3
    v_mov_b32 v212, v4
    v_mov_b32 v213, v5
    v_mov_b32 v214, v6
    v_mov_b32 v215, v7
    v_mov_b32 v216, v8
    v_mov_b32 v217, v9
    v_mov_b32 v218, v10
    v_mov_b32 v219, v11
    v_mov_b32 v220, v12
    v_mov_b32 v221, v13
    v_mov_b32 v222, v14
    v_mov_b32 v223, v15
    v_mov_b32 v224, v16
    v_mov_b32 v225, v17
    v_mov_b32 v226, v18
    v_mov_b32 v227, v19
    v_mov_b32 v228, v20
    v_mov_b32 v229, v21
    v_mov_b32 v230, v22
    v_mov_b32 v231, v23
    v_mov_b32 v232, v24
    v_mov_b32 v233, v25
    v_mov_b32 v234, v26
    v_mov_b32 v235, v27
    v_mov_b32 v236, v28
    v_mov_b32 v237, v29
    v_mov_b32 v238, v30
    v_mov_b32 v239, v31
    ds_read_b128 v[0:3], v79 offset:18432
    ds_read_b128 v[4:7], v79 offset:19456
    ds_read_b128 v[8:11], v79 offset:22528
    ds_read_b128 v[12:15], v79 offset:23552
    s_waitcnt lgkmcnt(0)
    ds_write_b128 v79, v[240:243] offset:18432
    ds_write_b128 v79, v[244:247] offset:19456
    ds_write_b128 v79, v[248:251] offset:22528
    ds_write_b128 v79, v[252:255] offset:23552
    s_waitcnt lgkmcnt(0)
    v_mov_b32 v240, v0
    v_mov_b32 v241, v1
    v_mov_b32 v242, v2
    v_mov_b32 v243, v3
    v_mov_b32 v244, v4
    v_mov_b32 v245, v5
    v_mov_b32 v246, v6
    v_mov_b32 v247, v7
    v_mov_b32 v248, v8
    v_mov_b32 v249, v9
    v_mov_b32 v250, v10
    v_mov_b32 v251, v11
    v_mov_b32 v252, v12
    v_mov_b32 v253, v13
    v_mov_b32 v254, v14
    v_mov_b32 v255, v15
RWI_28:
    s_waitcnt vmcnt(0)
    v_readfirstlane_b32 s64, v68
    s_nop 0
    s_cmp_ge_u32 s64, 256
    s_cbranch_scc1 RWO_29
    buffer_load_dword v68, v67, s[12:15], 0 offen offset:128 sc1
    s_sub_u32 s19, s19, 1
    s_cbranch_scc1 REC_FAIL
    s_branch RWI_28
RWO_29:
    s_barrier
    s_cmp_lg_u32 s66, 0
    s_cbranch_scc1 W3sc1_PRE
    s_mov_b32 s58, 0x20e000
CEN_30:
    s_mov_b64 exec, 1
    v_mov_b32 v77, 256
    buffer_load_dword v60, v73, s[12:15], 0 offen sc1
    s_mov_b64 exec, -1
    s_waitcnt vmcnt(0)
    v_readfirstlane_b32 s56, v77
    v_readfirstlane_b32 s57, v60
    s_nop 0
    s_min_u32 s57, s57, 32
    s_cmp_ge_u32 s57, 32
    s_cbranch_scc1 CENF_31
    s_sub_u32 s19, s19, 1
    s_cbranch_scc1 REC_FAIL
    s_cmp_lt_u32 s56, 256
    s_cbranch_scc1 CEN_30
    s_branch W3sc1_PRE
CENF_31:
W3_PRE:
    v_add_u32 v78, 65536, v73
    v_add_u32 v79, 131072, v73
    s_add_u32 s31, s24, 4096
    s_add_u32 s38, s20, 4096
    s_add_u32 s39, s20, 8192
    s_barrier
    buffer_load_dwordx4 v[0:3], v73, s[4:7], s20 offen offset:0 sc1
    buffer_load_dwordx4 v[4:7], v73, s[4:7], s20 offen offset:1024 sc1
    buffer_load_dwordx4 v[8:11], v73, s[4:7], s20 offen offset:2048 sc1
    v_mov_b32 v36, 0
    v_mov_b32 v37, 0
    v_mov_b32 v38, 0
    v_mov_b32 v39, 0
    v_mov_b32 v40, 0
    v_mov_b32 v41, 0
    v_mov_b32 v42, 0
    v_mov_b32 v43, 0
    v_mov_b32 v44, 0
    v_mov_b32 v45, 0
    v_mov_b32 v46, 0
    v_mov_b32 v47, 0
    v_mov_b32 v48, 0
    v_mov_b32 v49, 0
    v_mov_b32 v50, 0
    v_mov_b32 v51, 0
    buffer_load_dwordx4 v[0:3], v73, s[4:7], s20 offen offset:0 sc1
    buffer_load_dwordx4 v[4:7], v73, s[4:7], s20 offen offset:1024 sc1
    buffer_load_dwordx4 v[8:11], v73, s[4:7], s20 offen offset:2048 sc1
W3_CHK1:
    s_waitcnt vmcnt(3)
    v_max3_u32 v32, v0, v1, v2
    v_max_u32 v32, v32, v3
    v_max3_u32 v33, v4, v5, v6
    v_max_u32 v33, v33, v7
    v_max3_u32 v34, v8, v9, v10
    v_max_u32 v34, v34, v11
    v_cmp_eq_u32 s[48:49], s47, v32
    v_cmp_eq_u32 s[50:51], s47, v33
    v_cmp_eq_u32 s[52:53], s47, v34
    s_or_b64 s[56:57], s[48:49], s[50:51]
    s_or_b64 s[56:57], s[56:57], s[52:53]
    s_cbranch_scc1 W3_RETRY1
    ds_write_b128 v73, v[0:3] offset:0
    ds_write_b128 v73, v[4:7] offset:1024
    ds_write_b128 v73, v[8:11] offset:2048
    buffer_load_dwordx4 v[52:55], v73, s[4:7], s22 offen offset:0 sc1
    buffer_load_dwordx4 v[56:59], v73, s[4:7], s22 offen offset:1024 sc1
    buffer_load_dwordx4 v[60:63], v73, s[4:7], s22 offen offset:2048 sc1
    buffer_load_dwordx4 v[64:67], v73, s[4:7], s22 offen offset:3072 sc1
    buffer_load_dwordx4 v[68:71], v73, s[4:7], s23 offen offset:0 sc1
    v_smfmac_f32_16x16x64_bf16 v[36:39], v[0:3], a[0:7], v72
    v_smfmac_f32_16x16x64_bf16 v[40:43], v[0:3], a[8:15], v72
    v_smfmac_f32_16x16x64_bf16 v[36:39], v[4:7], a[16:23], v72
    v_smfmac_f32_16x16x64_bf16 v[40:43], v[4:7], a[24:31], v72
    s_waitcnt lgkmcnt(0)
    s_barrier
    ds_read_b128 v[12:15], v73 offset:3072
    ds_read_b128 v[16:19], v73 offset:4096
    ds_read_b128 v[20:23], v73 offset:5120
    ds_read_b128 v[24:27], v73 offset:6144
    ds_read_b128 v[28:31], v73 offset:7168
    ds_read_b128 v[32:35], v73 offset:8192
    v_smfmac_f32_16x16x64_bf16 v[36:39], v[8:11], a[32:39], v72
    v_smfmac_f32_16x16x64_bf16 v[40:43], v[8:11], a[40:47], v72
    v_smfmac_f32_16x16x64_bf16 v[44:47], v[0:3], a[144:151], v72
    v_smfmac_f32_16x16x64_bf16 v[48:51], v[0:3], a[152:159], v72
    v_smfmac_f32_16x16x64_bf16 v[44:47], v[4:7], a[160:167], v72
    v_smfmac_f32_16x16x64_bf16 v[48:51], v[4:7], a[168:175], v72
    v_smfmac_f32_16x16x64_bf16 v[44:47], v[8:11], a[176:183], v72
    v_smfmac_f32_16x16x64_bf16 v[48:51], v[8:11], a[184:191], v72
    s_waitcnt lgkmcnt(5)
    v_smfmac_f32_16x16x64_bf16 v[36:39], v[12:15], a[48:55], v72
    buffer_load_dwordx4 v[0:3], v73, s[4:7], s23 offen offset:1024 sc1
    v_smfmac_f32_16x16x64_bf16 v[40:43], v[12:15], a[56:63], v72
    buffer_load_dwordx4 v[4:7], v73, s[4:7], s23 offen offset:2048 sc1
    s_waitcnt lgkmcnt(4)
    v_smfmac_f32_16x16x64_bf16 v[36:39], v[16:19], a[64:71], v72
    buffer_load_dwordx4 v[8:11], v73, s[4:7], s23 offen offset:3072 sc1
    v_smfmac_f32_16x16x64_bf16 v[40:43], v[16:19], a[72:79], v72
    s_waitcnt lgkmcnt(3)
    v_smfmac_f32_16x16x64_bf16 v[36:39], v[20:23], a[80:87], v72
    v_smfmac_f32_16x16x64_bf16 v[40:43], v[20:23], a[88:95], v72
    s_waitcnt lgkmcnt(2)
    v_smfmac_f32_16x16x64_bf16 v[36:39], v[24:27], a[96:103], v72
    v_smfmac_f32_16x16x64_bf16 v[40:43], v[24:27], a[104:111], v72
    s_waitcnt lgkmcnt(1)
    v_smfmac_f32_16x16x64_bf16 v[36:39], v[28:31], a[112:119], v72
    v_smfmac_f32_16x16x64_bf16 v[40:43], v[28:31], a[120:127], v72
    s_waitcnt lgkmcnt(0)
    v_smfmac_f32_16x16x64_bf16 v[36:39], v[32:35], a[128:135], v72
    v_smfmac_f32_16x16x64_bf16 v[40:43], v[32:35], a[136:143], v72
    s_add_u32 s22, s22, 262144
    s_add_u32 s23, s23, 262144
    v_smfmac_f32_16x16x64_bf16 v[44:47], v[12:15], a[192:199], v72
    v_smfmac_f32_16x16x64_bf16 v[48:51], v[12:15], a[200:207], v72
    s_nop 3
    v_permlane32_swap_b32 v36, v40
    v_permlane32_swap_b32 v37, v41
    v_permlane32_swap_b32 v38, v42
    v_smfmac_f32_16x16x64_bf16 v[44:47], v[16:19], a[208:215], v72
    v_permlane32_swap_b32 v39, v43
    v_add_f32 v36, v36, v40
    v_add_f32 v37, v37, v41
    v_smfmac_f32_16x16x64_bf16 v[48:51], v[16:19], a[216:223], v72
    v_add_f32 v38, v38, v42
    v_add_f32 v39, v39, v43
    v_cvt_pk_bf16_f32 v36, v36, v37
    v_smfmac_f32_16x16x64_bf16 v[44:47], v[20:23], a[224:231], v72
    v_cvt_pk_bf16_f32 v37, v38, v39
    ds_write_b64 v75, v[36:37] offset:10752
    v_smfmac_f32_16x16x64_bf16 v[48:51], v[20:23], a[232:239], v72
    v_smfmac_f32_16x16x64_bf16 v[44:47], v[24:27], a[240:247], v72
    v_smfmac_f32_16x16x64_bf16 v[48:51], v[24:27], a[248:255], v72
    s_waitcnt lgkmcnt(0)
    s_barrier
    v_smfmac_f32_16x16x64_bf16 v[44:47], v[28:31], v[80:87], v72
    ds_read_b64_tr_b16 v[12:13], v74 offset:9216
    ds_read_b64_tr_b16 v[14:15], v74 offset:9472
    ds_read_b64_tr_b16 v[16:17], v74 offset:9728
    ds_read_b64_tr_b16 v[18:19], v74 offset:9984
    ds_read_b64_tr_b16 v[20:21], v74 offset:10240
    ds_read_b64_tr_b16 v[22:23], v74 offset:10496
    v_smfmac_f32_16x16x64_bf16 v[48:51], v[28:31], v[88:95], v72
    ds_read_b64_tr_b16 v[24:25], v74 offset:10752
    ds_read_b64_tr_b16 v[26:27], v74 offset:11008
    v_smfmac_f32_16x16x64_bf16 v[44:47], v[32:35], v[96:103], v72
    v_smfmac_f32_16x16x64_bf16 v[48:51], v[32:35], v[104:111], v72
    s_waitcnt vmcnt(0)
    s_waitcnt lgkmcnt(6)
    v_mfma_f32_16x16x32_bf16 v[36:39], v[52:55], v[12:15], 0
    v_mfma_f32_16x16x32_bf16 v[40:43], v[68:71], v[12:15], 0
    s_nop 3
    v_permlane32_swap_b32 v44, v48
    v_permlane32_swap_b32 v45, v49
    v_permlane32_swap_b32 v46, v50
    v_permlane32_swap_b32 v47, v51
    s_waitcnt lgkmcnt(4)
    v_mfma_f32_16x16x32_bf16 v[36:39], v[56:59], v[16:19], v[36:39]
    v_add_f32 v44, v44, v48
    v_add_f32 v45, v45, v49
    v_add_f32 v46, v46, v50
    v_add_f32 v47, v47, v51
    v_mfma_f32_16x16x32_bf16 v[40:43], v[0:3], v[16:19], v[40:43]
    v_cvt_pk_bf16_f32 v44, v44, v45
    v_cvt_pk_bf16_f32 v45, v46, v47
    ds_write_b64 v75, v[44:45] offset:12800
    s_waitcnt lgkmcnt(3)
    v_mfma_f32_16x16x32_bf16 v[36:39], v[60:63], v[20:23], v[36:39]
    v_mfma_f32_16x16x32_bf16 v[40:43], v[4:7], v[20:23], v[40:43]
    s_waitcnt lgkmcnt(1)
    v_mfma_f32_16x16x32_bf16 v[36:39], v[64:67], v[24:27], v[36:39]
    v_mfma_f32_16x16x32_bf16 v[40:43], v[8:11], v[24:27], v[40:43]
    s_waitcnt lgkmcnt(0)
    s_barrier
    ds_read_b64_tr_b16 v[52:53], v74 offset:11264
    ds_read_b64_tr_b16 v[54:55], v74 offset:11520
    ds_read_b64_tr_b16 v[56:57], v74 offset:11776
    ds_read_b64_tr_b16 v[58:59], v74 offset:12032
    ds_read_b64_tr_b16 v[60:61], v74 offset:12288
    ds_read_b64_tr_b16 v[62:63], v74 offset:12544
    ds_read_b64_tr_b16 v[64:65], v74 offset:12800
    ds_read_b64_tr_b16 v[66:67], v74 offset:13056
    v_bfe_u32 v78, v73, 7, 1
    v_lshl_add_u32 v78, v78, 3, v76
    v_lshrrev_b32 v79, 1, v76
    v_cndmask_b32 v36, v36, v40, s[34:35]
    v_cndmask_b32 v37, v37, v41, s[34:35]
    v_cndmask_b32 v38, v38, v42, s[34:35]
    v_cndmask_b32 v39, v39, v43, s[34:35]
    s_waitcnt lgkmcnt(6)
    v_mfma_f32_16x16x32_bf16 v[44:47], v[52:55], v[12:15], 0
    v_max3_f32 v48, v36, v37, v38
    v_max_f32 v48, v48, v39
    s_waitcnt lgkmcnt(4)
    v_mfma_f32_16x16x32_bf16 v[44:47], v[56:59], v[16:19], v[44:47]
    v_max_f32_dpp v48, v48, v48 row_ror:8 row_mask:0xf bank_mask:0xf
    v_mov_b32 v77, v48
    s_waitcnt lgkmcnt(2)
    v_mfma_f32_16x16x32_bf16 v[44:47], v[60:63], v[20:23], v[44:47]
    v_permlane32_swap_b32 v48, v77
    v_max_f32 v48, v48, v77
    s_waitcnt lgkmcnt(0)
    v_mfma_f32_16x16x32_bf16 v[44:47], v[64:67], v[24:27], v[44:47]
    s_nop 7
    v_max3_f32 v51, v44, v45, v46
    v_max3_f32 v51, v51, v47, v48
    v_mov_b32 v48, v51
    s_nop 1
    v_permlane16_swap_b32 v51, v48
    v_max_f32 v51, v51, v48
    v_pk_add_f32 v[44:45], v[44:45], v[50:51] op_sel:[0,1] op_sel_hi:[1,1] neg_lo:[0,1] neg_hi:[0,1]
    v_pk_add_f32 v[46:47], v[46:47], v[50:51] op_sel:[0,1] op_sel_hi:[1,1] neg_lo:[0,1] neg_hi:[0,1]
    v_pk_add_f32 v[36:37], v[36:37], v[50:51] op_sel:[0,1] op_sel_hi:[1,1] neg_lo:[0,1] neg_hi:[0,1]
    v_pk_add_f32 v[38:39], v[38:39], v[50:51] op_sel:[0,1] op_sel_hi:[1,1] neg_lo:[0,1] neg_hi:[0,1]
    v_pk_mul_f32 v[44:45], v[44:45], s[92:93]
    v_pk_mul_f32 v[46:47], v[46:47], s[92:93]
    v_pk_mul_f32 v[36:37], v[36:37], s[92:93]
    v_pk_mul_f32 v[38:39], v[38:39], s[92:93]
    v_exp_f32 v44, v44
    v_exp_f32 v45, v45
    v_exp_f32 v46, v46
    v_exp_f32 v47, v47
    v_exp_f32 v36, v36
    v_exp_f32 v37, v37
    v_exp_f32 v38, v38
    v_exp_f32 v39, v39
    v_pk_add_f32 v[48:49], v[44:45], v[46:47]
    v_pk_add_f32 v[50:51], v[36:37], v[38:39]
    v_pk_fma_f32 v[48:49], v[48:49], s[94:95], v[50:51]
    v_add_f32 v49, v48, v49
    s_nop 1
    v_add_f32_dpp v49, v49, v49 row_ror:8 row_mask:0xf bank_mask:0xf
    v_mov_b32 v77, v49
    s_nop 1
    v_permlane16_swap_b32 v49, v77
    v_add_f32 v49, v49, v77
    v_mov_b32 v77, v49
    s_nop 1
    v_permlane32_swap_b32 v49, v77
    v_add_f32 v49, v49, v77
    v_rcp_f32 v48, v49
    v_rcp_f32 v49, v49
    s_nop 0
    v_pk_mul_f32 v[44:45], v[44:45], v[48:49]
    v_pk_mul_f32 v[46:47], v[46:47], v[48:49]
    v_pk_mul_f32 v[36:37], v[36:37], v[48:49]
    v_pk_mul_f32 v[38:39], v[38:39], v[48:49]
    v_cvt_pk_bf16_f32 v44, v44, v45
    v_cvt_pk_bf16_f32 v45, v46, v47
    ds_write_b64 v79, v[44:45] offset:11776
    v_cvt_pk_bf16_f32 v36, v36, v37
    v_cvt_pk_bf16_f32 v37, v38, v39
    ds_write_b64 v78, v[36:37] offset:11264
    s_waitcnt lgkmcnt(0)
    s_barrier
    v_add_u32 v78, 65536, v73
    v_add_u32 v79, 131072, v73
    ds_read_b128 v[8:11], v79 offset:26624
    ds_read_b128 v[12:15], v79 offset:27648
    ds_read_b128 v[16:19], v79 offset:30720
    ds_read_b128 v[20:23], v79 offset:31744
    v_mov_b64 v[0:1], 0
    v_mov_b64 v[2:3], 0
    v_mov_b64 v[4:5], 0
    v_mov_b64 v[6:7], 0
    v_mov_b64 v[32:33], 0
    v_mov_b64 v[34:35], 0
    v_mov_b64 v[60:61], 0
    v_mov_b64 v[62:63], 0
    v_mov_b64 v[24:25], 0
    v_mov_b64 v[26:27], 0
    s_mul_i32 s27, s16, 9344
    s_add_u32 s27, s27, s46
    s_add_u32 s31, s27, 4096
    s_add_u32 s38, s27, 7168
    s_barrier
    ds_read_b128 v[36:39], v76 offset:9216
    ds_read_b128 v[40:43], v76 offset:9728
    ds_read_b128 v[44:47], v76 offset:10240
    ds_read_b128 v[48:51], v76 offset:10752
    s_waitcnt lgkmcnt(3)
    v_smfmac_f32_16x16x64_bf16 v[0:3], v[36:39], v[112:119], v72
    s_waitcnt lgkmcnt(2)
    v_smfmac_f32_16x16x64_bf16 v[0:3], v[40:43], v[120:127], v72
    s_waitcnt lgkmcnt(1)
    v_smfmac_f32_16x16x64_bf16 v[0:3], v[44:47], v[128:135], v72
    s_waitcnt lgkmcnt(0)
    v_smfmac_f32_16x16x64_bf16 v[0:3], v[48:51], v[136:143], v72
    v_smfmac_f32_16x16x64_bf16 v[4:7], v[36:39], v[144:151], v72
    v_smfmac_f32_16x16x64_bf16 v[4:7], v[40:43], v[152:159], v72
    v_smfmac_f32_16x16x64_bf16 v[4:7], v[44:47], v[160:167], v72
    s_nop 4
    v_cvt_pk_bf16_f32 v0, v0, v1
    v_cvt_pk_bf16_f32 v1, v2, v3
    v_smfmac_f32_16x16x64_bf16 v[4:7], v[48:51], v[168:175], v72
    v_and_or_b32 v0, v0, -2, s90
    buffer_store_dwordx2 v[0:1], v75, s[4:7], s27 offen offset:1536
    v_smfmac_f32_16x16x64_bf16 v[32:35], v[36:39], v[176:183], v72
    v_smfmac_f32_16x16x64_bf16 v[32:35], v[40:43], v[184:191], v72
    v_smfmac_f32_16x16x64_bf16 v[32:35], v[44:47], v[192:199], v72
    s_nop 2
    v_cvt_pk_bf16_f32 v4, v4, v5
    v_cvt_pk_bf16_f32 v5, v6, v7
    v_smfmac_f32_16x16x64_bf16 v[32:35], v[48:51], v[200:207], v72
    v_and_or_b32 v4, v4, -2, s90
    buffer_store_dwordx2 v[4:5], v75, s[4:7], s27 offen offset:3584
    v_smfmac_f32_16x16x64_bf16 v[60:63], v[36:39], v[208:215], v72
    v_smfmac_f32_16x16x64_bf16 v[60:63], v[40:43], v[216:223], v72
    v_smfmac_f32_16x16x64_bf16 v[60:63], v[44:47], v[224:231], v72
    s_nop 2
    v_cvt_pk_bf16_f32 v32, v32, v33
    v_cvt_pk_bf16_f32 v33, v34, v35
    v_smfmac_f32_16x16x64_bf16 v[60:63], v[48:51], v[232:239], v72
    v_and_or_b32 v32, v32, -2, s90
    buffer_store_dwordx2 v[32:33], v75, s[4:7], s31 offen offset:1536
    v_smfmac_f32_16x16x64_bf16 v[24:27], v[36:39], v[240:247], v72
    v_smfmac_f32_16x16x64_bf16 v[24:27], v[40:43], v[248:255], v72
    v_smfmac_f32_16x16x64_bf16 v[24:27], v[44:47], v[8:15], v72
    s_nop 2
    v_cvt_pk_bf16_f32 v60, v60, v61
    v_cvt_pk_bf16_f32 v61, v62, v63
    v_smfmac_f32_16x16x64_bf16 v[24:27], v[48:51], v[16:23], v72
    v_and_or_b32 v60, v60, -2, s90
    buffer_store_dwordx2 v[60:61], v75, s[4:7], s31 offen offset:3584
    s_nop 5
    v_cvt_pk_bf16_f32 v24, v24, v25
    v_cvt_pk_bf16_f32 v25, v26, v27
    v_and_or_b32 v24, v24, -2, s90
    buffer_store_dwordx2 v[24:25], v75, s[4:7], s38 offen offset:1536
    s_add_u32 s40, s20, 16384
    s_cmp_eq_u32 s40, 0x110000
    s_cselect_b32 s40, 0x100000, s40
    s_mov_b32 s20, s40
    s_xor_b32 s46, s46, 0x80000
    s_and_b32 s31, s18, 1
    s_xor_b32 s90, s90, s31
    s_add_u32 s18, s18, 1
    s_cmp_lt_u32 s18, s67
    s_cbranch_scc1 W3_PRE
    s_branch REC_EXIT
W3_RETRY1:
    s_mov_b64 exec, s[48:49]
    buffer_load_dwordx4 v[0:3], v73, s[4:7], s20 offen offset:0 sc1
    s_mov_b64 exec, s[50:51]
    buffer_load_dwordx4 v[4:7], v73, s[4:7], s20 offen offset:1024 sc1
    s_mov_b64 exec, s[52:53]
    buffer_load_dwordx4 v[8:11], v73, s[4:7], s20 offen offset:2048 sc1
    s_mov_b64 exec, -1
    s_sub_u32 s19, s19, 1
    s_cbranch_scc1 REC_FAIL
    s_branch W3_CHK1
W3sc1_PRE:
    v_add_u32 v78, 65536, v73
    v_add_u32 v79, 131072, v73
    s_add_u32 s31, s24, 4096
    s_add_u32 s38, s20, 4096
    s_add_u32 s39, s20, 8192
    s_barrier
    buffer_load_dwordx4 v[0:3], v73, s[4:7], s20 offen offset:0 sc1
    buffer_load_dwordx4 v[4:7], v73, s[4:7], s20 offen offset:1024 sc1
    buffer_load_dwordx4 v[8:11], v73, s[4:7], s20 offen offset:2048 sc1
    v_mov_b32 v36, 0
    v_mov_b32 v37, 0
    v_mov_b32 v38, 0
    v_mov_b32 v39, 0
    v_mov_b32 v40, 0
    v_mov_b32 v41, 0
    v_mov_b32 v42, 0
    v_mov_b32 v43, 0
    v_mov_b32 v44, 0
    v_mov_b32 v45, 0
    v_mov_b32 v46, 0
    v_mov_b32 v47, 0
    v_mov_b32 v48, 0
    v_mov_b32 v49, 0
    v_mov_b32 v50, 0
    v_mov_b32 v51, 0
    buffer_load_dwordx4 v[0:3], v73, s[4:7], s20 offen offset:0 sc1
    buffer_load_dwordx4 v[4:7], v73, s[4:7], s20 offen offset:1024 sc1
    buffer_load_dwordx4 v[8:11], v73, s[4:7], s20 offen offset:2048 sc1
W3sc1_CHK1:
    s_waitcnt vmcnt(3)
    v_max3_u32 v32, v0, v1, v2
    v_max_u32 v32, v32, v3
    v_max3_u32 v33, v4, v5, v6
    v_max_u32 v33, v33, v7
    v_max3_u32 v34, v8, v9, v10
    v_max_u32 v34, v34, v11
    v_cmp_eq_u32 s[48:49], s47, v32
    v_cmp_eq_u32 s[50:51], s47, v33
    v_cmp_eq_u32 s[52:53], s47, v34
    s_or_b64 s[56:57], s[48:49], s[50:51]
    s_or_b64 s[56:57], s[56:57], s[52:53]
    s_cbranch_scc1 W3sc1_RETRY1
    ds_write_b128 v73, v[0:3] offset:0
    ds_write_b128 v73, v[4:7] offset:1024
    ds_write_b128 v73, v[8:11] offset:2048
    buffer_load_dwordx4 v[52:55], v73, s[4:7], s22 offen offset:0 sc1
    buffer_load_dwordx4 v[56:59], v73, s[4:7], s22 offen offset:1024 sc1
    buffer_load_dwordx4 v[60:63], v73, s[4:7], s22 offen offset:2048 sc1
    buffer_load_dwordx4 v[64:67], v73, s[4:7], s22 offen offset:3072 sc1
    buffer_load_dwordx4 v[68:71], v73, s[4:7], s23 offen offset:0 sc1
    v_smfmac_f32_16x16x64_bf16 v[36:39], v[0:3], a[0:7], v72
    v_smfmac_f32_16x16x64_bf16 v[40:43], v[0:3], a[8:15], v72
    v_smfmac_f32_16x16x64_bf16 v[36:39], v[4:7], a[16:23], v72
    v_smfmac_f32_16x16x64_bf16 v[40:43], v[4:7], a[24:31], v72
    s_waitcnt lgkmcnt(0)
    s_barrier
    ds_read_b128 v[12:15], v73 offset:3072
    ds_read_b128 v[16:19], v73 offset:4096
    ds_read_b128 v[20:23], v73 offset:5120
    ds_read_b128 v[24:27], v73 offset:6144
    ds_read_b128 v[28:31], v73 offset:7168
    ds_read_b128 v[32:35], v73 offset:8192
    v_smfmac_f32_16x16x64_bf16 v[36:39], v[8:11], a[32:39], v72
    v_smfmac_f32_16x16x64_bf16 v[40:43], v[8:11], a[40:47], v72
    v_smfmac_f32_16x16x64_bf16 v[44:47], v[0:3], a[144:151], v72
    v_smfmac_f32_16x16x64_bf16 v[48:51], v[0:3], a[152:159], v72
    v_smfmac_f32_16x16x64_bf16 v[44:47], v[4:7], a[160:167], v72
    v_smfmac_f32_16x16x64_bf16 v[48:51], v[4:7], a[168:175], v72
    v_smfmac_f32_16x16x64_bf16 v[44:47], v[8:11], a[176:183], v72
    v_smfmac_f32_16x16x64_bf16 v[48:51], v[8:11], a[184:191], v72
    s_waitcnt lgkmcnt(5)
    v_smfmac_f32_16x16x64_bf16 v[36:39], v[12:15], a[48:55], v72
    buffer_load_dwordx4 v[0:3], v73, s[4:7], s23 offen offset:1024 sc1
    v_smfmac_f32_16x16x64_bf16 v[40:43], v[12:15], a[56:63], v72
    buffer_load_dwordx4 v[4:7], v73, s[4:7], s23 offen offset:2048 sc1
    s_waitcnt lgkmcnt(4)
    v_smfmac_f32_16x16x64_bf16 v[36:39], v[16:19], a[64:71], v72
    buffer_load_dwordx4 v[8:11], v73, s[4:7], s23 offen offset:3072 sc1
    v_smfmac_f32_16x16x64_bf16 v[40:43], v[16:19], a[72:79], v72
    s_waitcnt lgkmcnt(3)
    v_smfmac_f32_16x16x64_bf16 v[36:39], v[20:23], a[80:87], v72
    v_smfmac_f32_16x16x64_bf16 v[40:43], v[20:23], a[88:95], v72
    s_waitcnt lgkmcnt(2)
    v_smfmac_f32_16x16x64_bf16 v[36:39], v[24:27], a[96:103], v72
    v_smfmac_f32_16x16x64_bf16 v[40:43], v[24:27], a[104:111], v72
    s_waitcnt lgkmcnt(1)
    v_smfmac_f32_16x16x64_bf16 v[36:39], v[28:31], a[112:119], v72
    v_smfmac_f32_16x16x64_bf16 v[40:43], v[28:31], a[120:127], v72
    s_waitcnt lgkmcnt(0)
    v_smfmac_f32_16x16x64_bf16 v[36:39], v[32:35], a[128:135], v72
    v_smfmac_f32_16x16x64_bf16 v[40:43], v[32:35], a[136:143], v72
    s_add_u32 s22, s22, 262144
    s_add_u32 s23, s23, 262144
    v_smfmac_f32_16x16x64_bf16 v[44:47], v[12:15], a[192:199], v72
    v_smfmac_f32_16x16x64_bf16 v[48:51], v[12:15], a[200:207], v72
    s_nop 3
    v_permlane32_swap_b32 v36, v40
    v_permlane32_swap_b32 v37, v41
    v_permlane32_swap_b32 v38, v42
    v_smfmac_f32_16x16x64_bf16 v[44:47], v[16:19], a[208:215], v72
    v_permlane32_swap_b32 v39, v43
    v_add_f32 v36, v36, v40
    v_add_f32 v37, v37, v41
    v_smfmac_f32_16x16x64_bf16 v[48:51], v[16:19], a[216:223], v72
    v_add_f32 v38, v38, v42
    v_add_f32 v39, v39, v43
    v_cvt_pk_bf16_f32 v36, v36, v37
    v_smfmac_f32_16x16x64_bf16 v[44:47], v[20:23], a[224:231], v72
    v_cvt_pk_bf16_f32 v37, v38, v39
    ds_write_b64 v75, v[36:37] offset:10752
    v_smfmac_f32_16x16x64_bf16 v[48:51], v[20:23], a[232:239], v72
    v_smfmac_f32_16x16x64_bf16 v[44:47], v[24:27], a[240:247], v72
    v_smfmac_f32_16x16x64_bf16 v[48:51], v[24:27], a[248:255], v72
    s_waitcnt lgkmcnt(0)
    s_barrier
    v_smfmac_f32_16x16x64_bf16 v[44:47], v[28:31], v[80:87], v72
    ds_read_b64_tr_b16 v[12:13], v74 offset:9216
    ds_read_b64_tr_b16 v[14:15], v74 offset:9472
    ds_read_b64_tr_b16 v[16:17], v74 offset:9728
    ds_read_b64_tr_b16 v[18:19], v74 offset:9984
    ds_read_b64_tr_b16 v[20:21], v74 offset:10240
    ds_read_b64_tr_b16 v[22:23], v74 offset:10496
    v_smfmac_f32_16x16x64_bf16 v[48:51], v[28:31], v[88:95], v72
    ds_read_b64_tr_b16 v[24:25], v74 offset:10752
    ds_read_b64_tr_b16 v[26:27], v74 offset:11008
    v_smfmac_f32_16x16x64_bf16 v[44:47], v[32:35], v[96:103], v72
    v_smfmac_f32_16x16x64_bf16 v[48:51], v[32:35], v[104:111], v72
    s_waitcnt vmcnt(0)
    s_waitcnt lgkmcnt(6)
    v_mfma_f32_16x16x32_bf16 v[36:39], v[52:55], v[12:15], 0
    v_mfma_f32_16x16x32_bf16 v[40:43], v[68:71], v[12:15], 0
    s_nop 3
    v_permlane32_swap_b32 v44, v48
    v_permlane32_swap_b32 v45, v49
    v_permlane32_swap_b32 v46, v50
    v_permlane32_swap_b32 v47, v51
    s_waitcnt lgkmcnt(4)
    v_mfma_f32_16x16x32_bf16 v[36:39], v[56:59], v[16:19], v[36:39]
    v_add_f32 v44, v44, v48
    v_add_f32 v45, v45, v49
    v_add_f32 v46, v46, v50
    v_add_f32 v47, v47, v51
    v_mfma_f32_16x16x32_bf16 v[40:43], v[0:3], v[16:19], v[40:43]
    v_cvt_pk_bf16_f32 v44, v44, v45
    v_cvt_pk_bf16_f32 v45, v46, v47
    ds_write_b64 v75, v[44:45] offset:12800
    s_waitcnt lgkmcnt(3)
    v_mfma_f32_16x16x32_bf16 v[36:39], v[60:63], v[20:23], v[36:39]
    v_mfma_f32_16x16x32_bf16 v[40:43], v[4:7], v[20:23], v[40:43]
    s_waitcnt lgkmcnt(1)
    v_mfma_f32_16x16x32_bf16 v[36:39], v[64:67], v[24:27], v[36:39]
    v_mfma_f32_16x16x32_bf16 v[40:43], v[8:11], v[24:27], v[40:43]
    s_waitcnt lgkmcnt(0)
    s_barrier
    ds_read_b64_tr_b16 v[52:53], v74 offset:11264
    ds_read_b64_tr_b16 v[54:55], v74 offset:11520
    ds_read_b64_tr_b16 v[56:57], v74 offset:11776
    ds_read_b64_tr_b16 v[58:59], v74 offset:12032
    ds_read_b64_tr_b16 v[60:61], v74 offset:12288
    ds_read_b64_tr_b16 v[62:63], v74 offset:12544
    ds_read_b64_tr_b16 v[64:65], v74 offset:12800
    ds_read_b64_tr_b16 v[66:67], v74 offset:13056
    v_bfe_u32 v78, v73, 7, 1
    v_lshl_add_u32 v78, v78, 3, v76
    v_lshrrev_b32 v79, 1, v76
    v_cndmask_b32 v36, v36, v40, s[34:35]
    v_cndmask_b32 v37, v37, v41, s[34:35]
    v_cndmask_b32 v38, v38, v42, s[34:35]
    v_cndmask_b32 v39, v39, v43, s[34:35]
    s_waitcnt lgkmcnt(6)
    v_mfma_f32_16x16x32_bf16 v[44:47], v[52:55], v[12:15], 0
    v_max3_f32 v48, v36, v37, v38
    v_max_f32 v48, v48, v39
    s_waitcnt lgkmcnt(4)
    v_mfma_f32_16x16x32_bf16 v[44:47], v[56:59], v[16:19], v[44:47]
    v_max_f32_dpp v48, v48, v48 row_ror:8 row_mask:0xf bank_mask:0xf
    v_mov_b32 v77, v48
    s_waitcnt lgkmcnt(2)
    v_mfma_f32_16x16x32_bf16 v[44:47], v[60:63], v[20:23], v[44:47]
    v_permlane32_swap_b32 v48, v77
    v_max_f32 v48, v48, v77
    s_waitcnt lgkmcnt(0)
    v_mfma_f32_16x16x32_bf16 v[44:47], v[64:67], v[24:27], v[44:47]
    s_nop 7
    v_max3_f32 v51, v44, v45, v46
    v_max3_f32 v51, v51, v47, v48
    v_mov_b32 v48, v51
    s_nop 1
    v_permlane16_swap_b32 v51, v48
    v_max_f32 v51, v51, v48
    v_pk_add_f32 v[44:45], v[44:45], v[50:51] op_sel:[0,1] op_sel_hi:[1,1] neg_lo:[0,1] neg_hi:[0,1]
    v_pk_add_f32 v[46:47], v[46:47], v[50:51] op_sel:[0,1] op_sel_hi:[1,1] neg_lo:[0,1] neg_hi:[0,1]
    v_pk_add_f32 v[36:37], v[36:37], v[50:51] op_sel:[0,1] op_sel_hi:[1,1] neg_lo:[0,1] neg_hi:[0,1]
    v_pk_add_f32 v[38:39], v[38:39], v[50:51] op_sel:[0,1] op_sel_hi:[1,1] neg_lo:[0,1] neg_hi:[0,1]
    v_pk_mul_f32 v[44:45], v[44:45], s[92:93]
    v_pk_mul_f32 v[46:47], v[46:47], s[92:93]
    v_pk_mul_f32 v[36:37], v[36:37], s[92:93]
    v_pk_mul_f32 v[38:39], v[38:39], s[92:93]
    v_exp_f32 v44, v44
    v_exp_f32 v45, v45
    v_exp_f32 v46, v46
    v_exp_f32 v47, v47
    v_exp_f32 v36, v36
    v_exp_f32 v37, v37
    v_exp_f32 v38, v38
    v_exp_f32 v39, v39
    v_pk_add_f32 v[48:49], v[44:45], v[46:47]
    v_pk_add_f32 v[50:51], v[36:37], v[38:39]
    v_pk_fma_f32 v[48:49], v[48:49], s[94:95], v[50:51]
    v_add_f32 v49, v48, v49
    s_nop 1
    v_add_f32_dpp v49, v49, v49 row_ror:8 row_mask:0xf bank_mask:0xf
    v_mov_b32 v77, v49
    s_nop 1
    v_permlane16_swap_b32 v49, v77
    v_add_f32 v49, v49, v77
    v_mov_b32 v77, v49
    s_nop 1
    v_permlane32_swap_b32 v49, v77
    v_add_f32 v49, v49, v77
    v_rcp_f32 v48, v49
    v_rcp_f32 v49, v49
    s_nop 0
    v_pk_mul_f32 v[44:45], v[44:45], v[48:49]
    v_pk_mul_f32 v[46:47], v[46:47], v[48:49]
    v_pk_mul_f32 v[36:37], v[36:37], v[48:49]
    v_pk_mul_f32 v[38:39], v[38:39], v[48:49]
    v_cvt_pk_bf16_f32 v44, v44, v45
    v_cvt_pk_bf16_f32 v45, v46, v47
    ds_write_b64 v79, v[44:45] offset:11776
    v_cvt_pk_bf16_f32 v36, v36, v37
    v_cvt_pk_bf16_f32 v37, v38, v39
    ds_write_b64 v78, v[36:37] offset:11264
    s_waitcnt lgkmcnt(0)
    s_barrier
    v_add_u32 v78, 65536, v73
    v_add_u32 v79, 131072, v73
    ds_read_b128 v[8:11], v79 offset:26624
    ds_read_b128 v[12:15], v79 offset:27648
    ds_read_b128 v[16:19], v79 offset:30720
    ds_read_b128 v[20:23], v79 offset:31744
    v_mov_b64 v[0:1], 0
    v_mov_b64 v[2:3], 0
    v_mov_b64 v[4:5], 0
    v_mov_b64 v[6:7], 0
    v_mov_b64 v[32:33], 0
    v_mov_b64 v[34:35], 0
    v_mov_b64 v[60:61], 0
    v_mov_b64 v[62:63], 0
    v_mov_b64 v[24:25], 0
    v_mov_b64 v[26:27], 0
    s_mul_i32 s27, s16, 9344
    s_add_u32 s27, s27, s46
    s_add_u32 s31, s27, 4096
    s_add_u32 s38, s27, 7168
    s_barrier
    ds_read_b128 v[36:39], v76 offset:9216
    ds_read_b128 v[40:43], v76 offset:9728
    ds_read_b128 v[44:47], v76 offset:10240
    ds_read_b128 v[48:51], v76 offset:10752
    s_waitcnt lgkmcnt(3)
    v_smfmac_f32_16x16x64_bf16 v[0:3], v[36:39], v[112:119], v72
    s_waitcnt lgkmcnt(2)
    v_smfmac_f32_16x16x64_bf16 v[0:3], v[40:43], v[120:127], v72
    s_waitcnt lgkmcnt(1)
    v_smfmac_f32_16x16x64_bf16 v[0:3], v[44:47], v[128:135], v72
    s_waitcnt lgkmcnt(0)
    v_smfmac_f32_16x16x64_bf16 v[0:3], v[48:51], v[136:143], v72
    v_smfmac_f32_16x16x64_bf16 v[4:7], v[36:39], v[144:151], v72
    v_smfmac_f32_16x16x64_bf16 v[4:7], v[40:43], v[152:159], v72
    v_smfmac_f32_16x16x64_bf16 v[4:7], v[44:47], v[160:167], v72
    s_nop 4
    v_cvt_pk_bf16_f32 v0, v0, v1
    v_cvt_pk_bf16_f32 v1, v2, v3
    v_smfmac_f32_16x16x64_bf16 v[4:7], v[48:51], v[168:175], v72
    v_and_or_b32 v0, v0, -2, s90
    buffer_store_dwordx2 v[0:1], v75, s[4:7], s27 offen offset:1536 sc1
    v_smfmac_f32_16x16x64_bf16 v[32:35], v[36:39], v[176:183], v72
    v_smfmac_f32_16x16x64_bf16 v[32:35], v[40:43], v[184:191], v72
    v_smfmac_f32_16x16x64_bf16 v[32:35], v[44:47], v[192:199], v72
    s_nop 2
    v_cvt_pk_bf16_f32 v4, v4, v5
    v_cvt_pk_bf16_f32 v5, v6, v7
    v_smfmac_f32_16x16x64_bf16 v[32:35], v[48:51], v[200:207], v72
    v_and_or_b32 v4, v4, -2, s90
    buffer_store_dwordx2 v[4:5], v75, s[4:7], s27 offen offset:3584 sc1
    v_smfmac_f32_16x16x64_bf16 v[60:63], v[36:39], v[208:215], v72
    v_smfmac_f32_16x16x64_bf16 v[60:63], v[40:43], v[216:223], v72
    v_smfmac_f32_16x16x64_bf16 v[60:63], v[44:47], v[224:231], v72
    s_nop 2
    v_cvt_pk_bf16_f32 v32, v32, v33
    v_cvt_pk_bf16_f32 v33, v34, v35
    v_smfmac_f32_16x16x64_bf16 v[60:63], v[48:51], v[232:239], v72
    v_and_or_b32 v32, v32, -2, s90
    buffer_store_dwordx2 v[32:33], v75, s[4:7], s31 offen offset:1536 sc1
    v_smfmac_f32_16x16x64_bf16 v[24:27], v[36:39], v[240:247], v72
    v_smfmac_f32_16x16x64_bf16 v[24:27], v[40:43], v[248:255], v72
    v_smfmac_f32_16x16x64_bf16 v[24:27], v[44:47], v[8:15], v72
    s_nop 2
    v_cvt_pk_bf16_f32 v60, v60, v61
    v_cvt_pk_bf16_f32 v61, v62, v63
    v_smfmac_f32_16x16x64_bf16 v[24:27], v[48:51], v[16:23], v72
    v_and_or_b32 v60, v60, -2, s90
    buffer_store_dwordx2 v[60:61], v75, s[4:7], s31 offen offset:3584 sc1
    s_nop 5
    v_cvt_pk_bf16_f32 v24, v24, v25
    v_cvt_pk_bf16_f32 v25, v26, v27
    v_and_or_b32 v24, v24, -2, s90
    buffer_store_dwordx2 v[24:25], v75, s[4:7], s38 offen offset:1536 sc1
    s_add_u32 s40, s20, 16384
    s_cmp_eq_u32 s40, 0x110000
    s_cselect_b32 s40, 0x100000, s40
    s_mov_b32 s20, s40
    s_xor_b32 s46, s46, 0x80000
    s_and_b32 s31, s18, 1
    s_xor_b32 s90, s90, s31
    s_add_u32 s18, s18, 1
    s_cmp_lt_u32 s18, s67
    s_cbranch_scc1 W3sc1_PRE
    s_branch REC_EXIT
W3sc1_RETRY1:
    s_mov_b64 exec, s[48:49]
    buffer_load_dwordx4 v[0:3], v73, s[4:7], s20 offen offset:0 sc1
    s_mov_b64 exec, s[50:51]
    buffer_load_dwordx4 v[4:7], v73, s[4:7], s20 offen offset:1024 sc1
    s_mov_b64 exec, s[52:53]
    buffer_load_dwordx4 v[8:11], v73, s[4:7], s20 offen offset:2048 sc1
    s_mov_b64 exec, -1
    s_sub_u32 s19, s19, 1
    s_cbranch_scc1 REC_FAIL
    s_branch W3sc1_CHK1
REC_EXIT:
    s_cmp_eq_u32 s66, 0
    s_cbranch_scc1 REC_DONE
    s_waitcnt vmcnt(0) lgkmcnt(0)
    s_barrier
    v_mbcnt_lo_u32_b32 v0, -1, 0
    v_mbcnt_hi_u32_b32 v0, -1, v0
    s_lshl_b32 s22, s17, 6
    v_add_u32 v0, s22, v0
WORKER:
    s_mov_b32 s21, s68
    s_load_dwordx2 s[4:5], s[0:1], 104
    s_mov_b32 s6, 268435456
    s_mov_b32 s7, 0x20000
    s_load_dwordx2 s[16:17], s[0:1], 0
    s_mov_b32 s18, 2359296
    s_mov_b32 s19, 0x20000
    v_lshrrev_b32 v1, 6, v0
    v_and_b32 v201, 63, v0
    v_readfirstlane_b32 s20, v1
    v_lshlrev_b32 v200, 4, v201
    s_mov_b32 s22, 300000
    s_load_dwordx2 s[8:9], s[0:1], 40
    s_mov_b32 s10, 4718592
    s_mov_b32 s11, 0x20000
    s_load_dwordx2 s[12:13], s[0:1], 16
    s_mov_b32 s14, 4718592
    s_mov_b32 s15, 0x20000
    s_waitcnt lgkmcnt(0)
    s_lshl_b32 s24, s21, 2
    s_add_u32 s24, s24, s20
    s_mul_i32 s24, s24, 5376
    v_lshlrev_b32 v2, 2, v200
    s_add_u32 s25, s24, 4096
    buffer_load_dword v252, v2, s[12:15], s24 offen
    buffer_load_dword v253, v2, s[12:15], s25 offen
    buffer_load_dword v250, v2, s[8:11], s24 offen
    buffer_load_dword v251, v2, s[8:11], s25 offen
    s_cmp_ge_u32 s21, 160
    s_cbranch_scc1 W_BB
    s_load_dwordx2 s[40:41], s[0:1], 16
    s_load_dwordx2 s[42:43], s[0:1], 24
    s_load_dwordx2 s[44:45], s[0:1], 32
    s_mov_b32 s10, 4718592
    s_mov_b32 s11, 0x20000
    s_mov_b32 s14, 4718592
    s_mov_b32 s15, 0x20000
    s_and_b32 s24, s21, 3
    s_mov_b32 s48, 16
    s_mov_b32 s49, 147456
    s_mov_b32 s50, 0x100000
    s_lshr_b32 s31, s21, 2
    s_lshr_b32 s32, s20, 1
    s_waitcnt lgkmcnt(0)
    s_cmp_ge_u32 s31, 32
    s_cbranch_scc1 G1Q_32
    s_mov_b32 s8, s42
    s_mov_b32 s9, s43
    s_mov_b32 s12, s44
    s_mov_b32 s13, s45
    s_lshl_b32 s46, s31, 8
    s_mov_b32 s47, s46
    s_mov_b32 s30, s32
    s_lshl_b32 s26, s31, 13
    s_mul_i32 s32, s32, 0x1000000
    s_add_u32 s26, s26, s32
    s_add_u32 s26, s26, 0x1000000
    s_branch G1E_33
G1Q_32:
    s_mov_b32 s8, s40
    s_mov_b32 s9, s41
    s_mov_b32 s12, s40
    s_mov_b32 s13, s41
    s_sub_u32 s31, s21, 128
    s_and_b32 s24, s31, 1
    s_lshr_b32 s31, s31, 1
    s_mov_b32 s48, 32
    s_mov_b32 s49, 73728
    s_mov_b32 s50, 0x80000
    s_lshl_b32 s46, s31, 9
    s_add_u32 s47, s46, 256
    s_mov_b32 s30, 0
    s_lshl_b32 s31, s31, 1
    s_add_u32 s31, s31, s32
    s_lshl_b32 s26, s31, 13
    s_add_u32 s26, s26, 0x3000000
G1E_33:
    s_lshl_b32 s31, s24, 18
    s_add_u32 s26, s26, s31
    s_and_b32 s31, s20, 1
    s_add_u32 s32, s30, 11
    s_lshl_b32 s31, s31, s32
    s_add_u32 s26, s26, s31
    s_lshl_b32 s27, s21, 7
    s_add_u32 s27, s27, 0x200000
    s_mul_i32 s25, s24, 36864
    v_and_b32 v1, 15, v201
    v_mul_u32_u24 v1, 1152, v1
    v_lshrrev_b32 v2, 4, v201
    v_lshl_add_u32 v202, v2, 4, v1
    s_lshr_b32 s34, s20, 1
    s_mul_i32 s34, s34, 18432
    s_and_b32 s35, s20, 1
    s_mul_i32 s35, s35, 576
    s_add_u32 s34, s34, s35
    s_mul_i32 s35, s20, 9216
    s_mov_b32 s29, 98304
    s_add_u32 s31, s25, s34
    s_add_u32 s32, s29, s35
    s_add_u32 m0, s32, 0
    s_nop 0
    buffer_load_dwordx4 v202, s[16:19], s31 offen lds
    s_add_u32 m0, s32, 1024
    s_add_u32 s31, s31, 64
    buffer_load_dwordx4 v202, s[16:19], s31 offen lds
    s_add_u32 m0, s32, 2048
    s_add_u32 s31, s31, 64
    buffer_load_dwordx4 v202, s[16:19], s31 offen lds
    s_add_u32 m0, s32, 3072
    s_add_u32 s31, s31, 64
    buffer_load_dwordx4 v202, s[16:19], s31 offen lds
    s_add_u32 m0, s32, 4096
    s_add_u32 s31, s31, 64
    buffer_load_dwordx4 v202, s[16:19], s31 offen lds
    s_add_u32 m0, s32, 5120
    s_add_u32 s31, s31, 64
    buffer_load_dwordx4 v202, s[16:19], s31 offen lds
    s_add_u32 m0, s32, 6144
    s_add_u32 s31, s31, 64
    buffer_load_dwordx4 v202, s[16:19], s31 offen lds
    s_add_u32 m0, s32, 7168
    s_add_u32 s31, s31, 64
    buffer_load_dwordx4 v202, s[16:19], s31 offen lds
    s_add_u32 m0, s32, 8192
    s_add_u32 s31, s31, 64
    buffer_load_dwordx4 v202, s[16:19], s31 offen lds
    v_and_b32 v1, 15, v201
    v_lshrrev_b32 v2, 4, v201
    v_bfe_u32 v3, v201, 2, 2
    v_and_b32 v4, 3, v201
    s_lshr_b32 s31, s20, 1
    s_lshl_b32 s31, s31, 2
    v_or_b32 v5, s31, v2
    v_lshlrev_b32 v5, 1, v5
    v_xor_b32 v5, v5, v1
    v_lshlrev_b32 v5, 4, v5
    v_lshl_add_u32 v5, v2, 13, v5
    s_lshl_b32 s31, s20, 15
    v_add_u32 v5, s31, v5
    v_add_u32 v8, s46, v5
    v_add_u32 v9, s47, v5
    v_and_b32 v6, 1, v2
    v_lshl_or_b32 v6, v6, 2, v3
    s_and_b32 s31, s20, 1
    s_lshl_b32 s31, s31, 2
    v_xor_b32 v6, s31, v6
    v_lshl_add_u32 v7, v2, 3, v3
    v_lshlrev_b32 v7, 8, v7
    v_lshl_add_u32 v7, v4, 3, v7
    s_lshr_b32 s31, s20, 1
    s_lshl_b32 s31, s31, 14
    v_add_u32 v7, s31, v7
    v_xor_b32 v10, 0, v6
    v_lshl_add_u32 v12, v10, 5, v7
    v_xor_b32 v10, 1, v6
    v_lshl_add_u32 v13, v10, 5, v7
    v_xor_b32 v10, 2, v6
    v_lshl_add_u32 v14, v10, 5, v7
    v_xor_b32 v10, 3, v6
    v_lshl_add_u32 v15, v10, 5, v7
    s_lshl_b32 s33, s20, 10
    s_add_u32 m0, s33, 0
    s_mov_b32 s31, 0
    buffer_load_dwordx4 v8, s[8:11], s31 offen lds
    s_add_u32 m0, s33, 4096
    s_mov_b32 s31, 131072
    buffer_load_dwordx4 v8, s[8:11], s31 offen lds
    s_add_u32 m0, s33, 8192
    s_mov_b32 s31, 262144
    buffer_load_dwordx4 v8, s[8:11], s31 offen lds
    s_add_u32 m0, s33, 12288
    s_mov_b32 s31, 393216
    buffer_load_dwordx4 v8, s[8:11], s31 offen lds
    s_add_u32 m0, s33, 16384
    s_mov_b32 s31, 0
    buffer_load_dwordx4 v9, s[12:15], s31 offen lds
    s_add_u32 m0, s33, 20480
    s_mov_b32 s31, 131072
    buffer_load_dwordx4 v9, s[12:15], s31 offen lds
    s_add_u32 m0, s33, 24576
    s_mov_b32 s31, 262144
    buffer_load_dwordx4 v9, s[12:15], s31 offen lds
    s_add_u32 m0, s33, 28672
    s_mov_b32 s31, 393216
    buffer_load_dwordx4 v9, s[12:15], s31 offen lds
    s_add_u32 m0, s33, 32768
    s_mov_b32 s31, 524288
    buffer_load_dwordx4 v8, s[8:11], s31 offen lds
    s_add_u32 m0, s33, 36864
    s_mov_b32 s31, 655360
    buffer_load_dwordx4 v8, s[8:11], s31 offen lds
    s_add_u32 m0, s33, 40960
    s_mov_b32 s31, 786432
    buffer_load_dwordx4 v8, s[8:11], s31 offen lds
    s_add_u32 m0, s33, 45056
    s_mov_b32 s31, 917504
    buffer_load_dwordx4 v8, s[8:11], s31 offen lds
    s_add_u32 m0, s33, 49152
    s_mov_b32 s31, 524288
    buffer_load_dwordx4 v9, s[12:15], s31 offen lds
    s_add_u32 m0, s33, 53248
    s_mov_b32 s31, 655360
    buffer_load_dwordx4 v9, s[12:15], s31 offen lds
    s_add_u32 m0, s33, 57344
    s_mov_b32 s31, 786432
    buffer_load_dwordx4 v9, s[12:15], s31 offen lds
    s_add_u32 m0, s33, 61440
    s_mov_b32 s31, 917504
    buffer_load_dwordx4 v9, s[12:15], s31 offen lds
    s_add_u32 m0, s33, 65536
    s_mov_b32 s31, 1048576
    buffer_load_dwordx4 v8, s[8:11], s31 offen lds
    s_add_u32 m0, s33, 69632
    s_mov_b32 s31, 1179648
    buffer_load_dwordx4 v8, s[8:11], s31 offen lds
    s_add_u32 m0, s33, 73728
    s_mov_b32 s31, 1310720
    buffer_load_dwordx4 v8, s[8:11], s31 offen lds
    s_add_u32 m0, s33, 77824
    s_mov_b32 s31, 1441792
    buffer_load_dwordx4 v8, s[8:11], s31 offen lds
    s_add_u32 m0, s33, 81920
    s_mov_b32 s31, 1048576
    buffer_load_dwordx4 v9, s[12:15], s31 offen lds
    s_add_u32 m0, s33, 86016
    s_mov_b32 s31, 1179648
    buffer_load_dwordx4 v9, s[12:15], s31 offen lds
    s_add_u32 m0, s33, 90112
    s_mov_b32 s31, 1310720
    buffer_load_dwordx4 v9, s[12:15], s31 offen lds
    s_add_u32 m0, s33, 94208
    s_mov_b32 s31, 1441792
    buffer_load_dwordx4 v9, s[12:15], s31 offen lds
    s_waitcnt vmcnt(16) lgkmcnt(0)
    s_barrier
    v_add_u32 v16, 0, v12
    v_add_u32 v17, 0, v13
    v_add_u32 v18, 0, v14
    v_add_u32 v19, 0, v15
    ds_read_b64_tr_b16 a[0:1], v16 offset:0
    ds_read_b64_tr_b16 a[2:3], v16 offset:1024
    ds_read_b64_tr_b16 a[72:73], v17 offset:0
    ds_read_b64_tr_b16 a[74:75], v17 offset:1024
    ds_read_b64_tr_b16 a[144:145], v18 offset:0
    ds_read_b64_tr_b16 a[146:147], v18 offset:1024
    ds_read_b64_tr_b16 a[216:217], v19 offset:0
    ds_read_b64_tr_b16 a[218:219], v19 offset:1024
    ds_read_b64_tr_b16 a[4:5], v16 offset:8192
    ds_read_b64_tr_b16 a[6:7], v16 offset:9216
    ds_read_b64_tr_b16 a[76:77], v17 offset:8192
    ds_read_b64_tr_b16 a[78:79], v17 offset:9216
    ds_read_b64_tr_b16 a[148:149], v18 offset:8192
    ds_read_b64_tr_b16 a[150:151], v18 offset:9216
    ds_read_b64_tr_b16 a[220:221], v19 offset:8192
    ds_read_b64_tr_b16 a[222:223], v19 offset:9216
    s_waitcnt vmcnt(8) lgkmcnt(0)
    s_barrier
    s_add_u32 m0, s33, 0
    s_mov_b32 s31, 1572864
    buffer_load_dwordx4 v8, s[8:11], s31 offen lds
    s_add_u32 m0, s33, 4096
    s_mov_b32 s31, 1703936
    buffer_load_dwordx4 v8, s[8:11], s31 offen lds
    s_add_u32 m0, s33, 8192
    s_mov_b32 s31, 1835008
    buffer_load_dwordx4 v8, s[8:11], s31 offen lds
    s_add_u32 m0, s33, 12288
    s_mov_b32 s31, 1966080
    buffer_load_dwordx4 v8, s[8:11], s31 offen lds
    s_add_u32 m0, s33, 16384
    s_mov_b32 s31, 1572864
    buffer_load_dwordx4 v9, s[12:15], s31 offen lds
    s_add_u32 m0, s33, 20480
    s_mov_b32 s31, 1703936
    buffer_load_dwordx4 v9, s[12:15], s31 offen lds
    s_add_u32 m0, s33, 24576
    s_mov_b32 s31, 1835008
    buffer_load_dwordx4 v9, s[12:15], s31 offen lds
    s_add_u32 m0, s33, 28672
    s_mov_b32 s31, 1966080
    buffer_load_dwordx4 v9, s[12:15], s31 offen lds
    v_add_u32 v16, 32768, v12
    v_add_u32 v17, 32768, v13
    v_add_u32 v18, 32768, v14
    v_add_u32 v19, 32768, v15
    ds_read_b64_tr_b16 a[8:9], v16 offset:0
    ds_read_b64_tr_b16 a[10:11], v16 offset:1024
    ds_read_b64_tr_b16 a[80:81], v17 offset:0
    ds_read_b64_tr_b16 a[82:83], v17 offset:1024
    ds_read_b64_tr_b16 a[152:153], v18 offset:0
    ds_read_b64_tr_b16 a[154:155], v18 offset:1024
    ds_read_b64_tr_b16 a[224:225], v19 offset:0
    ds_read_b64_tr_b16 a[226:227], v19 offset:1024
    ds_read_b64_tr_b16 a[12:13], v16 offset:8192
    ds_read_b64_tr_b16 a[14:15], v16 offset:9216
    ds_read_b64_tr_b16 a[84:85], v17 offset:8192
    ds_read_b64_tr_b16 a[86:87], v17 offset:9216
    ds_read_b64_tr_b16 a[156:157], v18 offset:8192
    ds_read_b64_tr_b16 a[158:159], v18 offset:9216
    ds_read_b64_tr_b16 a[228:229], v19 offset:8192
    ds_read_b64_tr_b16 a[230:231], v19 offset:9216
    s_waitcnt vmcnt(8) lgkmcnt(0)
    s_barrier
    s_add_u32 m0, s33, 32768
    s_mov_b32 s31, 2097152
    buffer_load_dwordx4 v8, s[8:11], s31 offen lds
    s_add_u32 m0, s33, 36864
    s_mov_b32 s31, 2228224
    buffer_load_dwordx4 v8, s[8:11], s31 offen lds
    s_add_u32 m0, s33, 40960
    s_mov_b32 s31, 2359296
    buffer_load_dwordx4 v8, s[8:11], s31 offen lds
    s_add_u32 m0, s33, 45056
    s_mov_b32 s31, 2490368
    buffer_load_dwordx4 v8, s[8:11], s31 offen lds
    s_add_u32 m0, s33, 49152
    s_mov_b32 s31, 2097152
    buffer_load_dwordx4 v9, s[12:15], s31 offen lds
    s_add_u32 m0, s33, 53248
    s_mov_b32 s31, 2228224
    buffer_load_dwordx4 v9, s[12:15], s31 offen lds
    s_add_u32 m0, s33, 57344
    s_mov_b32 s31, 2359296
    buffer_load_dwordx4 v9, s[12:15], s31 offen lds
    s_add_u32 m0, s33, 61440
    s_mov_b32 s31, 2490368
    buffer_load_dwordx4 v9, s[12:15], s31 offen lds
    v_add_u32 v16, 65536, v12
    v_add_u32 v17, 65536, v13
    v_add_u32 v18, 65536, v14
    v_add_u32 v19, 65536, v15
    ds_read_b64_tr_b16 a[16:17], v16 offset:0
    ds_read_b64_tr_b16 a[18:19], v16 offset:1024
    ds_read_b64_tr_b16 a[88:89], v17 offset:0
    ds_read_b64_tr_b16 a[90:91], v17 offset:1024
    ds_read_b64_tr_b16 a[160:161], v18 offset:0
    ds_read_b64_tr_b16 a[162:163], v18 offset:1024
    ds_read_b64_tr_b16 a[232:233], v19 offset:0
    ds_read_b64_tr_b16 a[234:235], v19 offset:1024
    ds_read_b64_tr_b16 a[20:21], v16 offset:8192
    ds_read_b64_tr_b16 a[22:23], v16 offset:9216
    ds_read_b64_tr_b16 a[92:93], v17 offset:8192
    ds_read_b64_tr_b16 a[94:95], v17 offset:9216
    ds_read_b64_tr_b16 a[164:165], v18 offset:8192
    ds_read_b64_tr_b16 a[166:167], v18 offset:9216
    ds_read_b64_tr_b16 a[236:237], v19 offset:8192
    ds_read_b64_tr_b16 a[238:239], v19 offset:9216
    s_waitcnt vmcnt(8) lgkmcnt(0)
    s_barrier
    s_add_u32 m0, s33, 65536
    s_mov_b32 s31, 2621440
    buffer_load_dwordx4 v8, s[8:11], s31 offen lds
    s_add_u32 m0, s33, 69632
    s_mov_b32 s31, 2752512
    buffer_load_dwordx4 v8, s[8:11], s31 offen lds
    s_add_u32 m0, s33, 73728
    s_mov_b32 s31, 2883584
    buffer_load_dwordx4 v8, s[8:11], s31 offen lds
    s_add_u32 m0, s33, 77824
    s_mov_b32 s31, 3014656
    buffer_load_dwordx4 v8, s[8:11], s31 offen lds
    s_add_u32 m0, s33, 81920
    s_mov_b32 s31, 2621440
    buffer_load_dwordx4 v9, s[12:15], s31 offen lds
    s_add_u32 m0, s33, 86016
    s_mov_b32 s31, 2752512
    buffer_load_dwordx4 v9, s[12:15], s31 offen lds
    s_add_u32 m0, s33, 90112
    s_mov_b32 s31, 2883584
    buffer_load_dwordx4 v9, s[12:15], s31 offen lds
    s_add_u32 m0, s33, 94208
    s_mov_b32 s31, 3014656
    buffer_load_dwordx4 v9, s[12:15], s31 offen lds
    v_add_u32 v16, 0, v12
    v_add_u32 v17, 0, v13
    v_add_u32 v18, 0, v14
    v_add_u32 v19, 0, v15
    ds_read_b64_tr_b16 a[24:25], v16 offset:0
    ds_read_b64_tr_b16 a[26:27], v16 offset:1024
    ds_read_b64_tr_b16 a[96:97], v17 offset:0
    ds_read_b64_tr_b16 a[98:99], v17 offset:1024
    ds_read_b64_tr_b16 a[168:169], v18 offset:0
    ds_read_b64_tr_b16 a[170:171], v18 offset:1024
    ds_read_b64_tr_b16 a[240:241], v19 offset:0
    ds_read_b64_tr_b16 a[242:243], v19 offset:1024
    ds_read_b64_tr_b16 a[28:29], v16 offset:8192
    ds_read_b64_tr_b16 a[30:31], v16 offset:9216
    ds_read_b64_tr_b16 a[100:101], v17 offset:8192
    ds_read_b64_tr_b16 a[102:103], v17 offset:9216
    ds_read_b64_tr_b16 a[172:173], v18 offset:8192
    ds_read_b64_tr_b16 a[174:175], v18 offset:9216
    ds_read_b64_tr_b16 a[244:245], v19 offset:8192
    ds_read_b64_tr_b16 a[246:247], v19 offset:9216
    s_waitcnt vmcnt(8) lgkmcnt(0)
    s_barrier
    s_add_u32 m0, s33, 0
    s_mov_b32 s31, 3145728
    buffer_load_dwordx4 v8, s[8:11], s31 offen lds
    s_add_u32 m0, s33, 4096
    s_mov_b32 s31, 3276800
    buffer_load_dwordx4 v8, s[8:11], s31 offen lds
    s_add_u32 m0, s33, 8192
    s_mov_b32 s31, 3407872
    buffer_load_dwordx4 v8, s[8:11], s31 offen lds
    s_add_u32 m0, s33, 12288
    s_mov_b32 s31, 3538944
    buffer_load_dwordx4 v8, s[8:11], s31 offen lds
    s_add_u32 m0, s33, 16384
    s_mov_b32 s31, 3145728
    buffer_load_dwordx4 v9, s[12:15], s31 offen lds
    s_add_u32 m0, s33, 20480
    s_mov_b32 s31, 3276800
    buffer_load_dwordx4 v9, s[12:15], s31 offen lds
    s_add_u32 m0, s33, 24576
    s_mov_b32 s31, 3407872
    buffer_load_dwordx4 v9, s[12:15], s31 offen lds
    s_add_u32 m0, s33, 28672
    s_mov_b32 s31, 3538944
    buffer_load_dwordx4 v9, s[12:15], s31 offen lds
    v_add_u32 v16, 32768, v12
    v_add_u32 v17, 32768, v13
    v_add_u32 v18, 32768, v14
    v_add_u32 v19, 32768, v15
    ds_read_b64_tr_b16 a[32:33], v16 offset:0
    ds_read_b64_tr_b16 a[34:35], v16 offset:1024
    ds_read_b64_tr_b16 a[104:105], v17 offset:0
    ds_read_b64_tr_b16 a[106:107], v17 offset:1024
    ds_read_b64_tr_b16 a[176:177], v18 offset:0
    ds_read_b64_tr_b16 a[178:179], v18 offset:1024
    ds_read_b64_tr_b16 a[248:249], v19 offset:0
    ds_read_b64_tr_b16 a[250:251], v19 offset:1024
    ds_read_b64_tr_b16 a[36:37], v16 offset:8192
    ds_read_b64_tr_b16 a[38:39], v16 offset:9216
    ds_read_b64_tr_b16 a[108:109], v17 offset:8192
    ds_read_b64_tr_b16 a[110:111], v17 offset:9216
    ds_read_b64_tr_b16 a[180:181], v18 offset:8192
    ds_read_b64_tr_b16 a[182:183], v18 offset:9216
    ds_read_b64_tr_b16 a[252:253], v19 offset:8192
    ds_read_b64_tr_b16 a[254:255], v19 offset:9216
    s_waitcnt vmcnt(8) lgkmcnt(0)
    s_barrier
    s_add_u32 m0, s33, 32768
    s_mov_b32 s31, 3670016
    buffer_load_dwordx4 v8, s[8:11], s31 offen lds
    s_add_u32 m0, s33, 36864
    s_mov_b32 s31, 3801088
    buffer_load_dwordx4 v8, s[8:11], s31 offen lds
    s_add_u32 m0, s33, 40960
    s_mov_b32 s31, 3932160
    buffer_load_dwordx4 v8, s[8:11], s31 offen lds
    s_add_u32 m0, s33, 45056
    s_mov_b32 s31, 4063232
    buffer_load_dwordx4 v8, s[8:11], s31 offen lds
    s_add_u32 m0, s33, 49152
    s_mov_b32 s31, 3670016
    buffer_load_dwordx4 v9, s[12:15], s31 offen lds
    s_add_u32 m0, s33, 53248
    s_mov_b32 s31, 3801088
    buffer_load_dwordx4 v9, s[12:15], s31 offen lds
    s_add_u32 m0, s33, 57344
    s_mov_b32 s31, 3932160
    buffer_load_dwordx4 v9, s[12:15], s31 offen lds
    s_add_u32 m0, s33, 61440
    s_mov_b32 s31, 4063232
    buffer_load_dwordx4 v9, s[12:15], s31 offen lds
    v_add_u32 v16, 65536, v12
    v_add_u32 v17, 65536, v13
    v_add_u32 v18, 65536, v14
    v_add_u32 v19, 65536, v15
    ds_read_b64_tr_b16 a[40:41], v16 offset:0
    ds_read_b64_tr_b16 a[42:43], v16 offset:1024
    ds_read_b64_tr_b16 a[112:113], v17 offset:0
    ds_read_b64_tr_b16 a[114:115], v17 offset:1024
    ds_read_b64_tr_b16 a[184:185], v18 offset:0
    ds_read_b64_tr_b16 a[186:187], v18 offset:1024
    ds_read_b64_tr_b16 v[208:209], v19 offset:0
    ds_read_b64_tr_b16 v[210:211], v19 offset:1024
    ds_read_b64_tr_b16 a[44:45], v16 offset:8192
    ds_read_b64_tr_b16 a[46:47], v16 offset:9216
    ds_read_b64_tr_b16 a[116:117], v17 offset:8192
    ds_read_b64_tr_b16 a[118:119], v17 offset:9216
    ds_read_b64_tr_b16 a[188:189], v18 offset:8192
    ds_read_b64_tr_b16 a[190:191], v18 offset:9216
    ds_read_b64_tr_b16 v[212:213], v19 offset:8192
    ds_read_b64_tr_b16 v[214:215], v19 offset:9216
    s_waitcnt vmcnt(8) lgkmcnt(0)
    s_barrier
    s_add_u32 m0, s33, 65536
    s_mov_b32 s31, 4194304
    buffer_load_dwordx4 v8, s[8:11], s31 offen lds
    s_add_u32 m0, s33, 69632
    s_mov_b32 s31, 4325376
    buffer_load_dwordx4 v8, s[8:11], s31 offen lds
    s_add_u32 m0, s33, 73728
    s_mov_b32 s31, 4456448
    buffer_load_dwordx4 v8, s[8:11], s31 offen lds
    s_add_u32 m0, s33, 77824
    s_mov_b32 s31, 4587520
    buffer_load_dwordx4 v8, s[8:11], s31 offen lds
    s_add_u32 m0, s33, 81920
    s_mov_b32 s31, 4194304
    buffer_load_dwordx4 v9, s[12:15], s31 offen lds
    s_add_u32 m0, s33, 86016
    s_mov_b32 s31, 4325376
    buffer_load_dwordx4 v9, s[12:15], s31 offen lds
    s_add_u32 m0, s33, 90112
    s_mov_b32 s31, 4456448
    buffer_load_dwordx4 v9, s[12:15], s31 offen lds
    s_add_u32 m0, s33, 94208
    s_mov_b32 s31, 4587520
    buffer_load_dwordx4 v9, s[12:15], s31 offen lds
    v_add_u32 v16, 0, v12
    v_add_u32 v17, 0, v13
    v_add_u32 v18, 0, v14
    v_add_u32 v19, 0, v15
    ds_read_b64_tr_b16 a[48:49], v16 offset:0
    ds_read_b64_tr_b16 a[50:51], v16 offset:1024
    ds_read_b64_tr_b16 a[120:121], v17 offset:0
    ds_read_b64_tr_b16 a[122:123], v17 offset:1024
    ds_read_b64_tr_b16 a[192:193], v18 offset:0
    ds_read_b64_tr_b16 a[194:195], v18 offset:1024
    ds_read_b64_tr_b16 v[216:217], v19 offset:0
    ds_read_b64_tr_b16 v[218:219], v19 offset:1024
    ds_read_b64_tr_b16 a[52:53], v16 offset:8192
    ds_read_b64_tr_b16 a[54:55], v16 offset:9216
    ds_read_b64_tr_b16 a[124:125], v17 offset:8192
    ds_read_b64_tr_b16 a[126:127], v17 offset:9216
    ds_read_b64_tr_b16 a[196:197], v18 offset:8192
    ds_read_b64_tr_b16 a[198:199], v18 offset:9216
    ds_read_b64_tr_b16 v[220:221], v19 offset:8192
    ds_read_b64_tr_b16 v[222:223], v19 offset:9216
    s_waitcnt vmcnt(8) lgkmcnt(0)
    s_barrier
    v_add_u32 v16, 32768, v12
    v_add_u32 v17, 32768, v13
    v_add_u32 v18, 32768, v14
    v_add_u32 v19, 32768, v15
    ds_read_b64_tr_b16 a[56:57], v16 offset:0
    ds_read_b64_tr_b16 a[58:59], v16 offset:1024
    ds_read_b64_tr_b16 a[128:129], v17 offset:0
    ds_read_b64_tr_b16 a[130:131], v17 offset:1024
    ds_read_b64_tr_b16 a[200:201], v18 offset:0
    ds_read_b64_tr_b16 a[202:203], v18 offset:1024
    ds_read_b64_tr_b16 v[224:225], v19 offset:0
    ds_read_b64_tr_b16 v[226:227], v19 offset:1024
    ds_read_b64_tr_b16 a[60:61], v16 offset:8192
    ds_read_b64_tr_b16 a[62:63], v16 offset:9216
    ds_read_b64_tr_b16 a[132:133], v17 offset:8192
    ds_read_b64_tr_b16 a[134:135], v17 offset:9216
    ds_read_b64_tr_b16 a[204:205], v18 offset:8192
    ds_read_b64_tr_b16 a[206:207], v18 offset:9216
    ds_read_b64_tr_b16 v[228:229], v19 offset:8192
    ds_read_b64_tr_b16 v[230:231], v19 offset:9216
    s_waitcnt vmcnt(0) lgkmcnt(0)
    s_barrier
    v_add_u32 v16, 65536, v12
    v_add_u32 v17, 65536, v13
    v_add_u32 v18, 65536, v14
    v_add_u32 v19, 65536, v15
    ds_read_b64_tr_b16 a[64:65], v16 offset:0
    ds_read_b64_tr_b16 a[66:67], v16 offset:1024
    ds_read_b64_tr_b16 a[136:137], v17 offset:0
    ds_read_b64_tr_b16 a[138:139], v17 offset:1024
    ds_read_b64_tr_b16 a[208:209], v18 offset:0
    ds_read_b64_tr_b16 a[210:211], v18 offset:1024
    ds_read_b64_tr_b16 v[232:233], v19 offset:0
    ds_read_b64_tr_b16 v[234:235], v19 offset:1024
    ds_read_b64_tr_b16 a[68:69], v16 offset:8192
    ds_read_b64_tr_b16 a[70:71], v16 offset:9216
    ds_read_b64_tr_b16 a[140:141], v17 offset:8192
    ds_read_b64_tr_b16 a[142:143], v17 offset:9216
    ds_read_b64_tr_b16 a[212:213], v18 offset:8192
    ds_read_b64_tr_b16 a[214:215], v18 offset:9216
    ds_read_b64_tr_b16 v[236:237], v19 offset:8192
    ds_read_b64_tr_b16 v[238:239], v19 offset:9216
    s_load_dwordx2 s[60:61], s[0:1], 96
    s_mov_b32 s62, 256
    s_mov_b32 s63, 0x20000
    v_mov_b32 v21, 0
    s_waitcnt lgkmcnt(0)
WI_34:
    buffer_load_dword v20, v21, s[60:63], 0 offen offset:128 sc1
    s_waitcnt vmcnt(0)
    v_readfirstlane_b32 s64, v20
    s_sub_u32 s22, s22, 1
    s_cbranch_scc1 W_FAIL
    s_cmp_lt_u32 s64, 256
    s_cbranch_scc1 WI_34
    s_mov_b32 s28, 0
    v_mov_b32 v203, 0
    s_waitcnt vmcnt(0) lgkmcnt(0)
    s_cmp_lg_u32 s30, 0
    s_cbranch_scc1 G1V_35
G1L_36:
    s_waitcnt vmcnt(4)
    s_cmp_lg_u32 s28, 1
    s_cbranch_scc1 G1F_37
    s_waitcnt vmcnt(0)
G1F_37:
    s_barrier
    s_max_u32 s31, s28, 2
    s_sub_u32 s31, s31, 1
    s_min_u32 s31, s31, s28
    v_mov_b32 v204, s31
    s_mov_b64 exec, 1
    buffer_store_dword v204, v203, s[4:7], s27 offen sc1
    s_mov_b64 exec, -1
    v_add_u32 v205, s29, v200
    s_add_u32 s25, s25, s49
    s_xor_b32 s29, s29, 98304
    s_add_u32 s31, s25, s34
    s_add_u32 s32, s29, s35
    s_add_u32 m0, s32, 0
    s_nop 0
    buffer_load_dwordx4 v202, s[16:19], s31 offen lds
    s_add_u32 m0, s32, 1024
    s_add_u32 s31, s31, 64
    buffer_load_dwordx4 v202, s[16:19], s31 offen lds
    s_add_u32 m0, s32, 2048
    s_add_u32 s31, s31, 64
    buffer_load_dwordx4 v202, s[16:19], s31 offen lds
    s_add_u32 m0, s32, 3072
    s_add_u32 s31, s31, 64
    buffer_load_dwordx4 v202, s[16:19], s31 offen lds
    s_add_u32 m0, s32, 4096
    s_add_u32 s31, s31, 64
    buffer_load_dwordx4 v202, s[16:19], s31 offen lds
    s_add_u32 m0, s32, 5120
    s_add_u32 s31, s31, 64
    buffer_load_dwordx4 v202, s[16:19], s31 offen lds
    s_add_u32 m0, s32, 6144
    s_add_u32 s31, s31, 64
    buffer_load_dwordx4 v202, s[16:19], s31 offen lds
    s_add_u32 m0, s32, 7168
    s_add_u32 s31, s31, 64
    buffer_load_dwordx4 v202, s[16:19], s31 offen lds
    s_add_u32 m0, s32, 8192
    s_add_u32 s31, s31, 64
    buffer_load_dwordx4 v202, s[16:19], s31 offen lds
    ds_read_b128 v[40:43], v205 offset:0
    ds_read_b128 v[44:47], v205 offset:1024
    ds_read_b128 v[48:51], v205 offset:2048
    ds_read_b128 v[52:55], v205 offset:3072
    ds_read_b128 v[56:59], v205 offset:4096
    ds_read_b128 v[60:63], v205 offset:5120
    s_waitcnt lgkmcnt(5)
    v_mfma_f32_16x16x32_bf16 v[0:3], a[0:3], v[40:43], 0
    v_mfma_f32_16x16x32_bf16 v[4:7], a[72:75], v[40:43], 0
    v_mfma_f32_16x16x32_bf16 v[8:11], a[144:147], v[40:43], 0
    v_mfma_f32_16x16x32_bf16 v[12:15], a[216:219], v[40:43], 0
    s_waitcnt lgkmcnt(4)
    v_mfma_f32_16x16x32_bf16 v[0:3], a[4:7], v[44:47], v[0:3]
    ds_read_b128 v[40:43], v205 offset:6144
    v_mfma_f32_16x16x32_bf16 v[4:7], a[76:79], v[44:47], v[4:7]
    v_mfma_f32_16x16x32_bf16 v[8:11], a[148:151], v[44:47], v[8:11]
    v_mfma_f32_16x16x32_bf16 v[12:15], a[220:223], v[44:47], v[12:15]
    s_waitcnt lgkmcnt(4)
    v_mfma_f32_16x16x32_bf16 v[0:3], a[8:11], v[48:51], v[0:3]
    ds_read_b128 v[44:47], v205 offset:7168
    v_mfma_f32_16x16x32_bf16 v[4:7], a[80:83], v[48:51], v[4:7]
    v_mfma_f32_16x16x32_bf16 v[8:11], a[152:155], v[48:51], v[8:11]
    v_mfma_f32_16x16x32_bf16 v[12:15], a[224:227], v[48:51], v[12:15]
    s_waitcnt lgkmcnt(4)
    v_mfma_f32_16x16x32_bf16 v[0:3], a[12:15], v[52:55], v[0:3]
    ds_read_b128 v[48:51], v205 offset:8192
    v_mfma_f32_16x16x32_bf16 v[4:7], a[84:87], v[52:55], v[4:7]
    v_mfma_f32_16x16x32_bf16 v[8:11], a[156:159], v[52:55], v[8:11]
    v_mfma_f32_16x16x32_bf16 v[12:15], a[228:231], v[52:55], v[12:15]
    s_waitcnt lgkmcnt(4)
    v_mfma_f32_16x16x32_bf16 v[0:3], a[16:19], v[56:59], v[0:3]
    ds_read_b128 v[52:55], v205 offset:9216
    v_mfma_f32_16x16x32_bf16 v[4:7], a[88:91], v[56:59], v[4:7]
    v_mfma_f32_16x16x32_bf16 v[8:11], a[160:163], v[56:59], v[8:11]
    v_mfma_f32_16x16x32_bf16 v[12:15], a[232:235], v[56:59], v[12:15]
    s_waitcnt lgkmcnt(4)
    v_mfma_f32_16x16x32_bf16 v[0:3], a[20:23], v[60:63], v[0:3]
    ds_read_b128 v[56:59], v205 offset:10240
    v_mfma_f32_16x16x32_bf16 v[4:7], a[92:95], v[60:63], v[4:7]
    v_mfma_f32_16x16x32_bf16 v[8:11], a[164:167], v[60:63], v[8:11]
    v_mfma_f32_16x16x32_bf16 v[12:15], a[236:239], v[60:63], v[12:15]
    s_waitcnt lgkmcnt(4)
    v_mfma_f32_16x16x32_bf16 v[0:3], a[24:27], v[40:43], v[0:3]
    ds_read_b128 v[60:63], v205 offset:11264
    v_mfma_f32_16x16x32_bf16 v[4:7], a[96:99], v[40:43], v[4:7]
    v_mfma_f32_16x16x32_bf16 v[8:11], a[168:171], v[40:43], v[8:11]
    v_mfma_f32_16x16x32_bf16 v[12:15], a[240:243], v[40:43], v[12:15]
    s_waitcnt lgkmcnt(4)
    v_mfma_f32_16x16x32_bf16 v[0:3], a[28:31], v[44:47], v[0:3]
    ds_read_b128 v[40:43], v205 offset:12288
    v_mfma_f32_16x16x32_bf16 v[4:7], a[100:103], v[44:47], v[4:7]
    v_mfma_f32_16x16x32_bf16 v[8:11], a[172:175], v[44:47], v[8:11]
    v_mfma_f32_16x16x32_bf16 v[12:15], a[244:247], v[44:47], v[12:15]
    s_waitcnt lgkmcnt(4)
    v_mfma_f32_16x16x32_bf16 v[0:3], a[32:35], v[48:51], v[0:3]
    ds_read_b128 v[44:47], v205 offset:13312
    v_mfma_f32_16x16x32_bf16 v[4:7], a[104:107], v[48:51], v[4:7]
    v_mfma_f32_16x16x32_bf16 v[8:11], a[176:179], v[48:51], v[8:11]
    v_mfma_f32_16x16x32_bf16 v[12:15], a[248:251], v[48:51], v[12:15]
    s_waitcnt lgkmcnt(4)
    v_mfma_f32_16x16x32_bf16 v[0:3], a[36:39], v[52:55], v[0:3]
    ds_read_b128 v[48:51], v205 offset:14336
    v_mfma_f32_16x16x32_bf16 v[4:7], a[108:111], v[52:55], v[4:7]
    v_mfma_f32_16x16x32_bf16 v[8:11], a[180:183], v[52:55], v[8:11]
    v_mfma_f32_16x16x32_bf16 v[12:15], a[252:255], v[52:55], v[12:15]
    s_waitcnt lgkmcnt(4)
    v_mfma_f32_16x16x32_bf16 v[0:3], a[40:43], v[56:59], v[0:3]
    ds_read_b128 v[52:55], v205 offset:15360
    v_mfma_f32_16x16x32_bf16 v[4:7], a[112:115], v[56:59], v[4:7]
    v_mfma_f32_16x16x32_bf16 v[8:11], a[184:187], v[56:59], v[8:11]
    v_mfma_f32_16x16x32_bf16 v[12:15], v[208:211], v[56:59], v[12:15]
    s_waitcnt lgkmcnt(4)
    v_mfma_f32_16x16x32_bf16 v[0:3], a[44:47], v[60:63], v[0:3]
    ds_read_b128 v[56:59], v205 offset:16384
    v_mfma_f32_16x16x32_bf16 v[4:7], a[116:119], v[60:63], v[4:7]
    v_mfma_f32_16x16x32_bf16 v[8:11], a[188:191], v[60:63], v[8:11]
    v_mfma_f32_16x16x32_bf16 v[12:15], v[212:215], v[60:63], v[12:15]
    s_waitcnt lgkmcnt(4)
    v_mfma_f32_16x16x32_bf16 v[0:3], a[48:51], v[40:43], v[0:3]
    ds_read_b128 v[60:63], v205 offset:17408
    v_mfma_f32_16x16x32_bf16 v[4:7], a[120:123], v[40:43], v[4:7]
    v_mfma_f32_16x16x32_bf16 v[8:11], a[192:195], v[40:43], v[8:11]
    v_mfma_f32_16x16x32_bf16 v[12:15], v[216:219], v[40:43], v[12:15]
    s_waitcnt lgkmcnt(4)
    v_mfma_f32_16x16x32_bf16 v[0:3], a[52:55], v[44:47], v[0:3]
    ds_read_b128 v[40:43], v205 offset:18432
    v_mfma_f32_16x16x32_bf16 v[4:7], a[124:127], v[44:47], v[4:7]
    v_mfma_f32_16x16x32_bf16 v[8:11], a[196:199], v[44:47], v[8:11]
    v_mfma_f32_16x16x32_bf16 v[12:15], v[220:223], v[44:47], v[12:15]
    s_waitcnt lgkmcnt(4)
    v_mfma_f32_16x16x32_bf16 v[0:3], a[56:59], v[48:51], v[0:3]
    ds_read_b128 v[44:47], v205 offset:19456
    v_mfma_f32_16x16x32_bf16 v[4:7], a[128:131], v[48:51], v[4:7]
    v_mfma_f32_16x16x32_bf16 v[8:11], a[200:203], v[48:51], v[8:11]
    v_mfma_f32_16x16x32_bf16 v[12:15], v[224:227], v[48:51], v[12:15]
    s_waitcnt lgkmcnt(4)
    v_mfma_f32_16x16x32_bf16 v[0:3], a[60:63], v[52:55], v[0:3]
    ds_read_b128 v[48:51], v205 offset:20480
    v_mfma_f32_16x16x32_bf16 v[4:7], a[132:135], v[52:55], v[4:7]
    v_mfma_f32_16x16x32_bf16 v[8:11], a[204:207], v[52:55], v[8:11]
    v_mfma_f32_16x16x32_bf16 v[12:15], v[228:231], v[52:55], v[12:15]
    s_waitcnt lgkmcnt(4)
    v_mfma_f32_16x16x32_bf16 v[0:3], a[64:67], v[56:59], v[0:3]
    ds_read_b128 v[52:55], v205 offset:21504
    v_mfma_f32_16x16x32_bf16 v[4:7], a[136:139], v[56:59], v[4:7]
    v_mfma_f32_16x16x32_bf16 v[8:11], a[208:211], v[56:59], v[8:11]
    v_mfma_f32_16x16x32_bf16 v[12:15], v[232:235], v[56:59], v[12:15]
    s_waitcnt lgkmcnt(4)
    v_mfma_f32_16x16x32_bf16 v[0:3], a[68:71], v[60:63], v[0:3]
    ds_read_b128 v[56:59], v205 offset:22528
    v_mfma_f32_16x16x32_bf16 v[4:7], a[140:143], v[60:63], v[4:7]
    v_mfma_f32_16x16x32_bf16 v[8:11], a[212:215], v[60:63], v[8:11]
    v_mfma_f32_16x16x32_bf16 v[12:15], v[236:239], v[60:63], v[12:15]
    s_waitcnt lgkmcnt(4)
    v_mfma_f32_16x16x32_bf16 v[16:19], a[0:3], v[40:43], 0
    ds_read_b128 v[60:63], v205 offset:23552
    v_mfma_f32_16x16x32_bf16 v[20:23], a[72:75], v[40:43], 0
    v_mfma_f32_16x16x32_bf16 v[24:27], a[144:147], v[40:43], 0
    v_mfma_f32_16x16x32_bf16 v[28:31], a[216:219], v[40:43], 0
    s_waitcnt lgkmcnt(4)
    v_mfma_f32_16x16x32_bf16 v[16:19], a[4:7], v[44:47], v[16:19]
    ds_read_b128 v[40:43], v205 offset:24576
    v_mfma_f32_16x16x32_bf16 v[20:23], a[76:79], v[44:47], v[20:23]
    v_mfma_f32_16x16x32_bf16 v[24:27], a[148:151], v[44:47], v[24:27]
    v_mfma_f32_16x16x32_bf16 v[28:31], a[220:223], v[44:47], v[28:31]
    s_waitcnt lgkmcnt(4)
    v_mfma_f32_16x16x32_bf16 v[16:19], a[8:11], v[48:51], v[16:19]
    ds_read_b128 v[44:47], v205 offset:25600
    v_mfma_f32_16x16x32_bf16 v[20:23], a[80:83], v[48:51], v[20:23]
    v_mfma_f32_16x16x32_bf16 v[24:27], a[152:155], v[48:51], v[24:27]
    v_mfma_f32_16x16x32_bf16 v[28:31], a[224:227], v[48:51], v[28:31]
    s_waitcnt lgkmcnt(4)
    v_mfma_f32_16x16x32_bf16 v[16:19], a[12:15], v[52:55], v[16:19]
    ds_read_b128 v[48:51], v205 offset:26624
    v_mfma_f32_16x16x32_bf16 v[20:23], a[84:87], v[52:55], v[20:23]
    v_mfma_f32_16x16x32_bf16 v[24:27], a[156:159], v[52:55], v[24:27]
    v_mfma_f32_16x16x32_bf16 v[28:31], a[228:231], v[52:55], v[28:31]
    s_waitcnt lgkmcnt(4)
    v_mfma_f32_16x16x32_bf16 v[16:19], a[16:19], v[56:59], v[16:19]
    ds_read_b128 v[52:55], v205 offset:27648
    v_mfma_f32_16x16x32_bf16 v[20:23], a[88:91], v[56:59], v[20:23]
    v_mfma_f32_16x16x32_bf16 v[24:27], a[160:163], v[56:59], v[24:27]
    v_mfma_f32_16x16x32_bf16 v[28:31], a[232:235], v[56:59], v[28:31]
    s_waitcnt lgkmcnt(4)
    v_mfma_f32_16x16x32_bf16 v[16:19], a[20:23], v[60:63], v[16:19]
    ds_read_b128 v[56:59], v205 offset:28672
    v_mfma_f32_16x16x32_bf16 v[20:23], a[92:95], v[60:63], v[20:23]
    v_mfma_f32_16x16x32_bf16 v[24:27], a[164:167], v[60:63], v[24:27]
    v_mfma_f32_16x16x32_bf16 v[28:31], a[236:239], v[60:63], v[28:31]
    s_waitcnt lgkmcnt(4)
    v_mfma_f32_16x16x32_bf16 v[16:19], a[24:27], v[40:43], v[16:19]
    ds_read_b128 v[60:63], v205 offset:29696
    v_mfma_f32_16x16x32_bf16 v[20:23], a[96:99], v[40:43], v[20:23]
    v_mfma_f32_16x16x32_bf16 v[24:27], a[168:171], v[40:43], v[24:27]
    v_mfma_f32_16x16x32_bf16 v[28:31], a[240:243], v[40:43], v[28:31]
    s_waitcnt lgkmcnt(4)
    v_mfma_f32_16x16x32_bf16 v[16:19], a[28:31], v[44:47], v[16:19]
    ds_read_b128 v[40:43], v205 offset:30720
    v_mfma_f32_16x16x32_bf16 v[20:23], a[100:103], v[44:47], v[20:23]
    v_mfma_f32_16x16x32_bf16 v[24:27], a[172:175], v[44:47], v[24:27]
    v_mfma_f32_16x16x32_bf16 v[28:31], a[244:247], v[44:47], v[28:31]
    s_waitcnt lgkmcnt(4)
    v_mfma_f32_16x16x32_bf16 v[16:19], a[32:35], v[48:51], v[16:19]
    ds_read_b128 v[44:47], v205 offset:31744
    v_mfma_f32_16x16x32_bf16 v[20:23], a[104:107], v[48:51], v[20:23]
    v_mfma_f32_16x16x32_bf16 v[24:27], a[176:179], v[48:51], v[24:27]
    v_mfma_f32_16x16x32_bf16 v[28:31], a[248:251], v[48:51], v[28:31]
    s_waitcnt lgkmcnt(4)
    v_mfma_f32_16x16x32_bf16 v[16:19], a[36:39], v[52:55], v[16:19]
    ds_read_b128 v[48:51], v205 offset:32768
    v_mfma_f32_16x16x32_bf16 v[20:23], a[108:111], v[52:55], v[20:23]
    v_mfma_f32_16x16x32_bf16 v[24:27], a[180:183], v[52:55], v[24:27]
    v_mfma_f32_16x16x32_bf16 v[28:31], a[252:255], v[52:55], v[28:31]
    s_waitcnt lgkmcnt(4)
    v_mfma_f32_16x16x32_bf16 v[16:19], a[40:43], v[56:59], v[16:19]
    ds_read_b128 v[52:55], v205 offset:33792
    v_mfma_f32_16x16x32_bf16 v[20:23], a[112:115], v[56:59], v[20:23]
    v_mfma_f32_16x16x32_bf16 v[24:27], a[184:187], v[56:59], v[24:27]
    v_mfma_f32_16x16x32_bf16 v[28:31], v[208:211], v[56:59], v[28:31]
    s_waitcnt lgkmcnt(4)
    v_mfma_f32_16x16x32_bf16 v[16:19], a[44:47], v[60:63], v[16:19]
    ds_read_b128 v[56:59], v205 offset:34816
    v_mfma_f32_16x16x32_bf16 v[20:23], a[116:119], v[60:63], v[20:23]
    v_mfma_f32_16x16x32_bf16 v[24:27], a[188:191], v[60:63], v[24:27]
    v_mfma_f32_16x16x32_bf16 v[28:31], v[212:215], v[60:63], v[28:31]
    s_waitcnt lgkmcnt(4)
    v_mfma_f32_16x16x32_bf16 v[16:19], a[48:51], v[40:43], v[16:19]
    ds_read_b128 v[60:63], v205 offset:35840
    v_mfma_f32_16x16x32_bf16 v[20:23], a[120:123], v[40:43], v[20:23]
    v_mfma_f32_16x16x32_bf16 v[24:27], a[192:195], v[40:43], v[24:27]
    v_mfma_f32_16x16x32_bf16 v[28:31], v[216:219], v[40:43], v[28:31]
    s_waitcnt lgkmcnt(4)
    v_mfma_f32_16x16x32_bf16 v[16:19], a[52:55], v[44:47], v[16:19]
    v_mfma_f32_16x16x32_bf16 v[20:23], a[124:127], v[44:47], v[20:23]
    v_mfma_f32_16x16x32_bf16 v[24:27], a[196:199], v[44:47], v[24:27]
    v_mfma_f32_16x16x32_bf16 v[28:31], v[220:223], v[44:47], v[28:31]
    s_waitcnt lgkmcnt(3)
    v_mfma_f32_16x16x32_bf16 v[16:19], a[56:59], v[48:51], v[16:19]
    v_mfma_f32_16x16x32_bf16 v[20:23], a[128:131], v[48:51], v[20:23]
    v_mfma_f32_16x16x32_bf16 v[24:27], a[200:203], v[48:51], v[24:27]
    v_mfma_f32_16x16x32_bf16 v[28:31], v[224:227], v[48:51], v[28:31]
    s_waitcnt lgkmcnt(2)
    v_mfma_f32_16x16x32_bf16 v[16:19], a[60:63], v[52:55], v[16:19]
    v_mfma_f32_16x16x32_bf16 v[20:23], a[132:135], v[52:55], v[20:23]
    v_mfma_f32_16x16x32_bf16 v[24:27], a[204:207], v[52:55], v[24:27]
    v_mfma_f32_16x16x32_bf16 v[28:31], v[228:231], v[52:55], v[28:31]
    s_waitcnt lgkmcnt(1)
    v_mfma_f32_16x16x32_bf16 v[16:19], a[64:67], v[56:59], v[16:19]
    v_mfma_f32_16x16x32_bf16 v[20:23], a[136:139], v[56:59], v[20:23]
    v_mfma_f32_16x16x32_bf16 v[24:27], a[208:211], v[56:59], v[24:27]
    v_mfma_f32_16x16x32_bf16 v[28:31], v[232:235], v[56:59], v[28:31]
    s_waitcnt lgkmcnt(0)
    v_mfma_f32_16x16x32_bf16 v[16:19], a[68:71], v[60:63], v[16:19]
    v_mfma_f32_16x16x32_bf16 v[20:23], a[140:143], v[60:63], v[20:23]
    v_mfma_f32_16x16x32_bf16 v[24:27], a[212:215], v[60:63], v[24:27]
    v_mfma_f32_16x16x32_bf16 v[28:31], v[236:239], v[60:63], v[28:31]
    s_add_u32 s31, s26, 4096
    v_cvt_pk_bf16_f32 v64, v0, v1
    v_cvt_pk_bf16_f32 v65, v2, v3
    v_cvt_pk_bf16_f32 v66, v4, v5
    v_cvt_pk_bf16_f32 v67, v6, v7
    buffer_store_dwordx4 v[64:67], v200, s[4:7], s26 offen offset:0 sc1
    v_cvt_pk_bf16_f32 v68, v8, v9
    v_cvt_pk_bf16_f32 v69, v10, v11
    v_cvt_pk_bf16_f32 v70, v12, v13
    v_cvt_pk_bf16_f32 v71, v14, v15
    buffer_store_dwordx4 v[68:71], v200, s[4:7], s26 offen offset:1024 sc1
    v_cvt_pk_bf16_f32 v72, v16, v17
    v_cvt_pk_bf16_f32 v73, v18, v19
    v_cvt_pk_bf16_f32 v74, v20, v21
    v_cvt_pk_bf16_f32 v75, v22, v23
    buffer_store_dwordx4 v[72:75], v200, s[4:7], s31 offen offset:0 sc1
    v_cvt_pk_bf16_f32 v76, v24, v25
    v_cvt_pk_bf16_f32 v77, v26, v27
    v_cvt_pk_bf16_f32 v78, v28, v29
    v_cvt_pk_bf16_f32 v79, v30, v31
    buffer_store_dwordx4 v[76:79], v200, s[4:7], s31 offen offset:1024 sc1
    s_add_u32 s26, s26, s50
    s_add_u32 s28, s28, 1
    s_cmp_lt_u32 s28, s48
    s_cbranch_scc1 G1L_36
    s_waitcnt vmcnt(0)
    s_barrier
    v_mov_b32 v204, s48
    s_mov_b64 exec, 1
    buffer_store_dword v204, v203, s[4:7], s27 offen sc1
    s_mov_b64 exec, -1
    s_branch W_NEXT
G1V_35:
G1L_38:
    s_waitcnt vmcnt(4)
    s_cmp_lg_u32 s28, 1
    s_cbranch_scc1 G1F_39
    s_waitcnt vmcnt(0)
G1F_39:
    s_barrier
    s_max_u32 s31, s28, 2
    s_sub_u32 s31, s31, 1
    s_min_u32 s31, s31, s28
    v_mov_b32 v204, s31
    s_mov_b64 exec, 1
    buffer_store_dword v204, v203, s[4:7], s27 offen sc1
    s_mov_b64 exec, -1
    v_add_u32 v205, s29, v200
    s_add_u32 s25, s25, s49
    s_xor_b32 s29, s29, 98304
    s_add_u32 s31, s25, s34
    s_add_u32 s32, s29, s35
    s_add_u32 m0, s32, 0
    s_nop 0
    buffer_load_dwordx4 v202, s[16:19], s31 offen lds
    s_add_u32 m0, s32, 1024
    s_add_u32 s31, s31, 64
    buffer_load_dwordx4 v202, s[16:19], s31 offen lds
    s_add_u32 m0, s32, 2048
    s_add_u32 s31, s31, 64
    buffer_load_dwordx4 v202, s[16:19], s31 offen lds
    s_add_u32 m0, s32, 3072
    s_add_u32 s31, s31, 64
    buffer_load_dwordx4 v202, s[16:19], s31 offen lds
    s_add_u32 m0, s32, 4096
    s_add_u32 s31, s31, 64
    buffer_load_dwordx4 v202, s[16:19], s31 offen lds
    s_add_u32 m0, s32, 5120
    s_add_u32 s31, s31, 64
    buffer_load_dwordx4 v202, s[16:19], s31 offen lds
    s_add_u32 m0, s32, 6144
    s_add_u32 s31, s31, 64
    buffer_load_dwordx4 v202, s[16:19], s31 offen lds
    s_add_u32 m0, s32, 7168
    s_add_u32 s31, s31, 64
    buffer_load_dwordx4 v202, s[16:19], s31 offen lds
    s_add_u32 m0, s32, 8192
    s_add_u32 s31, s31, 64
    buffer_load_dwordx4 v202, s[16:19], s31 offen lds
    ds_read_b128 v[40:43], v205 offset:0
    ds_read_b128 v[44:47], v205 offset:1024
    ds_read_b128 v[48:51], v205 offset:2048
    ds_read_b128 v[52:55], v205 offset:3072
    ds_read_b128 v[56:59], v205 offset:4096
    ds_read_b128 v[60:63], v205 offset:5120
    s_waitcnt lgkmcnt(5)
    v_mfma_f32_16x16x32_bf16 v[0:3], v[40:43], a[0:3], 0
    v_mfma_f32_16x16x32_bf16 v[4:7], v[40:43], a[72:75], 0
    v_mfma_f32_16x16x32_bf16 v[8:11], v[40:43], a[144:147], 0
    v_mfma_f32_16x16x32_bf16 v[12:15], v[40:43], a[216:219], 0
    s_waitcnt lgkmcnt(4)
    v_mfma_f32_16x16x32_bf16 v[0:3], v[44:47], a[4:7], v[0:3]
    ds_read_b128 v[40:43], v205 offset:6144
    v_mfma_f32_16x16x32_bf16 v[4:7], v[44:47], a[76:79], v[4:7]
    v_mfma_f32_16x16x32_bf16 v[8:11], v[44:47], a[148:151], v[8:11]
    v_mfma_f32_16x16x32_bf16 v[12:15], v[44:47], a[220:223], v[12:15]
    s_waitcnt lgkmcnt(4)
    v_mfma_f32_16x16x32_bf16 v[0:3], v[48:51], a[8:11], v[0:3]
    ds_read_b128 v[44:47], v205 offset:7168
    v_mfma_f32_16x16x32_bf16 v[4:7], v[48:51], a[80:83], v[4:7]
    v_mfma_f32_16x16x32_bf16 v[8:11], v[48:51], a[152:155], v[8:11]
    v_mfma_f32_16x16x32_bf16 v[12:15], v[48:51], a[224:227], v[12:15]
    s_waitcnt lgkmcnt(4)
    v_mfma_f32_16x16x32_bf16 v[0:3], v[52:55], a[12:15], v[0:3]
    ds_read_b128 v[48:51], v205 offset:8192
    v_mfma_f32_16x16x32_bf16 v[4:7], v[52:55], a[84:87], v[4:7]
    v_mfma_f32_16x16x32_bf16 v[8:11], v[52:55], a[156:159], v[8:11]
    v_mfma_f32_16x16x32_bf16 v[12:15], v[52:55], a[228:231], v[12:15]
    s_waitcnt lgkmcnt(4)
    v_mfma_f32_16x16x32_bf16 v[0:3], v[56:59], a[16:19], v[0:3]
    ds_read_b128 v[52:55], v205 offset:9216
    v_mfma_f32_16x16x32_bf16 v[4:7], v[56:59], a[88:91], v[4:7]
    v_mfma_f32_16x16x32_bf16 v[8:11], v[56:59], a[160:163], v[8:11]
    v_mfma_f32_16x16x32_bf16 v[12:15], v[56:59], a[232:235], v[12:15]
    s_waitcnt lgkmcnt(4)
    v_mfma_f32_16x16x32_bf16 v[0:3], v[60:63], a[20:23], v[0:3]
    ds_read_b128 v[56:59], v205 offset:10240
    v_mfma_f32_16x16x32_bf16 v[4:7], v[60:63], a[92:95], v[4:7]
    v_mfma_f32_16x16x32_bf16 v[8:11], v[60:63], a[164:167], v[8:11]
    v_mfma_f32_16x16x32_bf16 v[12:15], v[60:63], a[236:239], v[12:15]
    s_waitcnt lgkmcnt(4)
    v_mfma_f32_16x16x32_bf16 v[0:3], v[40:43], a[24:27], v[0:3]
    ds_read_b128 v[60:63], v205 offset:11264
    v_mfma_f32_16x16x32_bf16 v[4:7], v[40:43], a[96:99], v[4:7]
    v_mfma_f32_16x16x32_bf16 v[8:11], v[40:43], a[168:171], v[8:11]
    v_mfma_f32_16x16x32_bf16 v[12:15], v[40:43], a[240:243], v[12:15]
    s_waitcnt lgkmcnt(4)
    v_mfma_f32_16x16x32_bf16 v[0:3], v[44:47], a[28:31], v[0:3]
    ds_read_b128 v[40:43], v205 offset:12288
    v_mfma_f32_16x16x32_bf16 v[4:7], v[44:47], a[100:103], v[4:7]
    v_mfma_f32_16x16x32_bf16 v[8:11], v[44:47], a[172:175], v[8:11]
    v_mfma_f32_16x16x32_bf16 v[12:15], v[44:47], a[244:247], v[12:15]
    s_waitcnt lgkmcnt(4)
    v_mfma_f32_16x16x32_bf16 v[0:3], v[48:51], a[32:35], v[0:3]
    ds_read_b128 v[44:47], v205 offset:13312
    v_mfma_f32_16x16x32_bf16 v[4:7], v[48:51], a[104:107], v[4:7]
    v_mfma_f32_16x16x32_bf16 v[8:11], v[48:51], a[176:179], v[8:11]
    v_mfma_f32_16x16x32_bf16 v[12:15], v[48:51], a[248:251], v[12:15]
    s_waitcnt lgkmcnt(4)
    v_mfma_f32_16x16x32_bf16 v[0:3], v[52:55], a[36:39], v[0:3]
    ds_read_b128 v[48:51], v205 offset:14336
    v_mfma_f32_16x16x32_bf16 v[4:7], v[52:55], a[108:111], v[4:7]
    v_mfma_f32_16x16x32_bf16 v[8:11], v[52:55], a[180:183], v[8:11]
    v_mfma_f32_16x16x32_bf16 v[12:15], v[52:55], a[252:255], v[12:15]
    s_waitcnt lgkmcnt(4)
    v_mfma_f32_16x16x32_bf16 v[0:3], v[56:59], a[40:43], v[0:3]
    ds_read_b128 v[52:55], v205 offset:15360
    v_mfma_f32_16x16x32_bf16 v[4:7], v[56:59], a[112:115], v[4:7]
    v_mfma_f32_16x16x32_bf16 v[8:11], v[56:59], a[184:187], v[8:11]
    v_mfma_f32_16x16x32_bf16 v[12:15], v[56:59], v[208:211], v[12:15]
    s_waitcnt lgkmcnt(4)
    v_mfma_f32_16x16x32_bf16 v[0:3], v[60:63], a[44:47], v[0:3]
    ds_read_b128 v[56:59], v205 offset:16384
    v_mfma_f32_16x16x32_bf16 v[4:7], v[60:63], a[116:119], v[4:7]
    v_mfma_f32_16x16x32_bf16 v[8:11], v[60:63], a[188:191], v[8:11]
    v_mfma_f32_16x16x32_bf16 v[12:15], v[60:63], v[212:215], v[12:15]
    s_waitcnt lgkmcnt(4)
    v_mfma_f32_16x16x32_bf16 v[0:3], v[40:43], a[48:51], v[0:3]
    ds_read_b128 v[60:63], v205 offset:17408
    v_mfma_f32_16x16x32_bf16 v[4:7], v[40:43], a[120:123], v[4:7]
    v_mfma_f32_16x16x32_bf16 v[8:11], v[40:43], a[192:195], v[8:11]
    v_mfma_f32_16x16x32_bf16 v[12:15], v[40:43], v[216:219], v[12:15]
    s_waitcnt lgkmcnt(4)
    v_mfma_f32_16x16x32_bf16 v[0:3], v[44:47], a[52:55], v[0:3]
    ds_read_b128 v[40:43], v205 offset:18432
    v_mfma_f32_16x16x32_bf16 v[4:7], v[44:47], a[124:127], v[4:7]
    v_mfma_f32_16x16x32_bf16 v[8:11], v[44:47], a[196:199], v[8:11]
    v_mfma_f32_16x16x32_bf16 v[12:15], v[44:47], v[220:223], v[12:15]
    s_waitcnt lgkmcnt(4)
    v_mfma_f32_16x16x32_bf16 v[0:3], v[48:51], a[56:59], v[0:3]
    ds_read_b128 v[44:47], v205 offset:19456
    v_mfma_f32_16x16x32_bf16 v[4:7], v[48:51], a[128:131], v[4:7]
    v_mfma_f32_16x16x32_bf16 v[8:11], v[48:51], a[200:203], v[8:11]
    v_mfma_f32_16x16x32_bf16 v[12:15], v[48:51], v[224:227], v[12:15]
    s_waitcnt lgkmcnt(4)
    v_mfma_f32_16x16x32_bf16 v[0:3], v[52:55], a[60:63], v[0:3]
    ds_read_b128 v[48:51], v205 offset:20480
    v_mfma_f32_16x16x32_bf16 v[4:7], v[52:55], a[132:135], v[4:7]
    v_mfma_f32_16x16x32_bf16 v[8:11], v[52:55], a[204:207], v[8:11]
    v_mfma_f32_16x16x32_bf16 v[12:15], v[52:55], v[228:231], v[12:15]
    s_waitcnt lgkmcnt(4)
    v_mfma_f32_16x16x32_bf16 v[0:3], v[56:59], a[64:67], v[0:3]
    ds_read_b128 v[52:55], v205 offset:21504
    v_mfma_f32_16x16x32_bf16 v[4:7], v[56:59], a[136:139], v[4:7]
    v_mfma_f32_16x16x32_bf16 v[8:11], v[56:59], a[208:211], v[8:11]
    v_mfma_f32_16x16x32_bf16 v[12:15], v[56:59], v[232:235], v[12:15]
    s_waitcnt lgkmcnt(4)
    v_mfma_f32_16x16x32_bf16 v[0:3], v[60:63], a[68:71], v[0:3]
    ds_read_b128 v[56:59], v205 offset:22528
    v_mfma_f32_16x16x32_bf16 v[4:7], v[60:63], a[140:143], v[4:7]
    v_mfma_f32_16x16x32_bf16 v[8:11], v[60:63], a[212:215], v[8:11]
    v_mfma_f32_16x16x32_bf16 v[12:15], v[60:63], v[236:239], v[12:15]
    s_waitcnt lgkmcnt(4)
    v_mfma_f32_16x16x32_bf16 v[16:19], v[40:43], a[0:3], 0
    ds_read_b128 v[60:63], v205 offset:23552
    v_mfma_f32_16x16x32_bf16 v[20:23], v[40:43], a[72:75], 0
    v_mfma_f32_16x16x32_bf16 v[24:27], v[40:43], a[144:147], 0
    v_mfma_f32_16x16x32_bf16 v[28:31], v[40:43], a[216:219], 0
    s_waitcnt lgkmcnt(4)
    v_mfma_f32_16x16x32_bf16 v[16:19], v[44:47], a[4:7], v[16:19]
    ds_read_b128 v[40:43], v205 offset:24576
    v_mfma_f32_16x16x32_bf16 v[20:23], v[44:47], a[76:79], v[20:23]
    v_mfma_f32_16x16x32_bf16 v[24:27], v[44:47], a[148:151], v[24:27]
    v_mfma_f32_16x16x32_bf16 v[28:31], v[44:47], a[220:223], v[28:31]
    s_waitcnt lgkmcnt(4)
    v_mfma_f32_16x16x32_bf16 v[16:19], v[48:51], a[8:11], v[16:19]
    ds_read_b128 v[44:47], v205 offset:25600
    v_mfma_f32_16x16x32_bf16 v[20:23], v[48:51], a[80:83], v[20:23]
    v_mfma_f32_16x16x32_bf16 v[24:27], v[48:51], a[152:155], v[24:27]
    v_mfma_f32_16x16x32_bf16 v[28:31], v[48:51], a[224:227], v[28:31]
    s_waitcnt lgkmcnt(4)
    v_mfma_f32_16x16x32_bf16 v[16:19], v[52:55], a[12:15], v[16:19]
    ds_read_b128 v[48:51], v205 offset:26624
    v_mfma_f32_16x16x32_bf16 v[20:23], v[52:55], a[84:87], v[20:23]
    v_mfma_f32_16x16x32_bf16 v[24:27], v[52:55], a[156:159], v[24:27]
    v_mfma_f32_16x16x32_bf16 v[28:31], v[52:55], a[228:231], v[28:31]
    s_waitcnt lgkmcnt(4)
    v_mfma_f32_16x16x32_bf16 v[16:19], v[56:59], a[16:19], v[16:19]
    ds_read_b128 v[52:55], v205 offset:27648
    v_mfma_f32_16x16x32_bf16 v[20:23], v[56:59], a[88:91], v[20:23]
    v_mfma_f32_16x16x32_bf16 v[24:27], v[56:59], a[160:163], v[24:27]
    v_mfma_f32_16x16x32_bf16 v[28:31], v[56:59], a[232:235], v[28:31]
    s_waitcnt lgkmcnt(4)
    v_mfma_f32_16x16x32_bf16 v[16:19], v[60:63], a[20:23], v[16:19]
    ds_read_b128 v[56:59], v205 offset:28672
    v_mfma_f32_16x16x32_bf16 v[20:23], v[60:63], a[92:95], v[20:23]
    v_mfma_f32_16x16x32_bf16 v[24:27], v[60:63], a[164:167], v[24:27]
    v_mfma_f32_16x16x32_bf16 v[28:31], v[60:63], a[236:239], v[28:31]
    s_waitcnt lgkmcnt(4)
    v_mfma_f32_16x16x32_bf16 v[16:19], v[40:43], a[24:27], v[16:19]
    ds_read_b128 v[60:63], v205 offset:29696
    v_mfma_f32_16x16x32_bf16 v[20:23], v[40:43], a[96:99], v[20:23]
    v_mfma_f32_16x16x32_bf16 v[24:27], v[40:43], a[168:171], v[24:27]
    v_mfma_f32_16x16x32_bf16 v[28:31], v[40:43], a[240:243], v[28:31]
    s_waitcnt lgkmcnt(4)
    v_mfma_f32_16x16x32_bf16 v[16:19], v[44:47], a[28:31], v[16:19]
    ds_read_b128 v[40:43], v205 offset:30720
    v_mfma_f32_16x16x32_bf16 v[20:23], v[44:47], a[100:103], v[20:23]
    v_mfma_f32_16x16x32_bf16 v[24:27], v[44:47], a[172:175], v[24:27]
    v_mfma_f32_16x16x32_bf16 v[28:31], v[44:47], a[244:247], v[28:31]
    s_waitcnt lgkmcnt(4)
    v_mfma_f32_16x16x32_bf16 v[16:19], v[48:51], a[32:35], v[16:19]
    ds_read_b128 v[44:47], v205 offset:31744
    v_mfma_f32_16x16x32_bf16 v[20:23], v[48:51], a[104:107], v[20:23]
    v_mfma_f32_16x16x32_bf16 v[24:27], v[48:51], a[176:179], v[24:27]
    v_mfma_f32_16x16x32_bf16 v[28:31], v[48:51], a[248:251], v[28:31]
    s_waitcnt lgkmcnt(4)
    v_mfma_f32_16x16x32_bf16 v[16:19], v[52:55], a[36:39], v[16:19]
    ds_read_b128 v[48:51], v205 offset:32768
    v_mfma_f32_16x16x32_bf16 v[20:23], v[52:55], a[108:111], v[20:23]
    v_mfma_f32_16x16x32_bf16 v[24:27], v[52:55], a[180:183], v[24:27]
    v_mfma_f32_16x16x32_bf16 v[28:31], v[52:55], a[252:255], v[28:31]
    s_waitcnt lgkmcnt(4)
    v_mfma_f32_16x16x32_bf16 v[16:19], v[56:59], a[40:43], v[16:19]
    ds_read_b128 v[52:55], v205 offset:33792
    v_mfma_f32_16x16x32_bf16 v[20:23], v[56:59], a[112:115], v[20:23]
    v_mfma_f32_16x16x32_bf16 v[24:27], v[56:59], a[184:187], v[24:27]
    v_mfma_f32_16x16x32_bf16 v[28:31], v[56:59], v[208:211], v[28:31]
    s_waitcnt lgkmcnt(4)
    v_mfma_f32_16x16x32_bf16 v[16:19], v[60:63], a[44:47], v[16:19]
    ds_read_b128 v[56:59], v205 offset:34816
    v_mfma_f32_16x16x32_bf16 v[20:23], v[60:63], a[116:119], v[20:23]
    v_mfma_f32_16x16x32_bf16 v[24:27], v[60:63], a[188:191], v[24:27]
    v_mfma_f32_16x16x32_bf16 v[28:31], v[60:63], v[212:215], v[28:31]
    s_waitcnt lgkmcnt(4)
    v_mfma_f32_16x16x32_bf16 v[16:19], v[40:43], a[48:51], v[16:19]
    ds_read_b128 v[60:63], v205 offset:35840
    v_mfma_f32_16x16x32_bf16 v[20:23], v[40:43], a[120:123], v[20:23]
    v_mfma_f32_16x16x32_bf16 v[24:27], v[40:43], a[192:195], v[24:27]
    v_mfma_f32_16x16x32_bf16 v[28:31], v[40:43], v[216:219], v[28:31]
    s_waitcnt lgkmcnt(4)
    v_mfma_f32_16x16x32_bf16 v[16:19], v[44:47], a[52:55], v[16:19]
    v_mfma_f32_16x16x32_bf16 v[20:23], v[44:47], a[124:127], v[20:23]
    v_mfma_f32_16x16x32_bf16 v[24:27], v[44:47], a[196:199], v[24:27]
    v_mfma_f32_16x16x32_bf16 v[28:31], v[44:47], v[220:223], v[28:31]
    s_waitcnt lgkmcnt(3)
    v_mfma_f32_16x16x32_bf16 v[16:19], v[48:51], a[56:59], v[16:19]
    v_mfma_f32_16x16x32_bf16 v[20:23], v[48:51], a[128:131], v[20:23]
    v_mfma_f32_16x16x32_bf16 v[24:27], v[48:51], a[200:203], v[24:27]
    v_mfma_f32_16x16x32_bf16 v[28:31], v[48:51], v[224:227], v[28:31]
    s_waitcnt lgkmcnt(2)
    v_mfma_f32_16x16x32_bf16 v[16:19], v[52:55], a[60:63], v[16:19]
    v_mfma_f32_16x16x32_bf16 v[20:23], v[52:55], a[132:135], v[20:23]
    v_mfma_f32_16x16x32_bf16 v[24:27], v[52:55], a[204:207], v[24:27]
    v_mfma_f32_16x16x32_bf16 v[28:31], v[52:55], v[228:231], v[28:31]
    s_waitcnt lgkmcnt(1)
    v_mfma_f32_16x16x32_bf16 v[16:19], v[56:59], a[64:67], v[16:19]
    v_mfma_f32_16x16x32_bf16 v[20:23], v[56:59], a[136:139], v[20:23]
    v_mfma_f32_16x16x32_bf16 v[24:27], v[56:59], a[208:211], v[24:27]
    v_mfma_f32_16x16x32_bf16 v[28:31], v[56:59], v[232:235], v[28:31]
    s_waitcnt lgkmcnt(0)
    v_mfma_f32_16x16x32_bf16 v[16:19], v[60:63], a[68:71], v[16:19]
    v_mfma_f32_16x16x32_bf16 v[20:23], v[60:63], a[140:143], v[20:23]
    v_mfma_f32_16x16x32_bf16 v[24:27], v[60:63], a[212:215], v[24:27]
    v_mfma_f32_16x16x32_bf16 v[28:31], v[60:63], v[236:239], v[28:31]
    s_add_u32 s31, s26, 4096
    v_cvt_pk_bf16_f32 v64, v0, v1
    v_cvt_pk_bf16_f32 v65, v2, v3
    s_nop 1
    v_cvt_pk_bf16_f32 v66, v16, v17
    v_cvt_pk_bf16_f32 v67, v18, v19
    buffer_store_dwordx4 v[64:67], v200, s[4:7], s26 offen offset:0 sc1
    v_cvt_pk_bf16_f32 v68, v4, v5
    v_cvt_pk_bf16_f32 v69, v6, v7
    v_cvt_pk_bf16_f32 v70, v20, v21
    v_cvt_pk_bf16_f32 v71, v22, v23
    buffer_store_dwordx4 v[68:71], v200, s[4:7], s26 offen offset:1024 sc1
    v_cvt_pk_bf16_f32 v72, v8, v9
    v_cvt_pk_bf16_f32 v73, v10, v11
    v_cvt_pk_bf16_f32 v74, v24, v25
    v_cvt_pk_bf16_f32 v75, v26, v27
    buffer_store_dwordx4 v[72:75], v200, s[4:7], s26 offen offset:2048 sc1
    v_cvt_pk_bf16_f32 v76, v12, v13
    v_cvt_pk_bf16_f32 v77, v14, v15
    v_cvt_pk_bf16_f32 v78, v28, v29
    v_cvt_pk_bf16_f32 v79, v30, v31
    buffer_store_dwordx4 v[76:79], v200, s[4:7], s26 offen offset:3072 sc1
    s_add_u32 s26, s26, s50
    s_add_u32 s28, s28, 1
    s_cmp_lt_u32 s28, s48
    s_cbranch_scc1 G1L_38
    s_waitcnt vmcnt(0)
    s_barrier
    v_mov_b32 v204, s48
    s_mov_b64 exec, 1
    buffer_store_dword v204, v203, s[4:7], s27 offen sc1
    s_mov_b64 exec, -1
    s_branch W_NEXT
W_BB:
    s_load_dwordx2 s[8:9], s[0:1], 64
    s_mov_b32 s10, 1990656
    s_mov_b32 s11, 0x20000
    s_load_dwordx2 s[12:13], s[0:1], 80
    s_mov_b32 s14, 1152
    s_mov_b32 s15, 0x20000
    s_mov_b32 s36, 0x3fb8aa3b
    s_sub_u32 s31, s21, 160
    s_and_b32 s24, s31, 7
    s_lshr_b32 s30, s31, 3
    s_lshl_b32 s30, s30, 2
    s_add_u32 s30, s30, s20
    s_lshl_b32 s27, s31, 7
    s_add_u32 s27, s27, 0x208000
    s_mul_i32 s25, s24, 294912
    s_lshl_b32 s31, s31, 2
    s_add_u32 s31, s31, s20
    s_lshl_b32 s26, s31, 14
    s_add_u32 s26, s26, 0x6a00000
    s_lshl_b32 s37, s24, 10
    s_add_u32 s37, s37, 0x280000
    v_and_b32 v1, 15, v201
    v_mul_u32_u24 v1, 1152, v1
    v_lshrrev_b32 v2, 4, v201
    v_lshl_add_u32 v202, v2, 4, v1
    s_lshr_b32 s34, s20, 1
    s_mul_i32 s34, s34, 18432
    s_and_b32 s35, s20, 1
    s_mul_i32 s35, s35, 576
    s_add_u32 s34, s34, s35
    s_mul_i32 s35, s20, 9216
    s_mov_b32 s29, 98304
    s_waitcnt lgkmcnt(0)
    s_add_u32 s31, s25, s34
    s_add_u32 s32, s29, s35
    s_add_u32 m0, s32, 0
    s_nop 0
    buffer_load_dwordx4 v202, s[16:19], s31 offen lds
    s_add_u32 m0, s32, 1024
    s_add_u32 s31, s31, 64
    buffer_load_dwordx4 v202, s[16:19], s31 offen lds
    s_add_u32 m0, s32, 2048
    s_add_u32 s31, s31, 64
    buffer_load_dwordx4 v202, s[16:19], s31 offen lds
    s_add_u32 m0, s32, 3072
    s_add_u32 s31, s31, 64
    buffer_load_dwordx4 v202, s[16:19], s31 offen lds
    s_add_u32 m0, s32, 4096
    s_add_u32 s31, s31, 64
    buffer_load_dwordx4 v202, s[16:19], s31 offen lds
    s_add_u32 m0, s32, 5120
    s_add_u32 s31, s31, 64
    buffer_load_dwordx4 v202, s[16:19], s31 offen lds
    s_add_u32 m0, s32, 6144
    s_add_u32 s31, s31, 64
    buffer_load_dwordx4 v202, s[16:19], s31 offen lds
    s_add_u32 m0, s32, 7168
    s_add_u32 s31, s31, 64
    buffer_load_dwordx4 v202, s[16:19], s31 offen lds
    s_add_u32 m0, s32, 8192
    s_add_u32 s31, s31, 64
    buffer_load_dwordx4 v202, s[16:19], s31 offen lds
    v_and_b32 v1, 15, v201
    v_lshrrev_b32 v2, 4, v201
    v_bfe_u32 v3, v201, 2, 2
    v_and_b32 v4, 3, v201
    v_lshlrev_b32 v5, 4, v2
    buffer_load_dwordx4 v[128:131], v5, s[12:15], 0 offen offset:0
    buffer_load_dwordx4 v[132:135], v5, s[12:15], 0 offen offset:64
    buffer_load_dwordx4 v[136:139], v5, s[12:15], 0 offen offset:128
    buffer_load_dwordx4 v[140:143], v5, s[12:15], 0 offen offset:192
    buffer_load_dwordx4 v[144:147], v5, s[12:15], 0 offen offset:256
    buffer_load_dwordx4 v[148:151], v5, s[12:15], 0 offen offset:320
    buffer_load_dwordx4 v[152:155], v5, s[12:15], 0 offen offset:384
    buffer_load_dwordx4 v[156:159], v5, s[12:15], 0 offen offset:448
    buffer_load_dwordx4 v[160:163], v5, s[12:15], 0 offen offset:512
    buffer_load_dwordx4 v[164:167], v5, s[12:15], 0 offen offset:576
    buffer_load_dwordx4 v[168:171], v5, s[12:15], 0 offen offset:640
    buffer_load_dwordx4 v[172:175], v5, s[12:15], 0 offen offset:704
    buffer_load_dwordx4 v[176:179], v5, s[12:15], 0 offen offset:768
    buffer_load_dwordx4 v[180:183], v5, s[12:15], 0 offen offset:832
    buffer_load_dwordx4 v[184:187], v5, s[12:15], 0 offen offset:896
    buffer_load_dwordx4 v[188:191], v5, s[12:15], 0 offen offset:960
    buffer_load_dwordx4 v[192:195], v5, s[12:15], 0 offen offset:1024
    buffer_load_dwordx4 v[196:199], v5, s[12:15], 0 offen offset:1088
    s_mul_i32 s31, s30, 36
    v_and_b32 v5, 7, v201
    v_bfe_u32 v6, v201, 3, 2
    v_lshrrev_b32 v7, 5, v201
    v_mul_u32_u24 v7, 3456, v7
    v_add_u32 v7, s31, v7
    v_lshlrev_b32 v12, 2, v5
    v_mov_b32 v13, 0x40000000
    v_cmp_eq_u32 vcc, 0, v5
    v_mov_b32 v14, 1184
    s_nop 0
    v_cndmask_b32 v13, v13, v14, vcc
    v_cmp_eq_u32 vcc, 1, v5
    v_mov_b32 v14, 2336
    s_nop 0
    v_cndmask_b32 v13, v13, v14, vcc
    v_cmp_eq_u32 vcc, 2, v5
    v_mov_b32 v14, 32
    s_nop 0
    v_cndmask_b32 v13, v13, v14, vcc
    v_xor_b32 v14, 0, v6
    v_add_u32 v15, 1152, v12
    v_add_u32 v16, 2304, v12
    v_cmp_eq_u32 vcc, 1, v14
    s_nop 1
    v_cndmask_b32 v15, v15, v16, vcc
    v_cmp_eq_u32 vcc, 2, v14
    s_nop 1
    v_cndmask_b32 v15, v15, v13, vcc
    v_cmp_eq_u32 vcc, 3, v14
    s_nop 1
    v_cndmask_b32 v15, v15, v12, vcc
    v_add_u32 v8, v15, v7
    v_xor_b32 v14, 1, v6
    v_add_u32 v15, 1152, v12
    v_add_u32 v16, 2304, v12
    v_cmp_eq_u32 vcc, 1, v14
    s_nop 1
    v_cndmask_b32 v15, v15, v16, vcc
    v_cmp_eq_u32 vcc, 2, v14
    s_nop 1
    v_cndmask_b32 v15, v15, v13, vcc
    v_cmp_eq_u32 vcc, 3, v14
    s_nop 1
    v_cndmask_b32 v15, v15, v12, vcc
    v_add_u32 v9, v15, v7
    v_xor_b32 v14, 2, v6
    v_add_u32 v15, 1152, v12
    v_add_u32 v16, 2304, v12
    v_cmp_eq_u32 vcc, 1, v14
    s_nop 1
    v_cndmask_b32 v15, v15, v16, vcc
    v_cmp_eq_u32 vcc, 2, v14
    s_nop 1
    v_cndmask_b32 v15, v15, v13, vcc
    v_cmp_eq_u32 vcc, 3, v14
    s_nop 1
    v_cndmask_b32 v15, v15, v12, vcc
    v_add_u32 v10, v15, v7
    v_xor_b32 v14, 3, v6
    v_add_u32 v15, 1152, v12
    v_add_u32 v16, 2304, v12
    v_cmp_eq_u32 vcc, 1, v14
    s_nop 1
    v_cndmask_b32 v15, v15, v16, vcc
    v_cmp_eq_u32 vcc, 2, v14
    s_nop 1
    v_cndmask_b32 v15, v15, v13, vcc
    v_cmp_eq_u32 vcc, 3, v14
    s_nop 1
    v_cndmask_b32 v15, v15, v12, vcc
    v_add_u32 v11, v15, v7
    v_and_b32 v5, 1, v2
    v_lshrrev_b32 v6, 1, v3
    v_lshl_or_b32 v6, v5, 1, v6
    v_lshl_add_u32 v7, v2, 3, v3
    v_lshlrev_b32 v7, 7, v7
    v_lshl_add_u32 v7, v4, 3, v7
    s_mul_i32 s33, s20, 24576
    v_add_u32 v7, s33, v7
    v_xor_b32 v5, 0, v6
    v_lshl_add_u32 v12, v5, 5, v7
    v_xor_b32 v5, 1, v6
    v_lshl_add_u32 v13, v5, 5, v7
    v_xor_b32 v5, 2, v6
    v_lshl_add_u32 v14, v5, 5, v7
    v_xor_b32 v5, 3, v6
    v_lshl_add_u32 v15, v5, 5, v7
    s_waitcnt vmcnt(0)
    s_add_u32 m0, s33, 0
    s_mov_b32 s31, 0
    buffer_load_dword v8, s[8:11], s31 offen lds
    s_add_u32 m0, s33, 256
    s_mov_b32 s31, 6912
    buffer_load_dword v9, s[8:11], s31 offen lds
    s_add_u32 m0, s33, 512
    s_mov_b32 s31, 13824
    buffer_load_dword v8, s[8:11], s31 offen lds
    s_add_u32 m0, s33, 768
    s_mov_b32 s31, 20736
    buffer_load_dword v9, s[8:11], s31 offen lds
    s_add_u32 m0, s33, 1024
    s_mov_b32 s31, 27648
    buffer_load_dword v10, s[8:11], s31 offen lds
    s_add_u32 m0, s33, 1280
    s_mov_b32 s31, 34560
    buffer_load_dword v11, s[8:11], s31 offen lds
    s_add_u32 m0, s33, 1536
    s_mov_b32 s31, 41472
    buffer_load_dword v10, s[8:11], s31 offen lds
    s_add_u32 m0, s33, 1792
    s_mov_b32 s31, 48384
    buffer_load_dword v11, s[8:11], s31 offen lds
    s_add_u32 m0, s33, 2048
    s_mov_b32 s31, 55296
    buffer_load_dword v8, s[8:11], s31 offen lds
    s_add_u32 m0, s33, 2304
    s_mov_b32 s31, 62208
    buffer_load_dword v9, s[8:11], s31 offen lds
    s_add_u32 m0, s33, 2560
    s_mov_b32 s31, 69120
    buffer_load_dword v8, s[8:11], s31 offen lds
    s_add_u32 m0, s33, 2816
    s_mov_b32 s31, 76032
    buffer_load_dword v9, s[8:11], s31 offen lds
    s_add_u32 m0, s33, 3072
    s_mov_b32 s31, 82944
    buffer_load_dword v10, s[8:11], s31 offen lds
    s_add_u32 m0, s33, 3328
    s_mov_b32 s31, 89856
    buffer_load_dword v11, s[8:11], s31 offen lds
    s_add_u32 m0, s33, 3584
    s_mov_b32 s31, 96768
    buffer_load_dword v10, s[8:11], s31 offen lds
    s_add_u32 m0, s33, 3840
    s_mov_b32 s31, 103680
    buffer_load_dword v11, s[8:11], s31 offen lds
    s_add_u32 m0, s33, 4096
    s_mov_b32 s31, 110592
    buffer_load_dword v8, s[8:11], s31 offen lds
    s_add_u32 m0, s33, 4352
    s_mov_b32 s31, 117504
    buffer_load_dword v9, s[8:11], s31 offen lds
    s_add_u32 m0, s33, 4608
    s_mov_b32 s31, 124416
    buffer_load_dword v8, s[8:11], s31 offen lds
    s_add_u32 m0, s33, 4864
    s_mov_b32 s31, 131328
    buffer_load_dword v9, s[8:11], s31 offen lds
    s_add_u32 m0, s33, 5120
    s_mov_b32 s31, 138240
    buffer_load_dword v10, s[8:11], s31 offen lds
    s_add_u32 m0, s33, 5376
    s_mov_b32 s31, 145152
    buffer_load_dword v11, s[8:11], s31 offen lds
    s_add_u32 m0, s33, 5632
    s_mov_b32 s31, 152064
    buffer_load_dword v10, s[8:11], s31 offen lds
    s_add_u32 m0, s33, 5888
    s_mov_b32 s31, 158976
    buffer_load_dword v11, s[8:11], s31 offen lds
    s_add_u32 m0, s33, 6144
    s_mov_b32 s31, 165888
    buffer_load_dword v8, s[8:11], s31 offen lds
    s_add_u32 m0, s33, 6400
    s_mov_b32 s31, 172800
    buffer_load_dword v9, s[8:11], s31 offen lds
    s_add_u32 m0, s33, 6656
    s_mov_b32 s31, 179712
    buffer_load_dword v8, s[8:11], s31 offen lds
    s_add_u32 m0, s33, 6912
    s_mov_b32 s31, 186624
    buffer_load_dword v9, s[8:11], s31 offen lds
    s_add_u32 m0, s33, 7168
    s_mov_b32 s31, 193536
    buffer_load_dword v10, s[8:11], s31 offen lds
    s_add_u32 m0, s33, 7424
    s_mov_b32 s31, 200448
    buffer_load_dword v11, s[8:11], s31 offen lds
    s_add_u32 m0, s33, 7680
    s_mov_b32 s31, 207360
    buffer_load_dword v10, s[8:11], s31 offen lds
    s_add_u32 m0, s33, 7936
    s_mov_b32 s31, 214272
    buffer_load_dword v11, s[8:11], s31 offen lds
    s_add_u32 m0, s33, 8192
    s_mov_b32 s31, 221184
    buffer_load_dword v8, s[8:11], s31 offen lds
    s_add_u32 m0, s33, 8448
    s_mov_b32 s31, 228096
    buffer_load_dword v9, s[8:11], s31 offen lds
    s_add_u32 m0, s33, 8704
    s_mov_b32 s31, 235008
    buffer_load_dword v8, s[8:11], s31 offen lds
    s_add_u32 m0, s33, 8960
    s_mov_b32 s31, 241920
    buffer_load_dword v9, s[8:11], s31 offen lds
    s_add_u32 m0, s33, 9216
    s_mov_b32 s31, 248832
    buffer_load_dword v10, s[8:11], s31 offen lds
    s_add_u32 m0, s33, 9472
    s_mov_b32 s31, 255744
    buffer_load_dword v11, s[8:11], s31 offen lds
    s_add_u32 m0, s33, 9728
    s_mov_b32 s31, 262656
    buffer_load_dword v10, s[8:11], s31 offen lds
    s_add_u32 m0, s33, 9984
    s_mov_b32 s31, 269568
    buffer_load_dword v11, s[8:11], s31 offen lds
    s_add_u32 m0, s33, 10240
    s_mov_b32 s31, 276480
    buffer_load_dword v8, s[8:11], s31 offen lds
    s_add_u32 m0, s33, 10496
    s_mov_b32 s31, 283392
    buffer_load_dword v9, s[8:11], s31 offen lds
    s_add_u32 m0, s33, 10752
    s_mov_b32 s31, 290304
    buffer_load_dword v8, s[8:11], s31 offen lds
    s_add_u32 m0, s33, 11008
    s_mov_b32 s31, 297216
    buffer_load_dword v9, s[8:11], s31 offen lds
    s_add_u32 m0, s33, 11264
    s_mov_b32 s31, 304128
    buffer_load_dword v10, s[8:11], s31 offen lds
    s_add_u32 m0, s33, 11520
    s_mov_b32 s31, 311040
    buffer_load_dword v11, s[8:11], s31 offen lds
    s_add_u32 m0, s33, 11776
    s_mov_b32 s31, 317952
    buffer_load_dword v10, s[8:11], s31 offen lds
    s_add_u32 m0, s33, 12032
    s_mov_b32 s31, 324864
    buffer_load_dword v11, s[8:11], s31 offen lds
    s_waitcnt vmcnt(32)
    ds_read_b64_tr_b16 a[0:1], v12 offset:0
    ds_read_b64_tr_b16 a[2:3], v12 offset:512
    ds_read_b64_tr_b16 a[72:73], v13 offset:0
    ds_read_b64_tr_b16 a[74:75], v13 offset:512
    ds_read_b64_tr_b16 a[144:145], v14 offset:0
    ds_read_b64_tr_b16 a[146:147], v14 offset:512
    ds_read_b64_tr_b16 a[216:217], v15 offset:0
    ds_read_b64_tr_b16 a[218:219], v15 offset:512
    s_waitcnt lgkmcnt(0)
    s_add_u32 m0, s33, 0
    s_mov_b32 s31, 331776
    buffer_load_dword v8, s[8:11], s31 offen lds
    s_add_u32 m0, s33, 256
    s_mov_b32 s31, 338688
    buffer_load_dword v9, s[8:11], s31 offen lds
    s_add_u32 m0, s33, 512
    s_mov_b32 s31, 345600
    buffer_load_dword v8, s[8:11], s31 offen lds
    s_add_u32 m0, s33, 768
    s_mov_b32 s31, 352512
    buffer_load_dword v9, s[8:11], s31 offen lds
    s_add_u32 m0, s33, 1024
    s_mov_b32 s31, 359424
    buffer_load_dword v10, s[8:11], s31 offen lds
    s_add_u32 m0, s33, 1280
    s_mov_b32 s31, 366336
    buffer_load_dword v11, s[8:11], s31 offen lds
    s_add_u32 m0, s33, 1536
    s_mov_b32 s31, 373248
    buffer_load_dword v10, s[8:11], s31 offen lds
    s_add_u32 m0, s33, 1792
    s_mov_b32 s31, 380160
    buffer_load_dword v11, s[8:11], s31 offen lds
    s_add_u32 m0, s33, 2048
    s_mov_b32 s31, 387072
    buffer_load_dword v8, s[8:11], s31 offen lds
    s_add_u32 m0, s33, 2304
    s_mov_b32 s31, 393984
    buffer_load_dword v9, s[8:11], s31 offen lds
    s_add_u32 m0, s33, 2560
    s_mov_b32 s31, 400896
    buffer_load_dword v8, s[8:11], s31 offen lds
    s_add_u32 m0, s33, 2816
    s_mov_b32 s31, 407808
    buffer_load_dword v9, s[8:11], s31 offen lds
    s_add_u32 m0, s33, 3072
    s_mov_b32 s31, 414720
    buffer_load_dword v10, s[8:11], s31 offen lds
    s_add_u32 m0, s33, 3328
    s_mov_b32 s31, 421632
    buffer_load_dword v11, s[8:11], s31 offen lds
    s_add_u32 m0, s33, 3584
    s_mov_b32 s31, 428544
    buffer_load_dword v10, s[8:11], s31 offen lds
    s_add_u32 m0, s33, 3840
    s_mov_b32 s31, 435456
    buffer_load_dword v11, s[8:11], s31 offen lds
    s_waitcnt vmcnt(32)
    ds_read_b64_tr_b16 a[4:5], v12 offset:4096
    ds_read_b64_tr_b16 a[6:7], v12 offset:4608
    ds_read_b64_tr_b16 a[76:77], v13 offset:4096
    ds_read_b64_tr_b16 a[78:79], v13 offset:4608
    ds_read_b64_tr_b16 a[148:149], v14 offset:4096
    ds_read_b64_tr_b16 a[150:151], v14 offset:4608
    ds_read_b64_tr_b16 a[220:221], v15 offset:4096
    ds_read_b64_tr_b16 a[222:223], v15 offset:4608
    s_waitcnt lgkmcnt(0)
    s_add_u32 m0, s33, 4096
    s_mov_b32 s31, 442368
    buffer_load_dword v8, s[8:11], s31 offen lds
    s_add_u32 m0, s33, 4352
    s_mov_b32 s31, 449280
    buffer_load_dword v9, s[8:11], s31 offen lds
    s_add_u32 m0, s33, 4608
    s_mov_b32 s31, 456192
    buffer_load_dword v8, s[8:11], s31 offen lds
    s_add_u32 m0, s33, 4864
    s_mov_b32 s31, 463104
    buffer_load_dword v9, s[8:11], s31 offen lds
    s_add_u32 m0, s33, 5120
    s_mov_b32 s31, 470016
    buffer_load_dword v10, s[8:11], s31 offen lds
    s_add_u32 m0, s33, 5376
    s_mov_b32 s31, 476928
    buffer_load_dword v11, s[8:11], s31 offen lds
    s_add_u32 m0, s33, 5632
    s_mov_b32 s31, 483840
    buffer_load_dword v10, s[8:11], s31 offen lds
    s_add_u32 m0, s33, 5888
    s_mov_b32 s31, 490752
    buffer_load_dword v11, s[8:11], s31 offen lds
    s_add_u32 m0, s33, 6144
    s_mov_b32 s31, 497664
    buffer_load_dword v8, s[8:11], s31 offen lds
    s_add_u32 m0, s33, 6400
    s_mov_b32 s31, 504576
    buffer_load_dword v9, s[8:11], s31 offen lds
    s_add_u32 m0, s33, 6656
    s_mov_b32 s31, 511488
    buffer_load_dword v8, s[8:11], s31 offen lds
    s_add_u32 m0, s33, 6912
    s_mov_b32 s31, 518400
    buffer_load_dword v9, s[8:11], s31 offen lds
    s_add_u32 m0, s33, 7168
    s_mov_b32 s31, 525312
    buffer_load_dword v10, s[8:11], s31 offen lds
    s_add_u32 m0, s33, 7424
    s_mov_b32 s31, 532224
    buffer_load_dword v11, s[8:11], s31 offen lds
    s_add_u32 m0, s33, 7680
    s_mov_b32 s31, 539136
    buffer_load_dword v10, s[8:11], s31 offen lds
    s_add_u32 m0, s33, 7936
    s_mov_b32 s31, 546048
    buffer_load_dword v11, s[8:11], s31 offen lds
    s_waitcnt vmcnt(32)
    ds_read_b64_tr_b16 a[8:9], v12 offset:8192
    ds_read_b64_tr_b16 a[10:11], v12 offset:8704
    ds_read_b64_tr_b16 a[80:81], v13 offset:8192
    ds_read_b64_tr_b16 a[82:83], v13 offset:8704
    ds_read_b64_tr_b16 a[152:153], v14 offset:8192
    ds_read_b64_tr_b16 a[154:155], v14 offset:8704
    ds_read_b64_tr_b16 a[224:225], v15 offset:8192
    ds_read_b64_tr_b16 a[226:227], v15 offset:8704
    s_waitcnt lgkmcnt(0)
    s_add_u32 m0, s33, 8192
    s_mov_b32 s31, 552960
    buffer_load_dword v8, s[8:11], s31 offen lds
    s_add_u32 m0, s33, 8448
    s_mov_b32 s31, 559872
    buffer_load_dword v9, s[8:11], s31 offen lds
    s_add_u32 m0, s33, 8704
    s_mov_b32 s31, 566784
    buffer_load_dword v8, s[8:11], s31 offen lds
    s_add_u32 m0, s33, 8960
    s_mov_b32 s31, 573696
    buffer_load_dword v9, s[8:11], s31 offen lds
    s_add_u32 m0, s33, 9216
    s_mov_b32 s31, 580608
    buffer_load_dword v10, s[8:11], s31 offen lds
    s_add_u32 m0, s33, 9472
    s_mov_b32 s31, 587520
    buffer_load_dword v11, s[8:11], s31 offen lds
    s_add_u32 m0, s33, 9728
    s_mov_b32 s31, 594432
    buffer_load_dword v10, s[8:11], s31 offen lds
    s_add_u32 m0, s33, 9984
    s_mov_b32 s31, 601344
    buffer_load_dword v11, s[8:11], s31 offen lds
    s_add_u32 m0, s33, 10240
    s_mov_b32 s31, 608256
    buffer_load_dword v8, s[8:11], s31 offen lds
    s_add_u32 m0, s33, 10496
    s_mov_b32 s31, 615168
    buffer_load_dword v9, s[8:11], s31 offen lds
    s_add_u32 m0, s33, 10752
    s_mov_b32 s31, 622080
    buffer_load_dword v8, s[8:11], s31 offen lds
    s_add_u32 m0, s33, 11008
    s_mov_b32 s31, 628992
    buffer_load_dword v9, s[8:11], s31 offen lds
    s_add_u32 m0, s33, 11264
    s_mov_b32 s31, 635904
    buffer_load_dword v10, s[8:11], s31 offen lds
    s_add_u32 m0, s33, 11520
    s_mov_b32 s31, 642816
    buffer_load_dword v11, s[8:11], s31 offen lds
    s_add_u32 m0, s33, 11776
    s_mov_b32 s31, 649728
    buffer_load_dword v10, s[8:11], s31 offen lds
    s_add_u32 m0, s33, 12032
    s_mov_b32 s31, 656640
    buffer_load_dword v11, s[8:11], s31 offen lds
    s_waitcnt vmcnt(32)
    ds_read_b64_tr_b16 a[12:13], v12 offset:0
    ds_read_b64_tr_b16 a[14:15], v12 offset:512
    ds_read_b64_tr_b16 a[84:85], v13 offset:0
    ds_read_b64_tr_b16 a[86:87], v13 offset:512
    ds_read_b64_tr_b16 a[156:157], v14 offset:0
    ds_read_b64_tr_b16 a[158:159], v14 offset:512
    ds_read_b64_tr_b16 a[228:229], v15 offset:0
    ds_read_b64_tr_b16 a[230:231], v15 offset:512
    s_waitcnt lgkmcnt(0)
    s_add_u32 m0, s33, 0
    s_mov_b32 s31, 663552
    buffer_load_dword v8, s[8:11], s31 offen lds
    s_add_u32 m0, s33, 256
    s_mov_b32 s31, 670464
    buffer_load_dword v9, s[8:11], s31 offen lds
    s_add_u32 m0, s33, 512
    s_mov_b32 s31, 677376
    buffer_load_dword v8, s[8:11], s31 offen lds
    s_add_u32 m0, s33, 768
    s_mov_b32 s31, 684288
    buffer_load_dword v9, s[8:11], s31 offen lds
    s_add_u32 m0, s33, 1024
    s_mov_b32 s31, 691200
    buffer_load_dword v10, s[8:11], s31 offen lds
    s_add_u32 m0, s33, 1280
    s_mov_b32 s31, 698112
    buffer_load_dword v11, s[8:11], s31 offen lds
    s_add_u32 m0, s33, 1536
    s_mov_b32 s31, 705024
    buffer_load_dword v10, s[8:11], s31 offen lds
    s_add_u32 m0, s33, 1792
    s_mov_b32 s31, 711936
    buffer_load_dword v11, s[8:11], s31 offen lds
    s_add_u32 m0, s33, 2048
    s_mov_b32 s31, 718848
    buffer_load_dword v8, s[8:11], s31 offen lds
    s_add_u32 m0, s33, 2304
    s_mov_b32 s31, 725760
    buffer_load_dword v9, s[8:11], s31 offen lds
    s_add_u32 m0, s33, 2560
    s_mov_b32 s31, 732672
    buffer_load_dword v8, s[8:11], s31 offen lds
    s_add_u32 m0, s33, 2816
    s_mov_b32 s31, 739584
    buffer_load_dword v9, s[8:11], s31 offen lds
    s_add_u32 m0, s33, 3072
    s_mov_b32 s31, 746496
    buffer_load_dword v10, s[8:11], s31 offen lds
    s_add_u32 m0, s33, 3328
    s_mov_b32 s31, 753408
    buffer_load_dword v11, s[8:11], s31 offen lds
    s_add_u32 m0, s33, 3584
    s_mov_b32 s31, 760320
    buffer_load_dword v10, s[8:11], s31 offen lds
    s_add_u32 m0, s33, 3840
    s_mov_b32 s31, 767232
    buffer_load_dword v11, s[8:11], s31 offen lds
    s_waitcnt vmcnt(32)
    ds_read_b64_tr_b16 a[16:17], v12 offset:4096
    ds_read_b64_tr_b16 a[18:19], v12 offset:4608
    ds_read_b64_tr_b16 a[88:89], v13 offset:4096
    ds_read_b64_tr_b16 a[90:91], v13 offset:4608
    ds_read_b64_tr_b16 a[160:161], v14 offset:4096
    ds_read_b64_tr_b16 a[162:163], v14 offset:4608
    ds_read_b64_tr_b16 a[232:233], v15 offset:4096
    ds_read_b64_tr_b16 a[234:235], v15 offset:4608
    s_waitcnt lgkmcnt(0)
    s_add_u32 m0, s33, 4096
    s_mov_b32 s31, 774144
    buffer_load_dword v8, s[8:11], s31 offen lds
    s_add_u32 m0, s33, 4352
    s_mov_b32 s31, 781056
    buffer_load_dword v9, s[8:11], s31 offen lds
    s_add_u32 m0, s33, 4608
    s_mov_b32 s31, 787968
    buffer_load_dword v8, s[8:11], s31 offen lds
    s_add_u32 m0, s33, 4864
    s_mov_b32 s31, 794880
    buffer_load_dword v9, s[8:11], s31 offen lds
    s_add_u32 m0, s33, 5120
    s_mov_b32 s31, 801792
    buffer_load_dword v10, s[8:11], s31 offen lds
    s_add_u32 m0, s33, 5376
    s_mov_b32 s31, 808704
    buffer_load_dword v11, s[8:11], s31 offen lds
    s_add_u32 m0, s33, 5632
    s_mov_b32 s31, 815616
    buffer_load_dword v10, s[8:11], s31 offen lds
    s_add_u32 m0, s33, 5888
    s_mov_b32 s31, 822528
    buffer_load_dword v11, s[8:11], s31 offen lds
    s_add_u32 m0, s33, 6144
    s_mov_b32 s31, 829440
    buffer_load_dword v8, s[8:11], s31 offen lds
    s_add_u32 m0, s33, 6400
    s_mov_b32 s31, 836352
    buffer_load_dword v9, s[8:11], s31 offen lds
    s_add_u32 m0, s33, 6656
    s_mov_b32 s31, 843264
    buffer_load_dword v8, s[8:11], s31 offen lds
    s_add_u32 m0, s33, 6912
    s_mov_b32 s31, 850176
    buffer_load_dword v9, s[8:11], s31 offen lds
    s_add_u32 m0, s33, 7168
    s_mov_b32 s31, 857088
    buffer_load_dword v10, s[8:11], s31 offen lds
    s_add_u32 m0, s33, 7424
    s_mov_b32 s31, 864000
    buffer_load_dword v11, s[8:11], s31 offen lds
    s_add_u32 m0, s33, 7680
    s_mov_b32 s31, 870912
    buffer_load_dword v10, s[8:11], s31 offen lds
    s_add_u32 m0, s33, 7936
    s_mov_b32 s31, 877824
    buffer_load_dword v11, s[8:11], s31 offen lds
    s_waitcnt vmcnt(32)
    ds_read_b64_tr_b16 a[20:21], v12 offset:8192
    ds_read_b64_tr_b16 a[22:23], v12 offset:8704
    ds_read_b64_tr_b16 a[92:93], v13 offset:8192
    ds_read_b64_tr_b16 a[94:95], v13 offset:8704
    ds_read_b64_tr_b16 a[164:165], v14 offset:8192
    ds_read_b64_tr_b16 a[166:167], v14 offset:8704
    ds_read_b64_tr_b16 a[236:237], v15 offset:8192
    ds_read_b64_tr_b16 a[238:239], v15 offset:8704
    s_waitcnt lgkmcnt(0)
    s_add_u32 m0, s33, 8192
    s_mov_b32 s31, 884736
    buffer_load_dword v8, s[8:11], s31 offen lds
    s_add_u32 m0, s33, 8448
    s_mov_b32 s31, 891648
    buffer_load_dword v9, s[8:11], s31 offen lds
    s_add_u32 m0, s33, 8704
    s_mov_b32 s31, 898560
    buffer_load_dword v8, s[8:11], s31 offen lds
    s_add_u32 m0, s33, 8960
    s_mov_b32 s31, 905472
    buffer_load_dword v9, s[8:11], s31 offen lds
    s_add_u32 m0, s33, 9216
    s_mov_b32 s31, 912384
    buffer_load_dword v10, s[8:11], s31 offen lds
    s_add_u32 m0, s33, 9472
    s_mov_b32 s31, 919296
    buffer_load_dword v11, s[8:11], s31 offen lds
    s_add_u32 m0, s33, 9728
    s_mov_b32 s31, 926208
    buffer_load_dword v10, s[8:11], s31 offen lds
    s_add_u32 m0, s33, 9984
    s_mov_b32 s31, 933120
    buffer_load_dword v11, s[8:11], s31 offen lds
    s_add_u32 m0, s33, 10240
    s_mov_b32 s31, 940032
    buffer_load_dword v8, s[8:11], s31 offen lds
    s_add_u32 m0, s33, 10496
    s_mov_b32 s31, 946944
    buffer_load_dword v9, s[8:11], s31 offen lds
    s_add_u32 m0, s33, 10752
    s_mov_b32 s31, 953856
    buffer_load_dword v8, s[8:11], s31 offen lds
    s_add_u32 m0, s33, 11008
    s_mov_b32 s31, 960768
    buffer_load_dword v9, s[8:11], s31 offen lds
    s_add_u32 m0, s33, 11264
    s_mov_b32 s31, 967680
    buffer_load_dword v10, s[8:11], s31 offen lds
    s_add_u32 m0, s33, 11520
    s_mov_b32 s31, 974592
    buffer_load_dword v11, s[8:11], s31 offen lds
    s_add_u32 m0, s33, 11776
    s_mov_b32 s31, 981504
    buffer_load_dword v10, s[8:11], s31 offen lds
    s_add_u32 m0, s33, 12032
    s_mov_b32 s31, 988416
    buffer_load_dword v11, s[8:11], s31 offen lds
    s_waitcnt vmcnt(32)
    ds_read_b64_tr_b16 a[24:25], v12 offset:0
    ds_read_b64_tr_b16 a[26:27], v12 offset:512
    ds_read_b64_tr_b16 a[96:97], v13 offset:0
    ds_read_b64_tr_b16 a[98:99], v13 offset:512
    ds_read_b64_tr_b16 a[168:169], v14 offset:0
    ds_read_b64_tr_b16 a[170:171], v14 offset:512
    ds_read_b64_tr_b16 a[240:241], v15 offset:0
    ds_read_b64_tr_b16 a[242:243], v15 offset:512
    s_waitcnt lgkmcnt(0)
    s_add_u32 m0, s33, 0
    s_mov_b32 s31, 995328
    buffer_load_dword v8, s[8:11], s31 offen lds
    s_add_u32 m0, s33, 256
    s_mov_b32 s31, 1002240
    buffer_load_dword v9, s[8:11], s31 offen lds
    s_add_u32 m0, s33, 512
    s_mov_b32 s31, 1009152
    buffer_load_dword v8, s[8:11], s31 offen lds
    s_add_u32 m0, s33, 768
    s_mov_b32 s31, 1016064
    buffer_load_dword v9, s[8:11], s31 offen lds
    s_add_u32 m0, s33, 1024
    s_mov_b32 s31, 1022976
    buffer_load_dword v10, s[8:11], s31 offen lds
    s_add_u32 m0, s33, 1280
    s_mov_b32 s31, 1029888
    buffer_load_dword v11, s[8:11], s31 offen lds
    s_add_u32 m0, s33, 1536
    s_mov_b32 s31, 1036800
    buffer_load_dword v10, s[8:11], s31 offen lds
    s_add_u32 m0, s33, 1792
    s_mov_b32 s31, 1043712
    buffer_load_dword v11, s[8:11], s31 offen lds
    s_add_u32 m0, s33, 2048
    s_mov_b32 s31, 1050624
    buffer_load_dword v8, s[8:11], s31 offen lds
    s_add_u32 m0, s33, 2304
    s_mov_b32 s31, 1057536
    buffer_load_dword v9, s[8:11], s31 offen lds
    s_add_u32 m0, s33, 2560
    s_mov_b32 s31, 1064448
    buffer_load_dword v8, s[8:11], s31 offen lds
    s_add_u32 m0, s33, 2816
    s_mov_b32 s31, 1071360
    buffer_load_dword v9, s[8:11], s31 offen lds
    s_add_u32 m0, s33, 3072
    s_mov_b32 s31, 1078272
    buffer_load_dword v10, s[8:11], s31 offen lds
    s_add_u32 m0, s33, 3328
    s_mov_b32 s31, 1085184
    buffer_load_dword v11, s[8:11], s31 offen lds
    s_add_u32 m0, s33, 3584
    s_mov_b32 s31, 1092096
    buffer_load_dword v10, s[8:11], s31 offen lds
    s_add_u32 m0, s33, 3840
    s_mov_b32 s31, 1099008
    buffer_load_dword v11, s[8:11], s31 offen lds
    s_waitcnt vmcnt(32)
    ds_read_b64_tr_b16 a[28:29], v12 offset:4096
    ds_read_b64_tr_b16 a[30:31], v12 offset:4608
    ds_read_b64_tr_b16 a[100:101], v13 offset:4096
    ds_read_b64_tr_b16 a[102:103], v13 offset:4608
    ds_read_b64_tr_b16 a[172:173], v14 offset:4096
    ds_read_b64_tr_b16 a[174:175], v14 offset:4608
    ds_read_b64_tr_b16 a[244:245], v15 offset:4096
    ds_read_b64_tr_b16 a[246:247], v15 offset:4608
    s_waitcnt lgkmcnt(0)
    s_add_u32 m0, s33, 4096
    s_mov_b32 s31, 1105920
    buffer_load_dword v8, s[8:11], s31 offen lds
    s_add_u32 m0, s33, 4352
    s_mov_b32 s31, 1112832
    buffer_load_dword v9, s[8:11], s31 offen lds
    s_add_u32 m0, s33, 4608
    s_mov_b32 s31, 1119744
    buffer_load_dword v8, s[8:11], s31 offen lds
    s_add_u32 m0, s33, 4864
    s_mov_b32 s31, 1126656
    buffer_load_dword v9, s[8:11], s31 offen lds
    s_add_u32 m0, s33, 5120
    s_mov_b32 s31, 1133568
    buffer_load_dword v10, s[8:11], s31 offen lds
    s_add_u32 m0, s33, 5376
    s_mov_b32 s31, 1140480
    buffer_load_dword v11, s[8:11], s31 offen lds
    s_add_u32 m0, s33, 5632
    s_mov_b32 s31, 1147392
    buffer_load_dword v10, s[8:11], s31 offen lds
    s_add_u32 m0, s33, 5888
    s_mov_b32 s31, 1154304
    buffer_load_dword v11, s[8:11], s31 offen lds
    s_add_u32 m0, s33, 6144
    s_mov_b32 s31, 1161216
    buffer_load_dword v8, s[8:11], s31 offen lds
    s_add_u32 m0, s33, 6400
    s_mov_b32 s31, 1168128
    buffer_load_dword v9, s[8:11], s31 offen lds
    s_add_u32 m0, s33, 6656
    s_mov_b32 s31, 1175040
    buffer_load_dword v8, s[8:11], s31 offen lds
    s_add_u32 m0, s33, 6912
    s_mov_b32 s31, 1181952
    buffer_load_dword v9, s[8:11], s31 offen lds
    s_add_u32 m0, s33, 7168
    s_mov_b32 s31, 1188864
    buffer_load_dword v10, s[8:11], s31 offen lds
    s_add_u32 m0, s33, 7424
    s_mov_b32 s31, 1195776
    buffer_load_dword v11, s[8:11], s31 offen lds
    s_add_u32 m0, s33, 7680
    s_mov_b32 s31, 1202688
    buffer_load_dword v10, s[8:11], s31 offen lds
    s_add_u32 m0, s33, 7936
    s_mov_b32 s31, 1209600
    buffer_load_dword v11, s[8:11], s31 offen lds
    s_waitcnt vmcnt(32)
    ds_read_b64_tr_b16 a[32:33], v12 offset:8192
    ds_read_b64_tr_b16 a[34:35], v12 offset:8704
    ds_read_b64_tr_b16 a[104:105], v13 offset:8192
    ds_read_b64_tr_b16 a[106:107], v13 offset:8704
    ds_read_b64_tr_b16 a[176:177], v14 offset:8192
    ds_read_b64_tr_b16 a[178:179], v14 offset:8704
    ds_read_b64_tr_b16 a[248:249], v15 offset:8192
    ds_read_b64_tr_b16 a[250:251], v15 offset:8704
    s_waitcnt lgkmcnt(0)
    s_add_u32 m0, s33, 8192
    s_mov_b32 s31, 1216512
    buffer_load_dword v8, s[8:11], s31 offen lds
    s_add_u32 m0, s33, 8448
    s_mov_b32 s31, 1223424
    buffer_load_dword v9, s[8:11], s31 offen lds
    s_add_u32 m0, s33, 8704
    s_mov_b32 s31, 1230336
    buffer_load_dword v8, s[8:11], s31 offen lds
    s_add_u32 m0, s33, 8960
    s_mov_b32 s31, 1237248
    buffer_load_dword v9, s[8:11], s31 offen lds
    s_add_u32 m0, s33, 9216
    s_mov_b32 s31, 1244160
    buffer_load_dword v10, s[8:11], s31 offen lds
    s_add_u32 m0, s33, 9472
    s_mov_b32 s31, 1251072
    buffer_load_dword v11, s[8:11], s31 offen lds
    s_add_u32 m0, s33, 9728
    s_mov_b32 s31, 1257984
    buffer_load_dword v10, s[8:11], s31 offen lds
    s_add_u32 m0, s33, 9984
    s_mov_b32 s31, 1264896
    buffer_load_dword v11, s[8:11], s31 offen lds
    s_add_u32 m0, s33, 10240
    s_mov_b32 s31, 1271808
    buffer_load_dword v8, s[8:11], s31 offen lds
    s_add_u32 m0, s33, 10496
    s_mov_b32 s31, 1278720
    buffer_load_dword v9, s[8:11], s31 offen lds
    s_add_u32 m0, s33, 10752
    s_mov_b32 s31, 1285632
    buffer_load_dword v8, s[8:11], s31 offen lds
    s_add_u32 m0, s33, 11008
    s_mov_b32 s31, 1292544
    buffer_load_dword v9, s[8:11], s31 offen lds
    s_add_u32 m0, s33, 11264
    s_mov_b32 s31, 1299456
    buffer_load_dword v10, s[8:11], s31 offen lds
    s_add_u32 m0, s33, 11520
    s_mov_b32 s31, 1306368
    buffer_load_dword v11, s[8:11], s31 offen lds
    s_add_u32 m0, s33, 11776
    s_mov_b32 s31, 1313280
    buffer_load_dword v10, s[8:11], s31 offen lds
    s_add_u32 m0, s33, 12032
    s_mov_b32 s31, 1320192
    buffer_load_dword v11, s[8:11], s31 offen lds
    s_waitcnt vmcnt(32)
    ds_read_b64_tr_b16 a[36:37], v12 offset:0
    ds_read_b64_tr_b16 a[38:39], v12 offset:512
    ds_read_b64_tr_b16 a[108:109], v13 offset:0
    ds_read_b64_tr_b16 a[110:111], v13 offset:512
    ds_read_b64_tr_b16 a[180:181], v14 offset:0
    ds_read_b64_tr_b16 a[182:183], v14 offset:512
    ds_read_b64_tr_b16 a[252:253], v15 offset:0
    ds_read_b64_tr_b16 a[254:255], v15 offset:512
    s_waitcnt lgkmcnt(0)
    s_add_u32 m0, s33, 0
    s_mov_b32 s31, 1327104
    buffer_load_dword v8, s[8:11], s31 offen lds
    s_add_u32 m0, s33, 256
    s_mov_b32 s31, 1334016
    buffer_load_dword v9, s[8:11], s31 offen lds
    s_add_u32 m0, s33, 512
    s_mov_b32 s31, 1340928
    buffer_load_dword v8, s[8:11], s31 offen lds
    s_add_u32 m0, s33, 768
    s_mov_b32 s31, 1347840
    buffer_load_dword v9, s[8:11], s31 offen lds
    s_add_u32 m0, s33, 1024
    s_mov_b32 s31, 1354752
    buffer_load_dword v10, s[8:11], s31 offen lds
    s_add_u32 m0, s33, 1280
    s_mov_b32 s31, 1361664
    buffer_load_dword v11, s[8:11], s31 offen lds
    s_add_u32 m0, s33, 1536
    s_mov_b32 s31, 1368576
    buffer_load_dword v10, s[8:11], s31 offen lds
    s_add_u32 m0, s33, 1792
    s_mov_b32 s31, 1375488
    buffer_load_dword v11, s[8:11], s31 offen lds
    s_add_u32 m0, s33, 2048
    s_mov_b32 s31, 1382400
    buffer_load_dword v8, s[8:11], s31 offen lds
    s_add_u32 m0, s33, 2304
    s_mov_b32 s31, 1389312
    buffer_load_dword v9, s[8:11], s31 offen lds
    s_add_u32 m0, s33, 2560
    s_mov_b32 s31, 1396224
    buffer_load_dword v8, s[8:11], s31 offen lds
    s_add_u32 m0, s33, 2816
    s_mov_b32 s31, 1403136
    buffer_load_dword v9, s[8:11], s31 offen lds
    s_add_u32 m0, s33, 3072
    s_mov_b32 s31, 1410048
    buffer_load_dword v10, s[8:11], s31 offen lds
    s_add_u32 m0, s33, 3328
    s_mov_b32 s31, 1416960
    buffer_load_dword v11, s[8:11], s31 offen lds
    s_add_u32 m0, s33, 3584
    s_mov_b32 s31, 1423872
    buffer_load_dword v10, s[8:11], s31 offen lds
    s_add_u32 m0, s33, 3840
    s_mov_b32 s31, 1430784
    buffer_load_dword v11, s[8:11], s31 offen lds
    s_waitcnt vmcnt(32)
    ds_read_b64_tr_b16 a[40:41], v12 offset:4096
    ds_read_b64_tr_b16 a[42:43], v12 offset:4608
    ds_read_b64_tr_b16 a[112:113], v13 offset:4096
    ds_read_b64_tr_b16 a[114:115], v13 offset:4608
    ds_read_b64_tr_b16 a[184:185], v14 offset:4096
    ds_read_b64_tr_b16 a[186:187], v14 offset:4608
    ds_read_b64_tr_b16 v[208:209], v15 offset:4096
    ds_read_b64_tr_b16 v[210:211], v15 offset:4608
    s_waitcnt lgkmcnt(0)
    s_add_u32 m0, s33, 4096
    s_mov_b32 s31, 1437696
    buffer_load_dword v8, s[8:11], s31 offen lds
    s_add_u32 m0, s33, 4352
    s_mov_b32 s31, 1444608
    buffer_load_dword v9, s[8:11], s31 offen lds
    s_add_u32 m0, s33, 4608
    s_mov_b32 s31, 1451520
    buffer_load_dword v8, s[8:11], s31 offen lds
    s_add_u32 m0, s33, 4864
    s_mov_b32 s31, 1458432
    buffer_load_dword v9, s[8:11], s31 offen lds
    s_add_u32 m0, s33, 5120
    s_mov_b32 s31, 1465344
    buffer_load_dword v10, s[8:11], s31 offen lds
    s_add_u32 m0, s33, 5376
    s_mov_b32 s31, 1472256
    buffer_load_dword v11, s[8:11], s31 offen lds
    s_add_u32 m0, s33, 5632
    s_mov_b32 s31, 1479168
    buffer_load_dword v10, s[8:11], s31 offen lds
    s_add_u32 m0, s33, 5888
    s_mov_b32 s31, 1486080
    buffer_load_dword v11, s[8:11], s31 offen lds
    s_add_u32 m0, s33, 6144
    s_mov_b32 s31, 1492992
    buffer_load_dword v8, s[8:11], s31 offen lds
    s_add_u32 m0, s33, 6400
    s_mov_b32 s31, 1499904
    buffer_load_dword v9, s[8:11], s31 offen lds
    s_add_u32 m0, s33, 6656
    s_mov_b32 s31, 1506816
    buffer_load_dword v8, s[8:11], s31 offen lds
    s_add_u32 m0, s33, 6912
    s_mov_b32 s31, 1513728
    buffer_load_dword v9, s[8:11], s31 offen lds
    s_add_u32 m0, s33, 7168
    s_mov_b32 s31, 1520640
    buffer_load_dword v10, s[8:11], s31 offen lds
    s_add_u32 m0, s33, 7424
    s_mov_b32 s31, 1527552
    buffer_load_dword v11, s[8:11], s31 offen lds
    s_add_u32 m0, s33, 7680
    s_mov_b32 s31, 1534464
    buffer_load_dword v10, s[8:11], s31 offen lds
    s_add_u32 m0, s33, 7936
    s_mov_b32 s31, 1541376
    buffer_load_dword v11, s[8:11], s31 offen lds
    s_waitcnt vmcnt(32)
    ds_read_b64_tr_b16 a[44:45], v12 offset:8192
    ds_read_b64_tr_b16 a[46:47], v12 offset:8704
    ds_read_b64_tr_b16 a[116:117], v13 offset:8192
    ds_read_b64_tr_b16 a[118:119], v13 offset:8704
    ds_read_b64_tr_b16 a[188:189], v14 offset:8192
    ds_read_b64_tr_b16 a[190:191], v14 offset:8704
    ds_read_b64_tr_b16 v[212:213], v15 offset:8192
    ds_read_b64_tr_b16 v[214:215], v15 offset:8704
    s_waitcnt lgkmcnt(0)
    s_add_u32 m0, s33, 8192
    s_mov_b32 s31, 1548288
    buffer_load_dword v8, s[8:11], s31 offen lds
    s_add_u32 m0, s33, 8448
    s_mov_b32 s31, 1555200
    buffer_load_dword v9, s[8:11], s31 offen lds
    s_add_u32 m0, s33, 8704
    s_mov_b32 s31, 1562112
    buffer_load_dword v8, s[8:11], s31 offen lds
    s_add_u32 m0, s33, 8960
    s_mov_b32 s31, 1569024
    buffer_load_dword v9, s[8:11], s31 offen lds
    s_add_u32 m0, s33, 9216
    s_mov_b32 s31, 1575936
    buffer_load_dword v10, s[8:11], s31 offen lds
    s_add_u32 m0, s33, 9472
    s_mov_b32 s31, 1582848
    buffer_load_dword v11, s[8:11], s31 offen lds
    s_add_u32 m0, s33, 9728
    s_mov_b32 s31, 1589760
    buffer_load_dword v10, s[8:11], s31 offen lds
    s_add_u32 m0, s33, 9984
    s_mov_b32 s31, 1596672
    buffer_load_dword v11, s[8:11], s31 offen lds
    s_add_u32 m0, s33, 10240
    s_mov_b32 s31, 1603584
    buffer_load_dword v8, s[8:11], s31 offen lds
    s_add_u32 m0, s33, 10496
    s_mov_b32 s31, 1610496
    buffer_load_dword v9, s[8:11], s31 offen lds
    s_add_u32 m0, s33, 10752
    s_mov_b32 s31, 1617408
    buffer_load_dword v8, s[8:11], s31 offen lds
    s_add_u32 m0, s33, 11008
    s_mov_b32 s31, 1624320
    buffer_load_dword v9, s[8:11], s31 offen lds
    s_add_u32 m0, s33, 11264
    s_mov_b32 s31, 1631232
    buffer_load_dword v10, s[8:11], s31 offen lds
    s_add_u32 m0, s33, 11520
    s_mov_b32 s31, 1638144
    buffer_load_dword v11, s[8:11], s31 offen lds
    s_add_u32 m0, s33, 11776
    s_mov_b32 s31, 1645056
    buffer_load_dword v10, s[8:11], s31 offen lds
    s_add_u32 m0, s33, 12032
    s_mov_b32 s31, 1651968
    buffer_load_dword v11, s[8:11], s31 offen lds
    s_waitcnt vmcnt(32)
    ds_read_b64_tr_b16 a[48:49], v12 offset:0
    ds_read_b64_tr_b16 a[50:51], v12 offset:512
    ds_read_b64_tr_b16 a[120:121], v13 offset:0
    ds_read_b64_tr_b16 a[122:123], v13 offset:512
    ds_read_b64_tr_b16 a[192:193], v14 offset:0
    ds_read_b64_tr_b16 a[194:195], v14 offset:512
    ds_read_b64_tr_b16 v[216:217], v15 offset:0
    ds_read_b64_tr_b16 v[218:219], v15 offset:512
    s_waitcnt lgkmcnt(0)
    s_add_u32 m0, s33, 0
    s_mov_b32 s31, 1658880
    buffer_load_dword v8, s[8:11], s31 offen lds
    s_add_u32 m0, s33, 256
    s_mov_b32 s31, 1665792
    buffer_load_dword v9, s[8:11], s31 offen lds
    s_add_u32 m0, s33, 512
    s_mov_b32 s31, 1672704
    buffer_load_dword v8, s[8:11], s31 offen lds
    s_add_u32 m0, s33, 768
    s_mov_b32 s31, 1679616
    buffer_load_dword v9, s[8:11], s31 offen lds
    s_add_u32 m0, s33, 1024
    s_mov_b32 s31, 1686528
    buffer_load_dword v10, s[8:11], s31 offen lds
    s_add_u32 m0, s33, 1280
    s_mov_b32 s31, 1693440
    buffer_load_dword v11, s[8:11], s31 offen lds
    s_add_u32 m0, s33, 1536
    s_mov_b32 s31, 1700352
    buffer_load_dword v10, s[8:11], s31 offen lds
    s_add_u32 m0, s33, 1792
    s_mov_b32 s31, 1707264
    buffer_load_dword v11, s[8:11], s31 offen lds
    s_add_u32 m0, s33, 2048
    s_mov_b32 s31, 1714176
    buffer_load_dword v8, s[8:11], s31 offen lds
    s_add_u32 m0, s33, 2304
    s_mov_b32 s31, 1721088
    buffer_load_dword v9, s[8:11], s31 offen lds
    s_add_u32 m0, s33, 2560
    s_mov_b32 s31, 1728000
    buffer_load_dword v8, s[8:11], s31 offen lds
    s_add_u32 m0, s33, 2816
    s_mov_b32 s31, 1734912
    buffer_load_dword v9, s[8:11], s31 offen lds
    s_add_u32 m0, s33, 3072
    s_mov_b32 s31, 1741824
    buffer_load_dword v10, s[8:11], s31 offen lds
    s_add_u32 m0, s33, 3328
    s_mov_b32 s31, 1748736
    buffer_load_dword v11, s[8:11], s31 offen lds
    s_add_u32 m0, s33, 3584
    s_mov_b32 s31, 1755648
    buffer_load_dword v10, s[8:11], s31 offen lds
    s_add_u32 m0, s33, 3840
    s_mov_b32 s31, 1762560
    buffer_load_dword v11, s[8:11], s31 offen lds
    s_waitcnt vmcnt(32)
    ds_read_b64_tr_b16 a[52:53], v12 offset:4096
    ds_read_b64_tr_b16 a[54:55], v12 offset:4608
    ds_read_b64_tr_b16 a[124:125], v13 offset:4096
    ds_read_b64_tr_b16 a[126:127], v13 offset:4608
    ds_read_b64_tr_b16 a[196:197], v14 offset:4096
    ds_read_b64_tr_b16 a[198:199], v14 offset:4608
    ds_read_b64_tr_b16 v[220:221], v15 offset:4096
    ds_read_b64_tr_b16 v[222:223], v15 offset:4608
    s_waitcnt lgkmcnt(0)
    s_add_u32 m0, s33, 4096
    s_mov_b32 s31, 1769472
    buffer_load_dword v8, s[8:11], s31 offen lds
    s_add_u32 m0, s33, 4352
    s_mov_b32 s31, 1776384
    buffer_load_dword v9, s[8:11], s31 offen lds
    s_add_u32 m0, s33, 4608
    s_mov_b32 s31, 1783296
    buffer_load_dword v8, s[8:11], s31 offen lds
    s_add_u32 m0, s33, 4864
    s_mov_b32 s31, 1790208
    buffer_load_dword v9, s[8:11], s31 offen lds
    s_add_u32 m0, s33, 5120
    s_mov_b32 s31, 1797120
    buffer_load_dword v10, s[8:11], s31 offen lds
    s_add_u32 m0, s33, 5376
    s_mov_b32 s31, 1804032
    buffer_load_dword v11, s[8:11], s31 offen lds
    s_add_u32 m0, s33, 5632
    s_mov_b32 s31, 1810944
    buffer_load_dword v10, s[8:11], s31 offen lds
    s_add_u32 m0, s33, 5888
    s_mov_b32 s31, 1817856
    buffer_load_dword v11, s[8:11], s31 offen lds
    s_add_u32 m0, s33, 6144
    s_mov_b32 s31, 1824768
    buffer_load_dword v8, s[8:11], s31 offen lds
    s_add_u32 m0, s33, 6400
    s_mov_b32 s31, 1831680
    buffer_load_dword v9, s[8:11], s31 offen lds
    s_add_u32 m0, s33, 6656
    s_mov_b32 s31, 1838592
    buffer_load_dword v8, s[8:11], s31 offen lds
    s_add_u32 m0, s33, 6912
    s_mov_b32 s31, 1845504
    buffer_load_dword v9, s[8:11], s31 offen lds
    s_add_u32 m0, s33, 7168
    s_mov_b32 s31, 1852416
    buffer_load_dword v10, s[8:11], s31 offen lds
    s_add_u32 m0, s33, 7424
    s_mov_b32 s31, 1859328
    buffer_load_dword v11, s[8:11], s31 offen lds
    s_add_u32 m0, s33, 7680
    s_mov_b32 s31, 1866240
    buffer_load_dword v10, s[8:11], s31 offen lds
    s_add_u32 m0, s33, 7936
    s_mov_b32 s31, 1873152
    buffer_load_dword v11, s[8:11], s31 offen lds
    s_waitcnt vmcnt(32)
    ds_read_b64_tr_b16 a[56:57], v12 offset:8192
    ds_read_b64_tr_b16 a[58:59], v12 offset:8704
    ds_read_b64_tr_b16 a[128:129], v13 offset:8192
    ds_read_b64_tr_b16 a[130:131], v13 offset:8704
    ds_read_b64_tr_b16 a[200:201], v14 offset:8192
    ds_read_b64_tr_b16 a[202:203], v14 offset:8704
    ds_read_b64_tr_b16 v[224:225], v15 offset:8192
    ds_read_b64_tr_b16 v[226:227], v15 offset:8704
    s_waitcnt lgkmcnt(0)
    s_add_u32 m0, s33, 8192
    s_mov_b32 s31, 1880064
    buffer_load_dword v8, s[8:11], s31 offen lds
    s_add_u32 m0, s33, 8448
    s_mov_b32 s31, 1886976
    buffer_load_dword v9, s[8:11], s31 offen lds
    s_add_u32 m0, s33, 8704
    s_mov_b32 s31, 1893888
    buffer_load_dword v8, s[8:11], s31 offen lds
    s_add_u32 m0, s33, 8960
    s_mov_b32 s31, 1900800
    buffer_load_dword v9, s[8:11], s31 offen lds
    s_add_u32 m0, s33, 9216
    s_mov_b32 s31, 1907712
    buffer_load_dword v10, s[8:11], s31 offen lds
    s_add_u32 m0, s33, 9472
    s_mov_b32 s31, 1914624
    buffer_load_dword v11, s[8:11], s31 offen lds
    s_add_u32 m0, s33, 9728
    s_mov_b32 s31, 1921536
    buffer_load_dword v10, s[8:11], s31 offen lds
    s_add_u32 m0, s33, 9984
    s_mov_b32 s31, 1928448
    buffer_load_dword v11, s[8:11], s31 offen lds
    s_add_u32 m0, s33, 10240
    s_mov_b32 s31, 1935360
    buffer_load_dword v8, s[8:11], s31 offen lds
    s_add_u32 m0, s33, 10496
    s_mov_b32 s31, 1942272
    buffer_load_dword v9, s[8:11], s31 offen lds
    s_add_u32 m0, s33, 10752
    s_mov_b32 s31, 1949184
    buffer_load_dword v8, s[8:11], s31 offen lds
    s_add_u32 m0, s33, 11008
    s_mov_b32 s31, 1956096
    buffer_load_dword v9, s[8:11], s31 offen lds
    s_add_u32 m0, s33, 11264
    s_mov_b32 s31, 1963008
    buffer_load_dword v10, s[8:11], s31 offen lds
    s_add_u32 m0, s33, 11520
    s_mov_b32 s31, 1969920
    buffer_load_dword v11, s[8:11], s31 offen lds
    s_add_u32 m0, s33, 11776
    s_mov_b32 s31, 1976832
    buffer_load_dword v10, s[8:11], s31 offen lds
    s_add_u32 m0, s33, 12032
    s_mov_b32 s31, 1983744
    buffer_load_dword v11, s[8:11], s31 offen lds
    s_waitcnt vmcnt(32)
    ds_read_b64_tr_b16 a[60:61], v12 offset:0
    ds_read_b64_tr_b16 a[62:63], v12 offset:512
    ds_read_b64_tr_b16 a[132:133], v13 offset:0
    ds_read_b64_tr_b16 a[134:135], v13 offset:512
    ds_read_b64_tr_b16 a[204:205], v14 offset:0
    ds_read_b64_tr_b16 a[206:207], v14 offset:512
    ds_read_b64_tr_b16 v[228:229], v15 offset:0
    ds_read_b64_tr_b16 v[230:231], v15 offset:512
    s_waitcnt vmcnt(16)
    ds_read_b64_tr_b16 a[64:65], v12 offset:4096
    ds_read_b64_tr_b16 a[66:67], v12 offset:4608
    ds_read_b64_tr_b16 a[136:137], v13 offset:4096
    ds_read_b64_tr_b16 a[138:139], v13 offset:4608
    ds_read_b64_tr_b16 a[208:209], v14 offset:4096
    ds_read_b64_tr_b16 a[210:211], v14 offset:4608
    ds_read_b64_tr_b16 v[232:233], v15 offset:4096
    ds_read_b64_tr_b16 v[234:235], v15 offset:4608
    s_waitcnt vmcnt(0)
    ds_read_b64_tr_b16 a[68:69], v12 offset:8192
    ds_read_b64_tr_b16 a[70:71], v12 offset:8704
    ds_read_b64_tr_b16 a[140:141], v13 offset:8192
    ds_read_b64_tr_b16 a[142:143], v13 offset:8704
    ds_read_b64_tr_b16 a[212:213], v14 offset:8192
    ds_read_b64_tr_b16 a[214:215], v14 offset:8704
    ds_read_b64_tr_b16 v[236:237], v15 offset:8192
    ds_read_b64_tr_b16 v[238:239], v15 offset:8704
    s_load_dwordx2 s[60:61], s[0:1], 96
    s_mov_b32 s62, 256
    s_mov_b32 s63, 0x20000
    v_mov_b32 v21, 0
    s_waitcnt lgkmcnt(0)
WI_40:
    buffer_load_dword v20, v21, s[60:63], 0 offen offset:128 sc1
    s_waitcnt vmcnt(0)
    v_readfirstlane_b32 s64, v20
    s_sub_u32 s22, s22, 1
    s_cbranch_scc1 W_FAIL
    s_cmp_lt_u32 s64, 256
    s_cbranch_scc1 WI_40
    v_mov_b32 v96, 0
    v_mov_b32 v97, 0
    v_mov_b32 v98, 0
    v_mov_b32 v99, 0
    v_mov_b32 v100, 0
    v_mov_b32 v101, 0
    v_mov_b32 v102, 0
    v_mov_b32 v103, 0
    v_mov_b32 v104, 0
    v_mov_b32 v105, 0
    v_mov_b32 v106, 0
    v_mov_b32 v107, 0
    v_mov_b32 v108, 0
    v_mov_b32 v109, 0
    v_mov_b32 v110, 0
    v_mov_b32 v111, 0
    v_mov_b32 v112, 0
    v_mov_b32 v113, 0
    v_mov_b32 v114, 0
    v_mov_b32 v115, 0
    v_mov_b32 v116, 0
    v_mov_b32 v117, 0
    v_mov_b32 v118, 0
    v_mov_b32 v119, 0
    v_mov_b32 v120, 0x3f803f80
    v_mov_b32 v121, 0x3f803f80
    v_mov_b32 v122, 0x3f803f80
    v_mov_b32 v123, 0x3f803f80
    s_mov_b32 s28, 0
    v_mov_b32 v203, 0
    s_mov_b32 s40, 0xffff0000
    s_mov_b32 s41, 0
    s_waitcnt vmcnt(0) lgkmcnt(0)
BL_41:
    s_waitcnt vmcnt(2)
    s_barrier
    v_add_u32 v205, s29, v200
    s_add_u32 s25, s25, 36864
    s_xor_b32 s29, s29, 98304
    s_add_u32 s31, s25, s34
    s_add_u32 s32, s29, s35
    s_add_u32 m0, s32, 0
    s_nop 0
    buffer_load_dwordx4 v202, s[16:19], s31 offen lds
    s_add_u32 m0, s32, 1024
    s_add_u32 s31, s31, 64
    buffer_load_dwordx4 v202, s[16:19], s31 offen lds
    s_add_u32 m0, s32, 2048
    s_add_u32 s31, s31, 64
    buffer_load_dwordx4 v202, s[16:19], s31 offen lds
    s_add_u32 m0, s32, 3072
    s_add_u32 s31, s31, 64
    buffer_load_dwordx4 v202, s[16:19], s31 offen lds
    s_add_u32 m0, s32, 4096
    s_add_u32 s31, s31, 64
    buffer_load_dwordx4 v202, s[16:19], s31 offen lds
    s_add_u32 m0, s32, 5120
    s_add_u32 s31, s31, 64
    buffer_load_dwordx4 v202, s[16:19], s31 offen lds
    s_add_u32 m0, s32, 6144
    s_add_u32 s31, s31, 64
    buffer_load_dwordx4 v202, s[16:19], s31 offen lds
    s_add_u32 m0, s32, 7168
    s_add_u32 s31, s31, 64
    buffer_load_dwordx4 v202, s[16:19], s31 offen lds
    s_add_u32 m0, s32, 8192
    s_add_u32 s31, s31, 64
    buffer_load_dwordx4 v202, s[16:19], s31 offen lds
    ds_read_b128 v[40:43], v205 offset:0
    ds_read_b128 v[44:47], v205 offset:1024
    ds_read_b128 v[48:51], v205 offset:2048
    ds_read_b128 v[52:55], v205 offset:3072
    ds_read_b128 v[56:59], v205 offset:4096
    ds_read_b128 v[60:63], v205 offset:5120
    s_waitcnt lgkmcnt(5)
    v_mfma_f32_16x16x32_bf16 v[0:3], v[40:43], a[0:3], 0
    v_mfma_f32_16x16x32_bf16 v[4:7], v[40:43], a[72:75], 0
    v_mfma_f32_16x16x32_bf16 v[8:11], v[40:43], a[144:147], 0
    v_mfma_f32_16x16x32_bf16 v[12:15], a[216:219], v[40:43], 0
    v_mfma_f32_16x16x32_bf16 v[16:19], a[144:147], v[40:43], 0
    s_waitcnt lgkmcnt(4)
    v_mfma_f32_16x16x32_bf16 v[0:3], v[44:47], a[4:7], v[0:3]
    ds_read_b128 v[40:43], v205 offset:6144
    v_mfma_f32_16x16x32_bf16 v[4:7], v[44:47], a[76:79], v[4:7]
    v_mfma_f32_16x16x32_bf16 v[8:11], v[44:47], a[148:151], v[8:11]
    v_mfma_f32_16x16x32_bf16 v[12:15], a[220:223], v[44:47], v[12:15]
    v_mfma_f32_16x16x32_bf16 v[16:19], a[148:151], v[44:47], v[16:19]
    s_waitcnt lgkmcnt(4)
    v_mfma_f32_16x16x32_bf16 v[0:3], v[48:51], a[8:11], v[0:3]
    ds_read_b128 v[44:47], v205 offset:7168
    v_mfma_f32_16x16x32_bf16 v[4:7], v[48:51], a[80:83], v[4:7]
    v_mfma_f32_16x16x32_bf16 v[8:11], v[48:51], a[152:155], v[8:11]
    v_mfma_f32_16x16x32_bf16 v[12:15], a[224:227], v[48:51], v[12:15]
    v_mfma_f32_16x16x32_bf16 v[16:19], a[152:155], v[48:51], v[16:19]
    s_waitcnt lgkmcnt(4)
    v_mfma_f32_16x16x32_bf16 v[0:3], v[52:55], a[12:15], v[0:3]
    ds_read_b128 v[48:51], v205 offset:8192
    v_mfma_f32_16x16x32_bf16 v[4:7], v[52:55], a[84:87], v[4:7]
    v_mfma_f32_16x16x32_bf16 v[8:11], v[52:55], a[156:159], v[8:11]
    v_mfma_f32_16x16x32_bf16 v[12:15], a[228:231], v[52:55], v[12:15]
    v_mfma_f32_16x16x32_bf16 v[16:19], a[156:159], v[52:55], v[16:19]
    s_waitcnt lgkmcnt(4)
    v_mfma_f32_16x16x32_bf16 v[0:3], v[56:59], a[16:19], v[0:3]
    ds_read_b128 v[52:55], v205 offset:9216
    v_mfma_f32_16x16x32_bf16 v[4:7], v[56:59], a[88:91], v[4:7]
    v_mfma_f32_16x16x32_bf16 v[8:11], v[56:59], a[160:163], v[8:11]
    v_mfma_f32_16x16x32_bf16 v[12:15], a[232:235], v[56:59], v[12:15]
    v_mfma_f32_16x16x32_bf16 v[16:19], a[160:163], v[56:59], v[16:19]
    s_waitcnt lgkmcnt(4)
    v_mfma_f32_16x16x32_bf16 v[0:3], v[60:63], a[20:23], v[0:3]
    ds_read_b128 v[56:59], v205 offset:10240
    v_mfma_f32_16x16x32_bf16 v[4:7], v[60:63], a[92:95], v[4:7]
    v_mfma_f32_16x16x32_bf16 v[8:11], v[60:63], a[164:167], v[8:11]
    v_mfma_f32_16x16x32_bf16 v[12:15], a[236:239], v[60:63], v[12:15]
    v_mfma_f32_16x16x32_bf16 v[16:19], a[164:167], v[60:63], v[16:19]
    s_waitcnt lgkmcnt(4)
    v_mfma_f32_16x16x32_bf16 v[0:3], v[40:43], a[24:27], v[0:3]
    ds_read_b128 v[60:63], v205 offset:11264
    v_mfma_f32_16x16x32_bf16 v[4:7], v[40:43], a[96:99], v[4:7]
    v_mfma_f32_16x16x32_bf16 v[8:11], v[40:43], a[168:171], v[8:11]
    v_mfma_f32_16x16x32_bf16 v[12:15], a[240:243], v[40:43], v[12:15]
    v_mfma_f32_16x16x32_bf16 v[16:19], a[168:171], v[40:43], v[16:19]
    s_waitcnt lgkmcnt(4)
    v_mfma_f32_16x16x32_bf16 v[0:3], v[44:47], a[28:31], v[0:3]
    ds_read_b128 v[40:43], v205 offset:12288
    v_mfma_f32_16x16x32_bf16 v[4:7], v[44:47], a[100:103], v[4:7]
    v_mfma_f32_16x16x32_bf16 v[8:11], v[44:47], a[172:175], v[8:11]
    v_mfma_f32_16x16x32_bf16 v[12:15], a[244:247], v[44:47], v[12:15]
    v_mfma_f32_16x16x32_bf16 v[16:19], a[172:175], v[44:47], v[16:19]
    s_waitcnt lgkmcnt(4)
    v_mfma_f32_16x16x32_bf16 v[0:3], v[48:51], a[32:35], v[0:3]
    ds_read_b128 v[44:47], v205 offset:13312
    v_mfma_f32_16x16x32_bf16 v[4:7], v[48:51], a[104:107], v[4:7]
    v_mfma_f32_16x16x32_bf16 v[8:11], v[48:51], a[176:179], v[8:11]
    v_mfma_f32_16x16x32_bf16 v[12:15], a[248:251], v[48:51], v[12:15]
    v_mfma_f32_16x16x32_bf16 v[16:19], a[176:179], v[48:51], v[16:19]
    s_waitcnt lgkmcnt(4)
    v_mfma_f32_16x16x32_bf16 v[0:3], v[52:55], a[36:39], v[0:3]
    ds_read_b128 v[48:51], v205 offset:14336
    v_mfma_f32_16x16x32_bf16 v[4:7], v[52:55], a[108:111], v[4:7]
    v_mfma_f32_16x16x32_bf16 v[8:11], v[52:55], a[180:183], v[8:11]
    v_mfma_f32_16x16x32_bf16 v[12:15], a[252:255], v[52:55], v[12:15]
    v_mfma_f32_16x16x32_bf16 v[16:19], a[180:183], v[52:55], v[16:19]
    s_waitcnt lgkmcnt(4)
    v_mfma_f32_16x16x32_bf16 v[0:3], v[56:59], a[40:43], v[0:3]
    ds_read_b128 v[52:55], v205 offset:15360
    v_mfma_f32_16x16x32_bf16 v[4:7], v[56:59], a[112:115], v[4:7]
    v_mfma_f32_16x16x32_bf16 v[8:11], v[56:59], a[184:187], v[8:11]
    v_mfma_f32_16x16x32_bf16 v[12:15], v[208:211], v[56:59], v[12:15]
    v_mfma_f32_16x16x32_bf16 v[16:19], a[184:187], v[56:59], v[16:19]
    s_waitcnt lgkmcnt(4)
    v_mfma_f32_16x16x32_bf16 v[0:3], v[60:63], a[44:47], v[0:3]
    ds_read_b128 v[56:59], v205 offset:16384
    v_mfma_f32_16x16x32_bf16 v[4:7], v[60:63], a[116:119], v[4:7]
    v_mfma_f32_16x16x32_bf16 v[8:11], v[60:63], a[188:191], v[8:11]
    v_mfma_f32_16x16x32_bf16 v[12:15], v[212:215], v[60:63], v[12:15]
    v_mfma_f32_16x16x32_bf16 v[16:19], a[188:191], v[60:63], v[16:19]
    s_waitcnt lgkmcnt(4)
    v_mfma_f32_16x16x32_bf16 v[0:3], v[40:43], a[48:51], v[0:3]
    ds_read_b128 v[60:63], v205 offset:17408
    v_mfma_f32_16x16x32_bf16 v[4:7], v[40:43], a[120:123], v[4:7]
    v_mfma_f32_16x16x32_bf16 v[8:11], v[40:43], a[192:195], v[8:11]
    v_mfma_f32_16x16x32_bf16 v[12:15], v[216:219], v[40:43], v[12:15]
    v_mfma_f32_16x16x32_bf16 v[16:19], a[192:195], v[40:43], v[16:19]
    s_waitcnt lgkmcnt(4)
    v_mfma_f32_16x16x32_bf16 v[0:3], v[44:47], a[52:55], v[0:3]
    ds_read_b128 v[40:43], v205 offset:18432
    v_mfma_f32_16x16x32_bf16 v[4:7], v[44:47], a[124:127], v[4:7]
    v_mfma_f32_16x16x32_bf16 v[8:11], v[44:47], a[196:199], v[8:11]
    v_mfma_f32_16x16x32_bf16 v[12:15], v[220:223], v[44:47], v[12:15]
    v_mfma_f32_16x16x32_bf16 v[16:19], a[196:199], v[44:47], v[16:19]
    s_waitcnt lgkmcnt(4)
    v_mfma_f32_16x16x32_bf16 v[0:3], v[48:51], a[56:59], v[0:3]
    ds_read_b128 v[44:47], v205 offset:19456
    v_mfma_f32_16x16x32_bf16 v[4:7], v[48:51], a[128:131], v[4:7]
    v_mfma_f32_16x16x32_bf16 v[8:11], v[48:51], a[200:203], v[8:11]
    v_mfma_f32_16x16x32_bf16 v[12:15], v[224:227], v[48:51], v[12:15]
    v_mfma_f32_16x16x32_bf16 v[16:19], a[200:203], v[48:51], v[16:19]
    s_waitcnt lgkmcnt(4)
    v_mfma_f32_16x16x32_bf16 v[0:3], v[52:55], a[60:63], v[0:3]
    ds_read_b128 v[48:51], v205 offset:20480
    v_mfma_f32_16x16x32_bf16 v[4:7], v[52:55], a[132:135], v[4:7]
    v_mfma_f32_16x16x32_bf16 v[8:11], v[52:55], a[204:207], v[8:11]
    v_mfma_f32_16x16x32_bf16 v[12:15], v[228:231], v[52:55], v[12:15]
    v_mfma_f32_16x16x32_bf16 v[16:19], a[204:207], v[52:55], v[16:19]
    s_waitcnt lgkmcnt(4)
    v_mfma_f32_16x16x32_bf16 v[0:3], v[56:59], a[64:67], v[0:3]
    ds_read_b128 v[52:55], v205 offset:21504
    v_mfma_f32_16x16x32_bf16 v[4:7], v[56:59], a[136:139], v[4:7]
    v_mfma_f32_16x16x32_bf16 v[8:11], v[56:59], a[208:211], v[8:11]
    v_mfma_f32_16x16x32_bf16 v[12:15], v[232:235], v[56:59], v[12:15]
    v_mfma_f32_16x16x32_bf16 v[16:19], a[208:211], v[56:59], v[16:19]
    s_waitcnt lgkmcnt(4)
    v_mfma_f32_16x16x32_bf16 v[0:3], v[60:63], a[68:71], v[0:3]
    ds_read_b128 v[56:59], v205 offset:22528
    v_mfma_f32_16x16x32_bf16 v[4:7], v[60:63], a[140:143], v[4:7]
    v_mfma_f32_16x16x32_bf16 v[8:11], v[60:63], a[212:215], v[8:11]
    v_mfma_f32_16x16x32_bf16 v[12:15], v[236:239], v[60:63], v[12:15]
    v_mfma_f32_16x16x32_bf16 v[16:19], a[212:215], v[60:63], v[16:19]
    s_waitcnt lgkmcnt(4)
    v_mfma_f32_16x16x32_bf16 v[20:23], v[40:43], a[0:3], 0
    ds_read_b128 v[60:63], v205 offset:23552
    v_mfma_f32_16x16x32_bf16 v[24:27], v[40:43], a[72:75], 0
    v_mfma_f32_16x16x32_bf16 v[28:31], v[40:43], a[144:147], 0
    v_mfma_f32_16x16x32_bf16 v[32:35], a[216:219], v[40:43], 0
    v_mfma_f32_16x16x32_bf16 v[36:39], a[144:147], v[40:43], 0
    s_waitcnt lgkmcnt(4)
    v_mfma_f32_16x16x32_bf16 v[20:23], v[44:47], a[4:7], v[20:23]
    ds_read_b128 v[40:43], v205 offset:24576
    v_mfma_f32_16x16x32_bf16 v[24:27], v[44:47], a[76:79], v[24:27]
    v_mfma_f32_16x16x32_bf16 v[28:31], v[44:47], a[148:151], v[28:31]
    v_mfma_f32_16x16x32_bf16 v[32:35], a[220:223], v[44:47], v[32:35]
    v_mfma_f32_16x16x32_bf16 v[36:39], a[148:151], v[44:47], v[36:39]
    s_waitcnt lgkmcnt(4)
    v_mfma_f32_16x16x32_bf16 v[20:23], v[48:51], a[8:11], v[20:23]
    ds_read_b128 v[44:47], v205 offset:25600
    v_mfma_f32_16x16x32_bf16 v[24:27], v[48:51], a[80:83], v[24:27]
    v_mfma_f32_16x16x32_bf16 v[28:31], v[48:51], a[152:155], v[28:31]
    v_mfma_f32_16x16x32_bf16 v[32:35], a[224:227], v[48:51], v[32:35]
    v_mfma_f32_16x16x32_bf16 v[36:39], a[152:155], v[48:51], v[36:39]
    s_waitcnt lgkmcnt(4)
    v_mfma_f32_16x16x32_bf16 v[20:23], v[52:55], a[12:15], v[20:23]
    ds_read_b128 v[48:51], v205 offset:26624
    v_mfma_f32_16x16x32_bf16 v[24:27], v[52:55], a[84:87], v[24:27]
    v_mfma_f32_16x16x32_bf16 v[28:31], v[52:55], a[156:159], v[28:31]
    v_mfma_f32_16x16x32_bf16 v[32:35], a[228:231], v[52:55], v[32:35]
    v_mfma_f32_16x16x32_bf16 v[36:39], a[156:159], v[52:55], v[36:39]
    s_waitcnt lgkmcnt(4)
    v_mfma_f32_16x16x32_bf16 v[20:23], v[56:59], a[16:19], v[20:23]
    ds_read_b128 v[52:55], v205 offset:27648
    v_mfma_f32_16x16x32_bf16 v[24:27], v[56:59], a[88:91], v[24:27]
    v_mfma_f32_16x16x32_bf16 v[28:31], v[56:59], a[160:163], v[28:31]
    v_mfma_f32_16x16x32_bf16 v[32:35], a[232:235], v[56:59], v[32:35]
    v_mfma_f32_16x16x32_bf16 v[36:39], a[160:163], v[56:59], v[36:39]
    s_waitcnt lgkmcnt(4)
    v_mfma_f32_16x16x32_bf16 v[20:23], v[60:63], a[20:23], v[20:23]
    ds_read_b128 v[56:59], v205 offset:28672
    v_mfma_f32_16x16x32_bf16 v[24:27], v[60:63], a[92:95], v[24:27]
    v_mfma_f32_16x16x32_bf16 v[28:31], v[60:63], a[164:167], v[28:31]
    v_mfma_f32_16x16x32_bf16 v[32:35], a[236:239], v[60:63], v[32:35]
    v_mfma_f32_16x16x32_bf16 v[36:39], a[164:167], v[60:63], v[36:39]
    s_waitcnt lgkmcnt(4)
    v_mfma_f32_16x16x32_bf16 v[20:23], v[40:43], a[24:27], v[20:23]
    ds_read_b128 v[60:63], v205 offset:29696
    v_mfma_f32_16x16x32_bf16 v[24:27], v[40:43], a[96:99], v[24:27]
    v_mfma_f32_16x16x32_bf16 v[28:31], v[40:43], a[168:171], v[28:31]
    v_mfma_f32_16x16x32_bf16 v[32:35], a[240:243], v[40:43], v[32:35]
    v_mfma_f32_16x16x32_bf16 v[36:39], a[168:171], v[40:43], v[36:39]
    s_waitcnt lgkmcnt(4)
    v_mfma_f32_16x16x32_bf16 v[20:23], v[44:47], a[28:31], v[20:23]
    ds_read_b128 v[40:43], v205 offset:30720
    v_mfma_f32_16x16x32_bf16 v[24:27], v[44:47], a[100:103], v[24:27]
    v_mfma_f32_16x16x32_bf16 v[28:31], v[44:47], a[172:175], v[28:31]
    v_mfma_f32_16x16x32_bf16 v[32:35], a[244:247], v[44:47], v[32:35]
    v_mfma_f32_16x16x32_bf16 v[36:39], a[172:175], v[44:47], v[36:39]
    s_waitcnt lgkmcnt(4)
    v_mfma_f32_16x16x32_bf16 v[20:23], v[48:51], a[32:35], v[20:23]
    ds_read_b128 v[44:47], v205 offset:31744
    v_mfma_f32_16x16x32_bf16 v[24:27], v[48:51], a[104:107], v[24:27]
    v_mfma_f32_16x16x32_bf16 v[28:31], v[48:51], a[176:179], v[28:31]
    v_mfma_f32_16x16x32_bf16 v[32:35], a[248:251], v[48:51], v[32:35]
    v_mfma_f32_16x16x32_bf16 v[36:39], a[176:179], v[48:51], v[36:39]
    s_waitcnt lgkmcnt(4)
    v_mfma_f32_16x16x32_bf16 v[20:23], v[52:55], a[36:39], v[20:23]
    ds_read_b128 v[48:51], v205 offset:32768
    v_mfma_f32_16x16x32_bf16 v[24:27], v[52:55], a[108:111], v[24:27]
    v_mfma_f32_16x16x32_bf16 v[28:31], v[52:55], a[180:183], v[28:31]
    v_mfma_f32_16x16x32_bf16 v[32:35], a[252:255], v[52:55], v[32:35]
    v_mfma_f32_16x16x32_bf16 v[36:39], a[180:183], v[52:55], v[36:39]
    s_waitcnt lgkmcnt(4)
    v_mfma_f32_16x16x32_bf16 v[20:23], v[56:59], a[40:43], v[20:23]
    ds_read_b128 v[52:55], v205 offset:33792
    v_mfma_f32_16x16x32_bf16 v[24:27], v[56:59], a[112:115], v[24:27]
    v_mfma_f32_16x16x32_bf16 v[28:31], v[56:59], a[184:187], v[28:31]
    v_mfma_f32_16x16x32_bf16 v[32:35], v[208:211], v[56:59], v[32:35]
    v_mfma_f32_16x16x32_bf16 v[36:39], a[184:187], v[56:59], v[36:39]
    s_waitcnt lgkmcnt(4)
    v_mfma_f32_16x16x32_bf16 v[20:23], v[60:63], a[44:47], v[20:23]
    ds_read_b128 v[56:59], v205 offset:34816
    v_mfma_f32_16x16x32_bf16 v[24:27], v[60:63], a[116:119], v[24:27]
    v_mfma_f32_16x16x32_bf16 v[28:31], v[60:63], a[188:191], v[28:31]
    v_mfma_f32_16x16x32_bf16 v[32:35], v[212:215], v[60:63], v[32:35]
    v_mfma_f32_16x16x32_bf16 v[36:39], a[188:191], v[60:63], v[36:39]
    s_waitcnt lgkmcnt(4)
    v_mfma_f32_16x16x32_bf16 v[20:23], v[40:43], a[48:51], v[20:23]
    ds_read_b128 v[60:63], v205 offset:35840
    v_mfma_f32_16x16x32_bf16 v[24:27], v[40:43], a[120:123], v[24:27]
    v_mfma_f32_16x16x32_bf16 v[28:31], v[40:43], a[192:195], v[28:31]
    v_mfma_f32_16x16x32_bf16 v[32:35], v[216:219], v[40:43], v[32:35]
    v_mfma_f32_16x16x32_bf16 v[36:39], a[192:195], v[40:43], v[36:39]
    s_waitcnt lgkmcnt(4)
    v_mfma_f32_16x16x32_bf16 v[20:23], v[44:47], a[52:55], v[20:23]
    v_mfma_f32_16x16x32_bf16 v[24:27], v[44:47], a[124:127], v[24:27]
    v_mfma_f32_16x16x32_bf16 v[28:31], v[44:47], a[196:199], v[28:31]
    v_mfma_f32_16x16x32_bf16 v[32:35], v[220:223], v[44:47], v[32:35]
    v_mfma_f32_16x16x32_bf16 v[36:39], a[196:199], v[44:47], v[36:39]
    s_waitcnt lgkmcnt(3)
    v_mfma_f32_16x16x32_bf16 v[20:23], v[48:51], a[56:59], v[20:23]
    v_mfma_f32_16x16x32_bf16 v[24:27], v[48:51], a[128:131], v[24:27]
    v_mfma_f32_16x16x32_bf16 v[28:31], v[48:51], a[200:203], v[28:31]
    v_mfma_f32_16x16x32_bf16 v[32:35], v[224:227], v[48:51], v[32:35]
    v_mfma_f32_16x16x32_bf16 v[36:39], a[200:203], v[48:51], v[36:39]
    s_waitcnt lgkmcnt(2)
    v_mfma_f32_16x16x32_bf16 v[20:23], v[52:55], a[60:63], v[20:23]
    v_mfma_f32_16x16x32_bf16 v[24:27], v[52:55], a[132:135], v[24:27]
    v_mfma_f32_16x16x32_bf16 v[28:31], v[52:55], a[204:207], v[28:31]
    v_mfma_f32_16x16x32_bf16 v[32:35], v[228:231], v[52:55], v[32:35]
    v_mfma_f32_16x16x32_bf16 v[36:39], a[204:207], v[52:55], v[36:39]
    s_waitcnt lgkmcnt(1)
    v_mfma_f32_16x16x32_bf16 v[20:23], v[56:59], a[64:67], v[20:23]
    v_mfma_f32_16x16x32_bf16 v[24:27], v[56:59], a[136:139], v[24:27]
    v_mfma_f32_16x16x32_bf16 v[28:31], v[56:59], a[208:211], v[28:31]
    v_mfma_f32_16x16x32_bf16 v[32:35], v[232:235], v[56:59], v[32:35]
    v_mfma_f32_16x16x32_bf16 v[36:39], a[208:211], v[56:59], v[36:39]
    s_waitcnt lgkmcnt(0)
    v_mfma_f32_16x16x32_bf16 v[20:23], v[60:63], a[68:71], v[20:23]
    v_mfma_f32_16x16x32_bf16 v[24:27], v[60:63], a[140:143], v[24:27]
    v_mfma_f32_16x16x32_bf16 v[28:31], v[60:63], a[212:215], v[28:31]
    v_mfma_f32_16x16x32_bf16 v[32:35], v[236:239], v[60:63], v[32:35]
    v_mfma_f32_16x16x32_bf16 v[36:39], a[212:215], v[60:63], v[36:39]
    s_cmp_lg_u32 s30, 0
    s_cbranch_scc1 NOG_42
    ds_read_b128 v[40:43], v205 offset:0
    ds_read_b128 v[44:47], v205 offset:1024
    ds_read_b128 v[48:51], v205 offset:2048
    ds_read_b128 v[52:55], v205 offset:3072
    ds_read_b128 v[56:59], v205 offset:4096
    ds_read_b128 v[60:63], v205 offset:5120
    s_waitcnt lgkmcnt(0)
    v_mfma_f32_16x16x32_bf16 v[64:67], v[128:131], v[40:43], 0
    v_mfma_f32_16x16x32_bf16 v[64:67], v[132:135], v[44:47], v[64:67]
    v_mfma_f32_16x16x32_bf16 v[64:67], v[136:139], v[48:51], v[64:67]
    v_mfma_f32_16x16x32_bf16 v[64:67], v[140:143], v[52:55], v[64:67]
    v_mfma_f32_16x16x32_bf16 v[64:67], v[144:147], v[56:59], v[64:67]
    v_mfma_f32_16x16x32_bf16 v[64:67], v[148:151], v[60:63], v[64:67]
    ds_read_b128 v[40:43], v205 offset:6144
    ds_read_b128 v[44:47], v205 offset:7168
    ds_read_b128 v[48:51], v205 offset:8192
    ds_read_b128 v[52:55], v205 offset:9216
    ds_read_b128 v[56:59], v205 offset:10240
    ds_read_b128 v[60:63], v205 offset:11264
    s_waitcnt lgkmcnt(0)
    v_mfma_f32_16x16x32_bf16 v[64:67], v[152:155], v[40:43], v[64:67]
    v_mfma_f32_16x16x32_bf16 v[64:67], v[156:159], v[44:47], v[64:67]
    v_mfma_f32_16x16x32_bf16 v[64:67], v[160:163], v[48:51], v[64:67]
    v_mfma_f32_16x16x32_bf16 v[64:67], v[164:167], v[52:55], v[64:67]
    v_mfma_f32_16x16x32_bf16 v[64:67], v[168:171], v[56:59], v[64:67]
    v_mfma_f32_16x16x32_bf16 v[64:67], v[172:175], v[60:63], v[64:67]
    ds_read_b128 v[40:43], v205 offset:12288
    ds_read_b128 v[44:47], v205 offset:13312
    ds_read_b128 v[48:51], v205 offset:14336
    ds_read_b128 v[52:55], v205 offset:15360
    ds_read_b128 v[56:59], v205 offset:16384
    ds_read_b128 v[60:63], v205 offset:17408
    s_waitcnt lgkmcnt(0)
    v_mfma_f32_16x16x32_bf16 v[64:67], v[176:179], v[40:43], v[64:67]
    v_mfma_f32_16x16x32_bf16 v[64:67], v[180:183], v[44:47], v[64:67]
    v_mfma_f32_16x16x32_bf16 v[64:67], v[184:187], v[48:51], v[64:67]
    v_mfma_f32_16x16x32_bf16 v[64:67], v[188:191], v[52:55], v[64:67]
    v_mfma_f32_16x16x32_bf16 v[64:67], v[192:195], v[56:59], v[64:67]
    v_mfma_f32_16x16x32_bf16 v[64:67], v[196:199], v[60:63], v[64:67]
    ds_read_b128 v[40:43], v205 offset:18432
    ds_read_b128 v[44:47], v205 offset:19456
    ds_read_b128 v[48:51], v205 offset:20480
    ds_read_b128 v[52:55], v205 offset:21504
    ds_read_b128 v[56:59], v205 offset:22528
    ds_read_b128 v[60:63], v205 offset:23552
    s_waitcnt lgkmcnt(0)
    v_mfma_f32_16x16x32_bf16 v[68:71], v[128:131], v[40:43], 0
    v_mfma_f32_16x16x32_bf16 v[68:71], v[132:135], v[44:47], v[68:71]
    v_mfma_f32_16x16x32_bf16 v[68:71], v[136:139], v[48:51], v[68:71]
    v_mfma_f32_16x16x32_bf16 v[68:71], v[140:143], v[52:55], v[68:71]
    v_mfma_f32_16x16x32_bf16 v[68:71], v[144:147], v[56:59], v[68:71]
    v_mfma_f32_16x16x32_bf16 v[68:71], v[148:151], v[60:63], v[68:71]
    ds_read_b128 v[40:43], v205 offset:24576
    ds_read_b128 v[44:47], v205 offset:25600
    ds_read_b128 v[48:51], v205 offset:26624
    ds_read_b128 v[52:55], v205 offset:27648
    ds_read_b128 v[56:59], v205 offset:28672
    ds_read_b128 v[60:63], v205 offset:29696
    s_waitcnt lgkmcnt(0)
    v_mfma_f32_16x16x32_bf16 v[68:71], v[152:155], v[40:43], v[68:71]
    v_mfma_f32_16x16x32_bf16 v[68:71], v[156:159], v[44:47], v[68:71]
    v_mfma_f32_16x16x32_bf16 v[68:71], v[160:163], v[48:51], v[68:71]
    v_mfma_f32_16x16x32_bf16 v[68:71], v[164:167], v[52:55], v[68:71]
    v_mfma_f32_16x16x32_bf16 v[68:71], v[168:171], v[56:59], v[68:71]
    v_mfma_f32_16x16x32_bf16 v[68:71], v[172:175], v[60:63], v[68:71]
    ds_read_b128 v[40:43], v205 offset:30720
    ds_read_b128 v[44:47], v205 offset:31744
    ds_read_b128 v[48:51], v205 offset:32768
    ds_read_b128 v[52:55], v205 offset:33792
    ds_read_b128 v[56:59], v205 offset:34816
    ds_read_b128 v[60:63], v205 offset:35840
    s_waitcnt lgkmcnt(0)
    v_mfma_f32_16x16x32_bf16 v[68:71], v[176:179], v[40:43], v[68:71]
    v_mfma_f32_16x16x32_bf16 v[68:71], v[180:183], v[44:47], v[68:71]
    v_mfma_f32_16x16x32_bf16 v[68:71], v[184:187], v[48:51], v[68:71]
    v_mfma_f32_16x16x32_bf16 v[68:71], v[188:191], v[52:55], v[68:71]
    v_mfma_f32_16x16x32_bf16 v[68:71], v[192:195], v[56:59], v[68:71]
    v_mfma_f32_16x16x32_bf16 v[68:71], v[196:199], v[60:63], v[68:71]
    v_lshlrev_b32 v72, 2, v201
    v_mul_f32 v64, s36, v64
    v_exp_f32 v64, -v64
    s_nop 0
    v_add_f32 v64, 1.0, v64
    v_rcp_f32 v64, v64
    s_mov_b64 exec, 0xffff
    buffer_store_dword v64, v72, s[4:7], s37 offen offset:0 sc1
    s_mov_b64 exec, -1
    v_mul_f32 v68, s36, v68
    v_exp_f32 v68, -v68
    s_nop 0
    v_add_f32 v68, 1.0, v68
    v_rcp_f32 v68, v68
    s_mov_b64 exec, 0xffff
    buffer_store_dword v68, v72, s[4:7], s37 offen offset:64 sc1
    s_mov_b64 exec, -1
    s_add_u32 s37, s37, 128
NOG_42:
    v_cvt_pk_bf16_f32 v72, v4, v5
    v_cvt_pk_bf16_f32 v73, v6, v7
    v_cvt_pk_bf16_f32 v76, v8, v9
    v_cvt_pk_bf16_f32 v77, v10, v11
    v_min_f32 v88, 0, v0
    v_mul_f32 v88, s36, v88
    v_exp_f32 v88, v88
    v_max_f32 v0, 0, v0
    v_add_f32 v0, 0x358637bd, v0
    v_add_f32 v0, v0, v88
    v_min_f32 v89, 0, v1
    v_mul_f32 v89, s36, v89
    v_exp_f32 v89, v89
    v_max_f32 v1, 0, v1
    v_add_f32 v1, 0x358637bd, v1
    v_add_f32 v1, v1, v89
    v_min_f32 v90, 0, v2
    v_mul_f32 v90, s36, v90
    v_exp_f32 v90, v90
    v_max_f32 v2, 0, v2
    v_add_f32 v2, 0x358637bd, v2
    v_add_f32 v2, v2, v90
    v_min_f32 v91, 0, v3
    v_mul_f32 v91, s36, v91
    v_exp_f32 v91, v91
    v_max_f32 v3, 0, v3
    v_add_f32 v3, 0x358637bd, v3
    v_add_f32 v3, v3, v91
    v_min_f32 v88, 0, v8
    v_mul_f32 v88, s36, v88
    v_exp_f32 v88, v88
    v_max_f32 v8, 0, v8
    v_add_f32 v8, 0x358637bd, v8
    v_add_f32 v8, v8, v88
    v_min_f32 v89, 0, v9
    v_mul_f32 v89, s36, v89
    v_exp_f32 v89, v89
    v_max_f32 v9, 0, v9
    v_add_f32 v9, 0x358637bd, v9
    v_add_f32 v9, v9, v89
    v_min_f32 v90, 0, v10
    v_mul_f32 v90, s36, v90
    v_exp_f32 v90, v90
    v_max_f32 v10, 0, v10
    v_add_f32 v10, 0x358637bd, v10
    v_add_f32 v10, v10, v90
    v_min_f32 v91, 0, v11
    v_mul_f32 v91, s36, v91
    v_exp_f32 v91, v91
    v_max_f32 v11, 0, v11
    v_add_f32 v11, 0x358637bd, v11
    v_add_f32 v11, v11, v91
    v_min_f32 v88, 0, v12
    v_mul_f32 v88, s36, v88
    v_exp_f32 v88, v88
    v_max_f32 v12, 0, v12
    v_add_f32 v12, 0x358637bd, v12
    v_add_f32 v12, v12, v88
    v_min_f32 v89, 0, v13
    v_mul_f32 v89, s36, v89
    v_exp_f32 v89, v89
    v_max_f32 v13, 0, v13
    v_add_f32 v13, 0x358637bd, v13
    v_add_f32 v13, v13, v89
    v_min_f32 v90, 0, v14
    v_mul_f32 v90, s36, v90
    v_exp_f32 v90, v90
    v_max_f32 v14, 0, v14
    v_add_f32 v14, 0x358637bd, v14
    v_add_f32 v14, v14, v90
    v_min_f32 v91, 0, v15
    v_mul_f32 v91, s36, v91
    v_exp_f32 v91, v91
    v_max_f32 v15, 0, v15
    v_add_f32 v15, 0x358637bd, v15
    v_add_f32 v15, v15, v91
    v_min_f32 v88, 0, v16
    v_mul_f32 v88, s36, v88
    v_exp_f32 v88, v88
    v_max_f32 v16, 0, v16
    v_add_f32 v16, 0x358637bd, v16
    v_add_f32 v16, v16, v88
    v_min_f32 v89, 0, v17
    v_mul_f32 v89, s36, v89
    v_exp_f32 v89, v89
    v_max_f32 v17, 0, v17
    v_add_f32 v17, 0x358637bd, v17
    v_add_f32 v17, v17, v89
    v_cvt_pk_bf16_f32 v64, v0, v1
    v_cvt_pk_bf16_f32 v65, v2, v3
    v_cvt_pk_bf16_f32 v68, v8, v9
    v_cvt_pk_bf16_f32 v69, v10, v11
    v_cvt_pk_bf16_f32 v80, v12, v13
    v_cvt_pk_bf16_f32 v81, v14, v15
    v_cvt_pk_bf16_f32 v88, v16, v17
    v_cndmask_b32 v84, 0, v88, s[40:41]
    v_cvt_pk_bf16_f32 v74, v24, v25
    v_cvt_pk_bf16_f32 v75, v26, v27
    v_cvt_pk_bf16_f32 v78, v28, v29
    v_cvt_pk_bf16_f32 v79, v30, v31
    v_min_f32 v88, 0, v20
    v_mul_f32 v88, s36, v88
    v_exp_f32 v88, v88
    v_max_f32 v20, 0, v20
    v_add_f32 v20, 0x358637bd, v20
    v_add_f32 v20, v20, v88
    v_min_f32 v89, 0, v21
    v_mul_f32 v89, s36, v89
    v_exp_f32 v89, v89
    v_max_f32 v21, 0, v21
    v_add_f32 v21, 0x358637bd, v21
    v_add_f32 v21, v21, v89
    v_min_f32 v90, 0, v22
    v_mul_f32 v90, s36, v90
    v_exp_f32 v90, v90
    v_max_f32 v22, 0, v22
    v_add_f32 v22, 0x358637bd, v22
    v_add_f32 v22, v22, v90
    v_min_f32 v91, 0, v23
    v_mul_f32 v91, s36, v91
    v_exp_f32 v91, v91
    v_max_f32 v23, 0, v23
    v_add_f32 v23, 0x358637bd, v23
    v_add_f32 v23, v23, v91
    v_min_f32 v88, 0, v28
    v_mul_f32 v88, s36, v88
    v_exp_f32 v88, v88
    v_max_f32 v28, 0, v28
    v_add_f32 v28, 0x358637bd, v28
    v_add_f32 v28, v28, v88
    v_min_f32 v89, 0, v29
    v_mul_f32 v89, s36, v89
    v_exp_f32 v89, v89
    v_max_f32 v29, 0, v29
    v_add_f32 v29, 0x358637bd, v29
    v_add_f32 v29, v29, v89
    v_min_f32 v90, 0, v30
    v_mul_f32 v90, s36, v90
    v_exp_f32 v90, v90
    v_max_f32 v30, 0, v30
    v_add_f32 v30, 0x358637bd, v30
    v_add_f32 v30, v30, v90
    v_min_f32 v91, 0, v31
    v_mul_f32 v91, s36, v91
    v_exp_f32 v91, v91
    v_max_f32 v31, 0, v31
    v_add_f32 v31, 0x358637bd, v31
    v_add_f32 v31, v31, v91
    v_min_f32 v88, 0, v32
    v_mul_f32 v88, s36, v88
    v_exp_f32 v88, v88
    v_max_f32 v32, 0, v32
    v_add_f32 v32, 0x358637bd, v32
    v_add_f32 v32, v32, v88
    v_min_f32 v89, 0, v33
    v_mul_f32 v89, s36, v89
    v_exp_f32 v89, v89
    v_max_f32 v33, 0, v33
    v_add_f32 v33, 0x358637bd, v33
    v_add_f32 v33, v33, v89
    v_min_f32 v90, 0, v34
    v_mul_f32 v90, s36, v90
    v_exp_f32 v90, v90
    v_max_f32 v34, 0, v34
    v_add_f32 v34, 0x358637bd, v34
    v_add_f32 v34, v34, v90
    v_min_f32 v91, 0, v35
    v_mul_f32 v91, s36, v91
    v_exp_f32 v91, v91
    v_max_f32 v35, 0, v35
    v_add_f32 v35, 0x358637bd, v35
    v_add_f32 v35, v35, v91
    v_min_f32 v88, 0, v36
    v_mul_f32 v88, s36, v88
    v_exp_f32 v88, v88
    v_max_f32 v36, 0, v36
    v_add_f32 v36, 0x358637bd, v36
    v_add_f32 v36, v36, v88
    v_min_f32 v89, 0, v37
    v_mul_f32 v89, s36, v89
    v_exp_f32 v89, v89
    v_max_f32 v37, 0, v37
    v_add_f32 v37, 0x358637bd, v37
    v_add_f32 v37, v37, v89
    v_cvt_pk_bf16_f32 v66, v20, v21
    v_cvt_pk_bf16_f32 v67, v22, v23
    v_cvt_pk_bf16_f32 v70, v28, v29
    v_cvt_pk_bf16_f32 v71, v30, v31
    v_cvt_pk_bf16_f32 v82, v32, v33
    v_cvt_pk_bf16_f32 v83, v34, v35
    v_cvt_pk_bf16_f32 v88, v36, v37
    v_cndmask_b32 v85, 0, v88, s[40:41]
    v_mfma_f32_16x16x32_bf16 v[96:99], v[64:67], v[72:75], v[96:99]
    v_mfma_f32_16x16x32_bf16 v[100:103], v[64:67], v[76:79], v[100:103]
    v_mfma_f32_16x16x32_bf16 v[104:107], v[64:67], v[120:123], v[104:107]
    v_mfma_f32_16x16x32_bf16 v[108:111], v[68:71], v[72:75], v[108:111]
    v_mfma_f32_16x16x32_bf16 v[112:115], v[68:71], v[76:79], v[112:115]
    v_mfma_f32_16x16x32_bf16 v[116:119], v[68:71], v[120:123], v[116:119]
    buffer_store_dwordx4 v[80:83], v200, s[4:7], s26 offen
    buffer_store_dwordx2 v[84:85], v200, s[4:7], s26 offen offset:1024
    s_add_u32 s26, s26, 2048
    s_add_u32 s28, s28, 1
    s_cmp_lt_u32 s28, 8
    s_cbranch_scc1 BL_41
    s_lshl_b32 s31, s30, 3
    s_mul_i32 s39, s31, 6144
    s_add_u32 s39, s39, 0x7000000
    s_mul_i32 s31, s24, 6144
    s_add_u32 s31, s31, s39
    s_add_u32 s32, s31, 3072
    buffer_store_dwordx4 v[96:99], v200, s[4:7], s31 offen offset:0 sc1
    buffer_store_dwordx4 v[100:103], v200, s[4:7], s31 offen offset:1024 sc1
    buffer_store_dwordx4 v[104:107], v200, s[4:7], s31 offen offset:2048 sc1
    buffer_store_dwordx4 v[108:111], v200, s[4:7], s32 offen offset:0 sc1
    buffer_store_dwordx4 v[112:115], v200, s[4:7], s32 offen offset:1024 sc1
    buffer_store_dwordx4 v[116:119], v200, s[4:7], s32 offen offset:2048 sc1
    s_waitcnt vmcnt(0)
    s_barrier
    v_mov_b32 v204, 1
    s_mov_b64 exec, 1
    buffer_store_dword v204, v203, s[4:7], s27 offen sc1
    s_mov_b64 exec, -1
    v_lshlrev_b32 v1, 3, v200
    s_and_b32 s31, s27, 0xfffffc00
    s_mov_b32 exec_lo, 0xff
    s_mov_b32 exec_hi, 0x0
POLL_43:
    buffer_load_dword v2, v1, s[4:7], s31 offen sc1
    s_waitcnt vmcnt(0)
    v_cmp_gt_u32 vcc, 1, v2
    s_cbranch_vccz POLLOK_44
    s_sleep 2
    s_sub_u32 s22, s22, 1
    s_cbranch_scc0 POLL_43
    s_mov_b64 exec, -1
    s_branch W_FAIL
POLLOK_44:
    s_mov_b64 exec, -1
    v_and_b32 v1, 0xf0, v200
    s_add_u32 s31, s39, 0
    s_add_u32 s32, s39, 3072
    buffer_load_dwordx4 v[8:11], v200, s[4:7], s31 offen offset:0 sc1
    buffer_load_dwordx4 v[12:15], v200, s[4:7], s31 offen offset:1024 sc1
    buffer_load_dwordx4 v[16:19], v200, s[4:7], s31 offen offset:2048 sc1
    buffer_load_dwordx4 v[20:23], v1, s[4:7], s32 offen offset:0 sc1
    buffer_load_dwordx4 v[24:27], v1, s[4:7], s32 offen offset:1024 sc1
    buffer_load_dwordx4 v[28:31], v1, s[4:7], s32 offen offset:2048 sc1
    s_add_u32 s31, s39, 6144
    s_add_u32 s32, s39, 9216
    buffer_load_dwordx4 v[32:35], v200, s[4:7], s31 offen offset:0 sc1
    buffer_load_dwordx4 v[36:39], v200, s[4:7], s31 offen offset:1024 sc1
    buffer_load_dwordx4 v[40:43], v200, s[4:7], s31 offen offset:2048 sc1
    buffer_load_dwordx4 v[44:47], v1, s[4:7], s32 offen offset:0 sc1
    buffer_load_dwordx4 v[48:51], v1, s[4:7], s32 offen offset:1024 sc1
    buffer_load_dwordx4 v[52:55], v1, s[4:7], s32 offen offset:2048 sc1
    s_add_u32 s31, s39, 12288
    s_add_u32 s32, s39, 15360
    buffer_load_dwordx4 v[56:59], v200, s[4:7], s31 offen offset:0 sc1
    buffer_load_dwordx4 v[60:63], v200, s[4:7], s31 offen offset:1024 sc1
    buffer_load_dwordx4 v[64:67], v200, s[4:7], s31 offen offset:2048 sc1
    buffer_load_dwordx4 v[68:71], v1, s[4:7], s32 offen offset:0 sc1
    buffer_load_dwordx4 v[72:75], v1, s[4:7], s32 offen offset:1024 sc1
    buffer_load_dwordx4 v[76:79], v1, s[4:7], s32 offen offset:2048 sc1
    s_add_u32 s31, s39, 18432
    s_add_u32 s32, s39, 21504
    buffer_load_dwordx4 v[80:83], v200, s[4:7], s31 offen offset:0 sc1
    buffer_load_dwordx4 v[84:87], v200, s[4:7], s31 offen offset:1024 sc1
    buffer_load_dwordx4 v[88:91], v200, s[4:7], s31 offen offset:2048 sc1
    buffer_load_dwordx4 v[92:95], v1, s[4:7], s32 offen offset:0 sc1
    buffer_load_dwordx4 v[96:99], v1, s[4:7], s32 offen offset:1024 sc1
    buffer_load_dwordx4 v[100:103], v1, s[4:7], s32 offen offset:2048 sc1
    s_add_u32 s31, s39, 24576
    s_add_u32 s32, s39, 27648
    buffer_load_dwordx4 v[104:107], v200, s[4:7], s31 offen offset:0 sc1
    buffer_load_dwordx4 v[108:111], v200, s[4:7], s31 offen offset:1024 sc1
    buffer_load_dwordx4 v[112:115], v200, s[4:7], s31 offen offset:2048 sc1
    buffer_load_dwordx4 v[116:119], v1, s[4:7], s32 offen offset:0 sc1
    buffer_load_dwordx4 v[120:123], v1, s[4:7], s32 offen offset:1024 sc1
    buffer_load_dwordx4 v[124:127], v1, s[4:7], s32 offen offset:2048 sc1
    s_add_u32 s31, s39, 30720
    s_add_u32 s32, s39, 33792
    buffer_load_dwordx4 v[128:131], v200, s[4:7], s31 offen offset:0 sc1
    buffer_load_dwordx4 v[132:135], v200, s[4:7], s31 offen offset:1024 sc1
    buffer_load_dwordx4 v[136:139], v200, s[4:7], s31 offen offset:2048 sc1
    buffer_load_dwordx4 v[140:143], v1, s[4:7], s32 offen offset:0 sc1
    buffer_load_dwordx4 v[144:147], v1, s[4:7], s32 offen offset:1024 sc1
    buffer_load_dwordx4 v[148:151], v1, s[4:7], s32 offen offset:2048 sc1
    s_add_u32 s31, s39, 36864
    s_add_u32 s32, s39, 39936
    buffer_load_dwordx4 v[152:155], v200, s[4:7], s31 offen offset:0 sc1
    buffer_load_dwordx4 v[156:159], v200, s[4:7], s31 offen offset:1024 sc1
    buffer_load_dwordx4 v[160:163], v200, s[4:7], s31 offen offset:2048 sc1
    buffer_load_dwordx4 v[164:167], v1, s[4:7], s32 offen offset:0 sc1
    buffer_load_dwordx4 v[168:171], v1, s[4:7], s32 offen offset:1024 sc1
    buffer_load_dwordx4 v[172:175], v1, s[4:7], s32 offen offset:2048 sc1
    s_add_u32 s31, s39, 43008
    s_add_u32 s32, s39, 46080
    buffer_load_dwordx4 v[176:179], v200, s[4:7], s31 offen offset:0 sc1
    buffer_load_dwordx4 v[180:183], v200, s[4:7], s31 offen offset:1024 sc1
    buffer_load_dwordx4 v[184:187], v200, s[4:7], s31 offen offset:2048 sc1
    buffer_load_dwordx4 v[188:191], v1, s[4:7], s32 offen offset:0 sc1
    buffer_load_dwordx4 v[192:195], v1, s[4:7], s32 offen offset:1024 sc1
    buffer_load_dwordx4 v[196:199], v1, s[4:7], s32 offen offset:2048 sc1
    s_waitcnt vmcnt(0)
    v_add_f32 v8, v8, v32
    v_add_f32 v8, v8, v56
    v_add_f32 v8, v8, v80
    v_add_f32 v8, v8, v104
    v_add_f32 v8, v8, v128
    v_add_f32 v8, v8, v152
    v_add_f32 v8, v8, v176
    v_add_f32 v9, v9, v33
    v_add_f32 v9, v9, v57
    v_add_f32 v9, v9, v81
    v_add_f32 v9, v9, v105
    v_add_f32 v9, v9, v129
    v_add_f32 v9, v9, v153
    v_add_f32 v9, v9, v177
    v_add_f32 v10, v10, v34
    v_add_f32 v10, v10, v58
    v_add_f32 v10, v10, v82
    v_add_f32 v10, v10, v106
    v_add_f32 v10, v10, v130
    v_add_f32 v10, v10, v154
    v_add_f32 v10, v10, v178
    v_add_f32 v11, v11, v35
    v_add_f32 v11, v11, v59
    v_add_f32 v11, v11, v83
    v_add_f32 v11, v11, v107
    v_add_f32 v11, v11, v131
    v_add_f32 v11, v11, v155
    v_add_f32 v11, v11, v179
    v_add_f32 v12, v12, v36
    v_add_f32 v12, v12, v60
    v_add_f32 v12, v12, v84
    v_add_f32 v12, v12, v108
    v_add_f32 v12, v12, v132
    v_add_f32 v12, v12, v156
    v_add_f32 v12, v12, v180
    v_add_f32 v13, v13, v37
    v_add_f32 v13, v13, v61
    v_add_f32 v13, v13, v85
    v_add_f32 v13, v13, v109
    v_add_f32 v13, v13, v133
    v_add_f32 v13, v13, v157
    v_add_f32 v13, v13, v181
    v_add_f32 v14, v14, v38
    v_add_f32 v14, v14, v62
    v_add_f32 v14, v14, v86
    v_add_f32 v14, v14, v110
    v_add_f32 v14, v14, v134
    v_add_f32 v14, v14, v158
    v_add_f32 v14, v14, v182
    v_add_f32 v15, v15, v39
    v_add_f32 v15, v15, v63
    v_add_f32 v15, v15, v87
    v_add_f32 v15, v15, v111
    v_add_f32 v15, v15, v135
    v_add_f32 v15, v15, v159
    v_add_f32 v15, v15, v183
    v_add_f32 v16, v16, v40
    v_add_f32 v16, v16, v64
    v_add_f32 v16, v16, v88
    v_add_f32 v16, v16, v112
    v_add_f32 v16, v16, v136
    v_add_f32 v16, v16, v160
    v_add_f32 v16, v16, v184
    v_add_f32 v17, v17, v41
    v_add_f32 v17, v17, v65
    v_add_f32 v17, v17, v89
    v_add_f32 v17, v17, v113
    v_add_f32 v17, v17, v137
    v_add_f32 v17, v17, v161
    v_add_f32 v17, v17, v185
    v_add_f32 v18, v18, v42
    v_add_f32 v18, v18, v66
    v_add_f32 v18, v18, v90
    v_add_f32 v18, v18, v114
    v_add_f32 v18, v18, v138
    v_add_f32 v18, v18, v162
    v_add_f32 v18, v18, v186
    v_add_f32 v19, v19, v43
    v_add_f32 v19, v19, v67
    v_add_f32 v19, v19, v91
    v_add_f32 v19, v19, v115
    v_add_f32 v19, v19, v139
    v_add_f32 v19, v19, v163
    v_add_f32 v19, v19, v187
    v_add_f32 v20, v20, v44
    v_add_f32 v20, v20, v68
    v_add_f32 v20, v20, v92
    v_add_f32 v20, v20, v116
    v_add_f32 v20, v20, v140
    v_add_f32 v20, v20, v164
    v_add_f32 v20, v20, v188
    v_add_f32 v21, v21, v45
    v_add_f32 v21, v21, v69
    v_add_f32 v21, v21, v93
    v_add_f32 v21, v21, v117
    v_add_f32 v21, v21, v141
    v_add_f32 v21, v21, v165
    v_add_f32 v21, v21, v189
    v_add_f32 v22, v22, v46
    v_add_f32 v22, v22, v70
    v_add_f32 v22, v22, v94
    v_add_f32 v22, v22, v118
    v_add_f32 v22, v22, v142
    v_add_f32 v22, v22, v166
    v_add_f32 v22, v22, v190
    v_add_f32 v23, v23, v47
    v_add_f32 v23, v23, v71
    v_add_f32 v23, v23, v95
    v_add_f32 v23, v23, v119
    v_add_f32 v23, v23, v143
    v_add_f32 v23, v23, v167
    v_add_f32 v23, v23, v191
    v_add_f32 v24, v24, v48
    v_add_f32 v24, v24, v72
    v_add_f32 v24, v24, v96
    v_add_f32 v24, v24, v120
    v_add_f32 v24, v24, v144
    v_add_f32 v24, v24, v168
    v_add_f32 v24, v24, v192
    v_add_f32 v25, v25, v49
    v_add_f32 v25, v25, v73
    v_add_f32 v25, v25, v97
    v_add_f32 v25, v25, v121
    v_add_f32 v25, v25, v145
    v_add_f32 v25, v25, v169
    v_add_f32 v25, v25, v193
    v_add_f32 v26, v26, v50
    v_add_f32 v26, v26, v74
    v_add_f32 v26, v26, v98
    v_add_f32 v26, v26, v122
    v_add_f32 v26, v26, v146
    v_add_f32 v26, v26, v170
    v_add_f32 v26, v26, v194
    v_add_f32 v27, v27, v51
    v_add_f32 v27, v27, v75
    v_add_f32 v27, v27, v99
    v_add_f32 v27, v27, v123
    v_add_f32 v27, v27, v147
    v_add_f32 v27, v27, v171
    v_add_f32 v27, v27, v195
    v_add_f32 v28, v28, v52
    v_add_f32 v28, v28, v76
    v_add_f32 v28, v28, v100
    v_add_f32 v28, v28, v124
    v_add_f32 v28, v28, v148
    v_add_f32 v28, v28, v172
    v_add_f32 v28, v28, v196
    v_add_f32 v29, v29, v53
    v_add_f32 v29, v29, v77
    v_add_f32 v29, v29, v101
    v_add_f32 v29, v29, v125
    v_add_f32 v29, v29, v149
    v_add_f32 v29, v29, v173
    v_add_f32 v29, v29, v197
    v_add_f32 v30, v30, v54
    v_add_f32 v30, v30, v78
    v_add_f32 v30, v30, v102
    v_add_f32 v30, v30, v126
    v_add_f32 v30, v30, v150
    v_add_f32 v30, v30, v174
    v_add_f32 v30, v30, v198
    v_add_f32 v31, v31, v55
    v_add_f32 v31, v31, v79
    v_add_f32 v31, v31, v103
    v_add_f32 v31, v31, v127
    v_add_f32 v31, v31, v151
    v_add_f32 v31, v31, v175
    v_add_f32 v31, v31, v199
    v_cvt_pk_bf16_f32 v104, v8, v9
    v_cvt_pk_bf16_f32 v105, v10, v11
    v_cvt_pk_bf16_f32 v106, v12, v13
    v_cvt_pk_bf16_f32 v107, v14, v15
    v_cvt_pk_bf16_f32 v108, v16, v17
    v_cvt_pk_bf16_f32 v109, v18, v19
    v_cvt_pk_bf16_f32 v110, v20, v21
    v_cvt_pk_bf16_f32 v111, v22, v23
    v_cvt_pk_bf16_f32 v112, v24, v25
    v_cvt_pk_bf16_f32 v113, v26, v27
    v_cvt_pk_bf16_f32 v114, v28, v29
    v_cvt_pk_bf16_f32 v115, v30, v31
    s_sub_u32 s26, s26, 16384
    s_mul_i32 s39, s24, 2392064
    s_add_u32 s39, s39, 0x5000000
    s_lshr_b32 s31, s30, 1
    s_lshl_b32 s31, s31, 10
    s_and_b32 s32, s30, 1
    s_lshl_b32 s32, s32, 3
    s_add_u32 s42, s31, s32
    s_add_u32 s42, s42, 131072
    s_add_u32 s42, s42, s39
    s_lshr_b32 s31, s30, 2
    s_lshl_b32 s31, s31, 8
    s_and_b32 s32, s30, 3
    s_lshl_b32 s32, s32, 2
    s_add_u32 s43, s31, s32
    s_add_u32 s43, s43, 147456
    s_add_u32 s43, s43, s39
    v_mov_b32 v9, 0
    v_mov_b32 v11, 0
    buffer_load_dwordx4 v[128:131], v200, s[4:7], s26 offen sc1
    buffer_load_dwordx2 v[132:133], v200, s[4:7], s26 offen offset:1024 sc1
    s_add_u32 s26, s26, 2048
    buffer_load_dwordx4 v[134:137], v200, s[4:7], s26 offen sc1
    buffer_load_dwordx2 v[138:139], v200, s[4:7], s26 offen offset:1024 sc1
    s_add_u32 s26, s26, 2048
    buffer_load_dwordx4 v[140:143], v200, s[4:7], s26 offen sc1
    buffer_load_dwordx2 v[144:145], v200, s[4:7], s26 offen offset:1024 sc1
    s_add_u32 s26, s26, 2048
    buffer_load_dwordx4 v[146:149], v200, s[4:7], s26 offen sc1
    buffer_load_dwordx2 v[150:151], v200, s[4:7], s26 offen offset:1024 sc1
    s_add_u32 s26, s26, 2048
    buffer_load_dwordx4 v[152:155], v200, s[4:7], s26 offen sc1
    buffer_load_dwordx2 v[156:157], v200, s[4:7], s26 offen offset:1024 sc1
    s_add_u32 s26, s26, 2048
    buffer_load_dwordx4 v[158:161], v200, s[4:7], s26 offen sc1
    buffer_load_dwordx2 v[162:163], v200, s[4:7], s26 offen offset:1024 sc1
    s_add_u32 s26, s26, 2048
    buffer_load_dwordx4 v[164:167], v200, s[4:7], s26 offen sc1
    buffer_load_dwordx2 v[168:169], v200, s[4:7], s26 offen offset:1024 sc1
    s_add_u32 s26, s26, 2048
    buffer_load_dwordx4 v[170:173], v200, s[4:7], s26 offen sc1
    buffer_load_dwordx2 v[174:175], v200, s[4:7], s26 offen offset:1024 sc1
    s_add_u32 s26, s26, 2048
    s_waitcnt vmcnt(0)
    v_mov_b32 v8, v132
    v_mov_b32 v10, v133
    v_mfma_f32_16x16x16_bf16 v[16:19], v[104:105], v[128:129], 0
    v_mfma_f32_16x16x16_bf16 v[16:19], v[110:111], v[8:9], v[16:19]
    v_mfma_f32_16x16x16_bf16 v[20:23], v[106:107], v[128:129], 0
    v_mfma_f32_16x16x16_bf16 v[20:23], v[112:113], v[8:9], v[20:23]
    v_mfma_f32_16x16x16_bf16 v[24:27], v[108:109], v[128:129], 0
    v_mfma_f32_16x16x16_bf16 v[24:27], v[114:115], v[8:9], v[24:27]
    v_mfma_f32_16x16x16_bf16 v[28:31], v[104:105], v[130:131], 0
    v_mfma_f32_16x16x16_bf16 v[28:31], v[110:111], v[10:11], v[28:31]
    v_mfma_f32_16x16x16_bf16 v[32:35], v[106:107], v[130:131], 0
    v_mfma_f32_16x16x16_bf16 v[32:35], v[112:113], v[10:11], v[32:35]
    v_mfma_f32_16x16x16_bf16 v[36:39], v[108:109], v[130:131], 0
    v_mfma_f32_16x16x16_bf16 v[36:39], v[114:115], v[10:11], v[36:39]
    s_nop 1
    v_add_f32 v24, 0x358637bd, v24
    v_rcp_f32 v24, v24
    s_nop 0
    v_mul_f32 v16, v16, v24
    v_mul_f32 v17, v17, v24
    v_mul_f32 v18, v18, v24
    v_mul_f32 v19, v19, v24
    v_mul_f32 v22, v22, v24
    v_mul_f32 v23, v23, v24
    v_cvt_pk_bf16_f32 v16, v16, v17
    v_cvt_pk_bf16_f32 v17, v18, v19
    v_cvt_pk_bf16_f32 v18, v22, v23
    buffer_store_dwordx2 v[16:17], v200, s[4:7], s42 offen sc1
    s_mov_b64 exec, 0xffff
    buffer_store_dword v18, v200, s[4:7], s43 offen sc1
    s_mov_b64 exec, -1
    s_add_u32 s42, s42, 149504
    s_add_u32 s43, s43, 149504
    v_add_f32 v36, 0x358637bd, v36
    v_rcp_f32 v36, v36
    s_nop 0
    v_mul_f32 v28, v28, v36
    v_mul_f32 v29, v29, v36
    v_mul_f32 v30, v30, v36
    v_mul_f32 v31, v31, v36
    v_mul_f32 v34, v34, v36
    v_mul_f32 v35, v35, v36
    v_cvt_pk_bf16_f32 v28, v28, v29
    v_cvt_pk_bf16_f32 v29, v30, v31
    v_cvt_pk_bf16_f32 v30, v34, v35
    buffer_store_dwordx2 v[28:29], v200, s[4:7], s42 offen sc1
    s_mov_b64 exec, 0xffff
    buffer_store_dword v30, v200, s[4:7], s43 offen sc1
    s_mov_b64 exec, -1
    s_add_u32 s42, s42, 149504
    s_add_u32 s43, s43, 149504
    v_mov_b32 v8, v138
    v_mov_b32 v10, v139
    v_mfma_f32_16x16x16_bf16 v[40:43], v[104:105], v[134:135], 0
    v_mfma_f32_16x16x16_bf16 v[40:43], v[110:111], v[8:9], v[40:43]
    v_mfma_f32_16x16x16_bf16 v[44:47], v[106:107], v[134:135], 0
    v_mfma_f32_16x16x16_bf16 v[44:47], v[112:113], v[8:9], v[44:47]
    v_mfma_f32_16x16x16_bf16 v[48:51], v[108:109], v[134:135], 0
    v_mfma_f32_16x16x16_bf16 v[48:51], v[114:115], v[8:9], v[48:51]
    v_mfma_f32_16x16x16_bf16 v[52:55], v[104:105], v[136:137], 0
    v_mfma_f32_16x16x16_bf16 v[52:55], v[110:111], v[10:11], v[52:55]
    v_mfma_f32_16x16x16_bf16 v[56:59], v[106:107], v[136:137], 0
    v_mfma_f32_16x16x16_bf16 v[56:59], v[112:113], v[10:11], v[56:59]
    v_mfma_f32_16x16x16_bf16 v[60:63], v[108:109], v[136:137], 0
    v_mfma_f32_16x16x16_bf16 v[60:63], v[114:115], v[10:11], v[60:63]
    s_nop 1
    v_add_f32 v48, 0x358637bd, v48
    v_rcp_f32 v48, v48
    s_nop 0
    v_mul_f32 v40, v40, v48
    v_mul_f32 v41, v41, v48
    v_mul_f32 v42, v42, v48
    v_mul_f32 v43, v43, v48
    v_mul_f32 v46, v46, v48
    v_mul_f32 v47, v47, v48
    v_cvt_pk_bf16_f32 v40, v40, v41
    v_cvt_pk_bf16_f32 v41, v42, v43
    v_cvt_pk_bf16_f32 v42, v46, v47
    buffer_store_dwordx2 v[40:41], v200, s[4:7], s42 offen sc1
    s_mov_b64 exec, 0xffff
    buffer_store_dword v42, v200, s[4:7], s43 offen sc1
    s_mov_b64 exec, -1
    s_add_u32 s42, s42, 149504
    s_add_u32 s43, s43, 149504
    v_add_f32 v60, 0x358637bd, v60
    v_rcp_f32 v60, v60
    s_nop 0
    v_mul_f32 v52, v52, v60
    v_mul_f32 v53, v53, v60
    v_mul_f32 v54, v54, v60
    v_mul_f32 v55, v55, v60
    v_mul_f32 v58, v58, v60
    v_mul_f32 v59, v59, v60
    v_cvt_pk_bf16_f32 v52, v52, v53
    v_cvt_pk_bf16_f32 v53, v54, v55
    v_cvt_pk_bf16_f32 v54, v58, v59
    buffer_store_dwordx2 v[52:53], v200, s[4:7], s42 offen sc1
    s_mov_b64 exec, 0xffff
    buffer_store_dword v54, v200, s[4:7], s43 offen sc1
    s_mov_b64 exec, -1
    s_add_u32 s42, s42, 149504
    s_add_u32 s43, s43, 149504
    v_mov_b32 v8, v144
    v_mov_b32 v10, v145
    v_mfma_f32_16x16x16_bf16 v[16:19], v[104:105], v[140:141], 0
    v_mfma_f32_16x16x16_bf16 v[16:19], v[110:111], v[8:9], v[16:19]
    v_mfma_f32_16x16x16_bf16 v[20:23], v[106:107], v[140:141], 0
    v_mfma_f32_16x16x16_bf16 v[20:23], v[112:113], v[8:9], v[20:23]
    v_mfma_f32_16x16x16_bf16 v[24:27], v[108:109], v[140:141], 0
    v_mfma_f32_16x16x16_bf16 v[24:27], v[114:115], v[8:9], v[24:27]
    v_mfma_f32_16x16x16_bf16 v[28:31], v[104:105], v[142:143], 0
    v_mfma_f32_16x16x16_bf16 v[28:31], v[110:111], v[10:11], v[28:31]
    v_mfma_f32_16x16x16_bf16 v[32:35], v[106:107], v[142:143], 0
    v_mfma_f32_16x16x16_bf16 v[32:35], v[112:113], v[10:11], v[32:35]
    v_mfma_f32_16x16x16_bf16 v[36:39], v[108:109], v[142:143], 0
    v_mfma_f32_16x16x16_bf16 v[36:39], v[114:115], v[10:11], v[36:39]
    s_nop 1
    v_add_f32 v24, 0x358637bd, v24
    v_rcp_f32 v24, v24
    s_nop 0
    v_mul_f32 v16, v16, v24
    v_mul_f32 v17, v17, v24
    v_mul_f32 v18, v18, v24
    v_mul_f32 v19, v19, v24
    v_mul_f32 v22, v22, v24
    v_mul_f32 v23, v23, v24
    v_cvt_pk_bf16_f32 v16, v16, v17
    v_cvt_pk_bf16_f32 v17, v18, v19
    v_cvt_pk_bf16_f32 v18, v22, v23
    buffer_store_dwordx2 v[16:17], v200, s[4:7], s42 offen sc1
    s_mov_b64 exec, 0xffff
    buffer_store_dword v18, v200, s[4:7], s43 offen sc1
    s_mov_b64 exec, -1
    s_add_u32 s42, s42, 149504
    s_add_u32 s43, s43, 149504
    v_add_f32 v36, 0x358637bd, v36
    v_rcp_f32 v36, v36
    s_nop 0
    v_mul_f32 v28, v28, v36
    v_mul_f32 v29, v29, v36
    v_mul_f32 v30, v30, v36
    v_mul_f32 v31, v31, v36
    v_mul_f32 v34, v34, v36
    v_mul_f32 v35, v35, v36
    v_cvt_pk_bf16_f32 v28, v28, v29
    v_cvt_pk_bf16_f32 v29, v30, v31
    v_cvt_pk_bf16_f32 v30, v34, v35
    buffer_store_dwordx2 v[28:29], v200, s[4:7], s42 offen sc1
    s_mov_b64 exec, 0xffff
    buffer_store_dword v30, v200, s[4:7], s43 offen sc1
    s_mov_b64 exec, -1
    s_add_u32 s42, s42, 149504
    s_add_u32 s43, s43, 149504
    v_mov_b32 v8, v150
    v_mov_b32 v10, v151
    v_mfma_f32_16x16x16_bf16 v[40:43], v[104:105], v[146:147], 0
    v_mfma_f32_16x16x16_bf16 v[40:43], v[110:111], v[8:9], v[40:43]
    v_mfma_f32_16x16x16_bf16 v[44:47], v[106:107], v[146:147], 0
    v_mfma_f32_16x16x16_bf16 v[44:47], v[112:113], v[8:9], v[44:47]
    v_mfma_f32_16x16x16_bf16 v[48:51], v[108:109], v[146:147], 0
    v_mfma_f32_16x16x16_bf16 v[48:51], v[114:115], v[8:9], v[48:51]
    v_mfma_f32_16x16x16_bf16 v[52:55], v[104:105], v[148:149], 0
    v_mfma_f32_16x16x16_bf16 v[52:55], v[110:111], v[10:11], v[52:55]
    v_mfma_f32_16x16x16_bf16 v[56:59], v[106:107], v[148:149], 0
    v_mfma_f32_16x16x16_bf16 v[56:59], v[112:113], v[10:11], v[56:59]
    v_mfma_f32_16x16x16_bf16 v[60:63], v[108:109], v[148:149], 0
    v_mfma_f32_16x16x16_bf16 v[60:63], v[114:115], v[10:11], v[60:63]
    s_nop 1
    v_add_f32 v48, 0x358637bd, v48
    v_rcp_f32 v48, v48
    s_nop 0
    v_mul_f32 v40, v40, v48
    v_mul_f32 v41, v41, v48
    v_mul_f32 v42, v42, v48
    v_mul_f32 v43, v43, v48
    v_mul_f32 v46, v46, v48
    v_mul_f32 v47, v47, v48
    v_cvt_pk_bf16_f32 v40, v40, v41
    v_cvt_pk_bf16_f32 v41, v42, v43
    v_cvt_pk_bf16_f32 v42, v46, v47
    buffer_store_dwordx2 v[40:41], v200, s[4:7], s42 offen sc1
    s_mov_b64 exec, 0xffff
    buffer_store_dword v42, v200, s[4:7], s43 offen sc1
    s_mov_b64 exec, -1
    s_add_u32 s42, s42, 149504
    s_add_u32 s43, s43, 149504
    v_add_f32 v60, 0x358637bd, v60
    v_rcp_f32 v60, v60
    s_nop 0
    v_mul_f32 v52, v52, v60
    v_mul_f32 v53, v53, v60
    v_mul_f32 v54, v54, v60
    v_mul_f32 v55, v55, v60
    v_mul_f32 v58, v58, v60
    v_mul_f32 v59, v59, v60
    v_cvt_pk_bf16_f32 v52, v52, v53
    v_cvt_pk_bf16_f32 v53, v54, v55
    v_cvt_pk_bf16_f32 v54, v58, v59
    buffer_store_dwordx2 v[52:53], v200, s[4:7], s42 offen sc1
    s_mov_b64 exec, 0xffff
    buffer_store_dword v54, v200, s[4:7], s43 offen sc1
    s_mov_b64 exec, -1
    s_add_u32 s42, s42, 149504
    s_add_u32 s43, s43, 149504
    v_mov_b32 v8, v156
    v_mov_b32 v10, v157
    v_mfma_f32_16x16x16_bf16 v[16:19], v[104:105], v[152:153], 0
    v_mfma_f32_16x16x16_bf16 v[16:19], v[110:111], v[8:9], v[16:19]
    v_mfma_f32_16x16x16_bf16 v[20:23], v[106:107], v[152:153], 0
    v_mfma_f32_16x16x16_bf16 v[20:23], v[112:113], v[8:9], v[20:23]
    v_mfma_f32_16x16x16_bf16 v[24:27], v[108:109], v[152:153], 0
    v_mfma_f32_16x16x16_bf16 v[24:27], v[114:115], v[8:9], v[24:27]
    v_mfma_f32_16x16x16_bf16 v[28:31], v[104:105], v[154:155], 0
    v_mfma_f32_16x16x16_bf16 v[28:31], v[110:111], v[10:11], v[28:31]
    v_mfma_f32_16x16x16_bf16 v[32:35], v[106:107], v[154:155], 0
    v_mfma_f32_16x16x16_bf16 v[32:35], v[112:113], v[10:11], v[32:35]
    v_mfma_f32_16x16x16_bf16 v[36:39], v[108:109], v[154:155], 0
    v_mfma_f32_16x16x16_bf16 v[36:39], v[114:115], v[10:11], v[36:39]
    s_nop 1
    v_add_f32 v24, 0x358637bd, v24
    v_rcp_f32 v24, v24
    s_nop 0
    v_mul_f32 v16, v16, v24
    v_mul_f32 v17, v17, v24
    v_mul_f32 v18, v18, v24
    v_mul_f32 v19, v19, v24
    v_mul_f32 v22, v22, v24
    v_mul_f32 v23, v23, v24
    v_cvt_pk_bf16_f32 v16, v16, v17
    v_cvt_pk_bf16_f32 v17, v18, v19
    v_cvt_pk_bf16_f32 v18, v22, v23
    buffer_store_dwordx2 v[16:17], v200, s[4:7], s42 offen sc1
    s_mov_b64 exec, 0xffff
    buffer_store_dword v18, v200, s[4:7], s43 offen sc1
    s_mov_b64 exec, -1
    s_add_u32 s42, s42, 149504
    s_add_u32 s43, s43, 149504
    v_add_f32 v36, 0x358637bd, v36
    v_rcp_f32 v36, v36
    s_nop 0
    v_mul_f32 v28, v28, v36
    v_mul_f32 v29, v29, v36
    v_mul_f32 v30, v30, v36
    v_mul_f32 v31, v31, v36
    v_mul_f32 v34, v34, v36
    v_mul_f32 v35, v35, v36
    v_cvt_pk_bf16_f32 v28, v28, v29
    v_cvt_pk_bf16_f32 v29, v30, v31
    v_cvt_pk_bf16_f32 v30, v34, v35
    buffer_store_dwordx2 v[28:29], v200, s[4:7], s42 offen sc1
    s_mov_b64 exec, 0xffff
    buffer_store_dword v30, v200, s[4:7], s43 offen sc1
    s_mov_b64 exec, -1
    s_add_u32 s42, s42, 149504
    s_add_u32 s43, s43, 149504
    v_mov_b32 v8, v162
    v_mov_b32 v10, v163
    v_mfma_f32_16x16x16_bf16 v[40:43], v[104:105], v[158:159], 0
    v_mfma_f32_16x16x16_bf16 v[40:43], v[110:111], v[8:9], v[40:43]
    v_mfma_f32_16x16x16_bf16 v[44:47], v[106:107], v[158:159], 0
    v_mfma_f32_16x16x16_bf16 v[44:47], v[112:113], v[8:9], v[44:47]
    v_mfma_f32_16x16x16_bf16 v[48:51], v[108:109], v[158:159], 0
    v_mfma_f32_16x16x16_bf16 v[48:51], v[114:115], v[8:9], v[48:51]
    v_mfma_f32_16x16x16_bf16 v[52:55], v[104:105], v[160:161], 0
    v_mfma_f32_16x16x16_bf16 v[52:55], v[110:111], v[10:11], v[52:55]
    v_mfma_f32_16x16x16_bf16 v[56:59], v[106:107], v[160:161], 0
    v_mfma_f32_16x16x16_bf16 v[56:59], v[112:113], v[10:11], v[56:59]
    v_mfma_f32_16x16x16_bf16 v[60:63], v[108:109], v[160:161], 0
    v_mfma_f32_16x16x16_bf16 v[60:63], v[114:115], v[10:11], v[60:63]
    s_nop 1
    v_add_f32 v48, 0x358637bd, v48
    v_rcp_f32 v48, v48
    s_nop 0
    v_mul_f32 v40, v40, v48
    v_mul_f32 v41, v41, v48
    v_mul_f32 v42, v42, v48
    v_mul_f32 v43, v43, v48
    v_mul_f32 v46, v46, v48
    v_mul_f32 v47, v47, v48
    v_cvt_pk_bf16_f32 v40, v40, v41
    v_cvt_pk_bf16_f32 v41, v42, v43
    v_cvt_pk_bf16_f32 v42, v46, v47
    buffer_store_dwordx2 v[40:41], v200, s[4:7], s42 offen sc1
    s_mov_b64 exec, 0xffff
    buffer_store_dword v42, v200, s[4:7], s43 offen sc1
    s_mov_b64 exec, -1
    s_add_u32 s42, s42, 149504
    s_add_u32 s43, s43, 149504
    v_add_f32 v60, 0x358637bd, v60
    v_rcp_f32 v60, v60
    s_nop 0
    v_mul_f32 v52, v52, v60
    v_mul_f32 v53, v53, v60
    v_mul_f32 v54, v54, v60
    v_mul_f32 v55, v55, v60
    v_mul_f32 v58, v58, v60
    v_mul_f32 v59, v59, v60
    v_cvt_pk_bf16_f32 v52, v52, v53
    v_cvt_pk_bf16_f32 v53, v54, v55
    v_cvt_pk_bf16_f32 v54, v58, v59
    buffer_store_dwordx2 v[52:53], v200, s[4:7], s42 offen sc1
    s_mov_b64 exec, 0xffff
    buffer_store_dword v54, v200, s[4:7], s43 offen sc1
    s_mov_b64 exec, -1
    s_add_u32 s42, s42, 149504
    s_add_u32 s43, s43, 149504
    v_mov_b32 v8, v168
    v_mov_b32 v10, v169
    v_mfma_f32_16x16x16_bf16 v[16:19], v[104:105], v[164:165], 0
    v_mfma_f32_16x16x16_bf16 v[16:19], v[110:111], v[8:9], v[16:19]
    v_mfma_f32_16x16x16_bf16 v[20:23], v[106:107], v[164:165], 0
    v_mfma_f32_16x16x16_bf16 v[20:23], v[112:113], v[8:9], v[20:23]
    v_mfma_f32_16x16x16_bf16 v[24:27], v[108:109], v[164:165], 0
    v_mfma_f32_16x16x16_bf16 v[24:27], v[114:115], v[8:9], v[24:27]
    v_mfma_f32_16x16x16_bf16 v[28:31], v[104:105], v[166:167], 0
    v_mfma_f32_16x16x16_bf16 v[28:31], v[110:111], v[10:11], v[28:31]
    v_mfma_f32_16x16x16_bf16 v[32:35], v[106:107], v[166:167], 0
    v_mfma_f32_16x16x16_bf16 v[32:35], v[112:113], v[10:11], v[32:35]
    v_mfma_f32_16x16x16_bf16 v[36:39], v[108:109], v[166:167], 0
    v_mfma_f32_16x16x16_bf16 v[36:39], v[114:115], v[10:11], v[36:39]
    s_nop 1
    v_add_f32 v24, 0x358637bd, v24
    v_rcp_f32 v24, v24
    s_nop 0
    v_mul_f32 v16, v16, v24
    v_mul_f32 v17, v17, v24
    v_mul_f32 v18, v18, v24
    v_mul_f32 v19, v19, v24
    v_mul_f32 v22, v22, v24
    v_mul_f32 v23, v23, v24
    v_cvt_pk_bf16_f32 v16, v16, v17
    v_cvt_pk_bf16_f32 v17, v18, v19
    v_cvt_pk_bf16_f32 v18, v22, v23
    buffer_store_dwordx2 v[16:17], v200, s[4:7], s42 offen sc1
    s_mov_b64 exec, 0xffff
    buffer_store_dword v18, v200, s[4:7], s43 offen sc1
    s_mov_b64 exec, -1
    s_add_u32 s42, s42, 149504
    s_add_u32 s43, s43, 149504
    v_add_f32 v36, 0x358637bd, v36
    v_rcp_f32 v36, v36
    s_nop 0
    v_mul_f32 v28, v28, v36
    v_mul_f32 v29, v29, v36
    v_mul_f32 v30, v30, v36
    v_mul_f32 v31, v31, v36
    v_mul_f32 v34, v34, v36
    v_mul_f32 v35, v35, v36
    v_cvt_pk_bf16_f32 v28, v28, v29
    v_cvt_pk_bf16_f32 v29, v30, v31
    v_cvt_pk_bf16_f32 v30, v34, v35
    buffer_store_dwordx2 v[28:29], v200, s[4:7], s42 offen sc1
    s_mov_b64 exec, 0xffff
    buffer_store_dword v30, v200, s[4:7], s43 offen sc1
    s_mov_b64 exec, -1
    s_add_u32 s42, s42, 149504
    s_add_u32 s43, s43, 149504
    v_mov_b32 v8, v174
    v_mov_b32 v10, v175
    v_mfma_f32_16x16x16_bf16 v[40:43], v[104:105], v[170:171], 0
    v_mfma_f32_16x16x16_bf16 v[40:43], v[110:111], v[8:9], v[40:43]
    v_mfma_f32_16x16x16_bf16 v[44:47], v[106:107], v[170:171], 0
    v_mfma_f32_16x16x16_bf16 v[44:47], v[112:113], v[8:9], v[44:47]
    v_mfma_f32_16x16x16_bf16 v[48:51], v[108:109], v[170:171], 0
    v_mfma_f32_16x16x16_bf16 v[48:51], v[114:115], v[8:9], v[48:51]
    v_mfma_f32_16x16x16_bf16 v[52:55], v[104:105], v[172:173], 0
    v_mfma_f32_16x16x16_bf16 v[52:55], v[110:111], v[10:11], v[52:55]
    v_mfma_f32_16x16x16_bf16 v[56:59], v[106:107], v[172:173], 0
    v_mfma_f32_16x16x16_bf16 v[56:59], v[112:113], v[10:11], v[56:59]
    v_mfma_f32_16x16x16_bf16 v[60:63], v[108:109], v[172:173], 0
    v_mfma_f32_16x16x16_bf16 v[60:63], v[114:115], v[10:11], v[60:63]
    s_nop 1
    v_add_f32 v48, 0x358637bd, v48
    v_rcp_f32 v48, v48
    s_nop 0
    v_mul_f32 v40, v40, v48
    v_mul_f32 v41, v41, v48
    v_mul_f32 v42, v42, v48
    v_mul_f32 v43, v43, v48
    v_mul_f32 v46, v46, v48
    v_mul_f32 v47, v47, v48
    v_cvt_pk_bf16_f32 v40, v40, v41
    v_cvt_pk_bf16_f32 v41, v42, v43
    v_cvt_pk_bf16_f32 v42, v46, v47
    buffer_store_dwordx2 v[40:41], v200, s[4:7], s42 offen sc1
    s_mov_b64 exec, 0xffff
    buffer_store_dword v42, v200, s[4:7], s43 offen sc1
    s_mov_b64 exec, -1
    s_add_u32 s42, s42, 149504
    s_add_u32 s43, s43, 149504
    v_add_f32 v60, 0x358637bd, v60
    v_rcp_f32 v60, v60
    s_nop 0
    v_mul_f32 v52, v52, v60
    v_mul_f32 v53, v53, v60
    v_mul_f32 v54, v54, v60
    v_mul_f32 v55, v55, v60
    v_mul_f32 v58, v58, v60
    v_mul_f32 v59, v59, v60
    v_cvt_pk_bf16_f32 v52, v52, v53
    v_cvt_pk_bf16_f32 v53, v54, v55
    v_cvt_pk_bf16_f32 v54, v58, v59
    buffer_store_dwordx2 v[52:53], v200, s[4:7], s42 offen sc1
    s_mov_b64 exec, 0xffff
    buffer_store_dword v54, v200, s[4:7], s43 offen sc1
    s_mov_b64 exec, -1
    s_add_u32 s42, s42, 149504
    s_add_u32 s43, s43, 149504
    s_waitcnt vmcnt(0)
    s_barrier
    s_add_u32 s27, s27, 16384
    s_mov_b64 exec, 1
    buffer_store_dword v204, v203, s[4:7], s27 offen sc1
    s_mov_b64 exec, -1
    s_branch W_FIN
W_NEXT:
    s_cmp_ge_u32 s21, 128
    s_cbranch_scc1 W_FINQ
    s_mov_b32 s36, 0x3e0293ee
    s_lshr_b32 s26, s21, 2
    s_and_b32 s25, s21, 3
    s_and_b32 s28, s20, 1
    s_lshr_b32 s29, s20, 1
    v_and_b32 v1, 15, v201
    s_lshl_b32 s31, s28, 4
    v_add_u32 v1, s31, v1
    v_lshrrev_b32 v2, 4, v201
    v_lshlrev_b32 v3, 2, v2
    v_add_u32 v4, 0, v3
    v_cmp_gt_u32 s[40:41], v4, v1
    v_add_u32 v4, 1, v3
    v_cmp_gt_u32 s[42:43], v4, v1
    v_add_u32 v4, 2, v3
    v_cmp_gt_u32 s[44:45], v4, v1
    v_add_u32 v4, 3, v3
    v_cmp_gt_u32 s[46:47], v4, v1
    v_add_u32 v4, 16, v3
    v_cmp_gt_u32 s[48:49], v4, v1
    v_add_u32 v4, 17, v3
    v_cmp_gt_u32 s[50:51], v4, v1
    v_add_u32 v4, 18, v3
    v_cmp_gt_u32 s[52:53], v4, v1
    v_add_u32 v4, 19, v3
    v_cmp_gt_u32 s[54:55], v4, v1
    s_mov_b32 s56, 0
    s_mov_b32 s57, -1
    v_mov_b32 v203, 0
    v_lshrrev_b32 v204, 1, v200
    v_and_b32 v4, 7, v201
    v_lshl_add_u32 v4, v2, 3, v4
    v_lshlrev_b32 v202, 4, v4
    s_lshl_b32 s58, s26, 9
    s_lshr_b32 s59, s26, 1
    s_lshl_b32 s59, s59, 8
    s_add_u32 s59, s59, 16384
    v_mov_b32 v206, 0xff800000
    v_mov_b32 v243, 0xd028965f
    s_lshl_b32 s31, s20, 11
    v_add_u32 v240, s31, v200
    s_lshl_b32 s31, s29, 11
    v_add_u32 v241, s31, v200
AL_45:
    s_and_b32 s31, s25, 1
    s_lshl_b32 s31, s31, 7
    s_add_u32 s31, s31, s59
    s_add_u32 s31, s31, 0x200000
    s_lshr_b32 s32, s25, 1
    s_add_u32 s32, s32, 1
    s_mov_b32 exec_lo, 0x1
    s_mov_b32 exec_hi, 0x0
POLL_46:
    buffer_load_dword v207, v203, s[4:7], s31 offen sc1
    s_waitcnt vmcnt(0)
    v_cmp_gt_u32 vcc, s32, v207
    s_cbranch_vccz POLLOK_47
    s_sleep 8
    s_sub_u32 s22, s22, 1
    s_cbranch_scc0 POLL_46
    s_mov_b64 exec, -1
    s_branch W_FAIL
POLLOK_47:
    s_mov_b64 exec, -1
    s_lshl_b32 s27, s25, 5
    s_add_u32 s27, s27, s26
    s_lshl_b32 s33, s27, 13
    s_lshl_b32 s31, s28, 12
    s_add_u32 s31, s31, s33
    s_add_u32 s31, s31, 0x3000000
    buffer_load_dwordx4 v[72:75], v200, s[4:7], s31 offen offset:0 sc1
    buffer_load_dwordx4 v[76:79], v200, s[4:7], s31 offen offset:1024 sc1
    buffer_load_dwordx4 v[80:83], v200, s[4:7], s31 offen offset:2048 sc1
    buffer_load_dwordx4 v[84:87], v200, s[4:7], s31 offen offset:3072 sc1
    s_add_u32 s31, s33, 0x1000000
    s_add_u32 s32, s33, 0x1001000
    buffer_load_dwordx4 v[88:91], v200, s[4:7], s31 offen offset:0 sc1
    buffer_load_dwordx4 v[92:95], v200, s[4:7], s31 offen offset:1024 sc1
    buffer_load_dwordx4 v[96:99], v200, s[4:7], s31 offen offset:2048 sc1
    buffer_load_dwordx4 v[100:103], v200, s[4:7], s31 offen offset:3072 sc1
    buffer_load_dwordx4 v[104:107], v200, s[4:7], s32 offen offset:0 sc1
    buffer_load_dwordx4 v[108:111], v200, s[4:7], s32 offen offset:1024 sc1
    buffer_load_dwordx4 v[112:115], v200, s[4:7], s32 offen offset:2048 sc1
    buffer_load_dwordx4 v[116:119], v200, s[4:7], s32 offen offset:3072 sc1
    s_lshl_b32 s31, s29, 12
    s_add_u32 s31, s31, s33
    s_add_u32 s31, s31, 0x2000000
    buffer_load_dwordx4 v[120:123], v200, s[4:7], s31 offen offset:0 sc1
    buffer_load_dwordx4 v[124:127], v200, s[4:7], s31 offen offset:1024 sc1
    buffer_load_dwordx4 v[128:131], v200, s[4:7], s31 offen offset:2048 sc1
    buffer_load_dwordx4 v[132:135], v200, s[4:7], s31 offen offset:3072 sc1
    s_waitcnt vmcnt(4)
    v_mfma_f32_16x16x32_bf16 v[164:167], v[88:91], v[72:75], 0
    v_mfma_f32_16x16x32_bf16 v[164:167], v[92:95], v[76:79], v[164:167]
    v_mfma_f32_16x16x32_bf16 v[164:167], v[96:99], v[80:83], v[164:167]
    v_mfma_f32_16x16x32_bf16 v[164:167], v[100:103], v[84:87], v[164:167]
    v_mfma_f32_16x16x32_bf16 v[168:171], v[104:107], v[72:75], 0
    v_mfma_f32_16x16x32_bf16 v[168:171], v[108:111], v[76:79], v[168:171]
    v_mfma_f32_16x16x32_bf16 v[168:171], v[112:115], v[80:83], v[168:171]
    v_mfma_f32_16x16x32_bf16 v[168:171], v[116:119], v[84:87], v[168:171]
    s_mul_i32 s31, s25, 9216
    s_add_u32 s31, s31, 0x110000
    s_add_u32 s32, s31, 4096
    s_add_u32 s33, s31, 8192
MPRE_50:
    buffer_load_dwordx4 v[68:71], v202, s[4:7], s33 offen offset:512 sc1
    s_waitcnt vmcnt(0)
    v_cmp_eq_u32 vcc, 0xffbfffbf, v68
    s_cbranch_vccz MP_48
    s_sleep 2
    s_sub_u32 s22, s22, 1
    s_cbranch_scc0 MPRE_50
    s_branch W_FAIL
MP_48:
    buffer_load_dwordx4 v[0:3], v202, s[4:7], s31 offen offset:0 sc1
    buffer_load_dwordx4 v[4:7], v202, s[4:7], s31 offen offset:512 sc1
    buffer_load_dwordx4 v[8:11], v202, s[4:7], s31 offen offset:1024 sc1
    buffer_load_dwordx4 v[12:15], v202, s[4:7], s31 offen offset:1536 sc1
    buffer_load_dwordx4 v[16:19], v202, s[4:7], s31 offen offset:2048 sc1
    buffer_load_dwordx4 v[20:23], v202, s[4:7], s31 offen offset:2560 sc1
    buffer_load_dwordx4 v[24:27], v202, s[4:7], s31 offen offset:3072 sc1
    buffer_load_dwordx4 v[28:31], v202, s[4:7], s31 offen offset:3584 sc1
    buffer_load_dwordx4 v[32:35], v202, s[4:7], s32 offen offset:0 sc1
    buffer_load_dwordx4 v[36:39], v202, s[4:7], s32 offen offset:512 sc1
    buffer_load_dwordx4 v[40:43], v202, s[4:7], s32 offen offset:1024 sc1
    buffer_load_dwordx4 v[44:47], v202, s[4:7], s32 offen offset:1536 sc1
    buffer_load_dwordx4 v[48:51], v202, s[4:7], s32 offen offset:2048 sc1
    buffer_load_dwordx4 v[52:55], v202, s[4:7], s32 offen offset:2560 sc1
    buffer_load_dwordx4 v[56:59], v202, s[4:7], s32 offen offset:3072 sc1
    buffer_load_dwordx4 v[60:63], v202, s[4:7], s32 offen offset:3584 sc1
    buffer_load_dwordx4 v[64:67], v202, s[4:7], s33 offen offset:0 sc1
    buffer_load_dwordx4 v[68:71], v202, s[4:7], s33 offen offset:512 sc1
    s_sub_u32 s22, s22, 1
    s_cbranch_scc1 W_FAIL
    s_waitcnt vmcnt(0)
    v_max3_u32 v207, v0, v1, v2
    v_max3_u32 v207, v207, v3, v4
    v_max3_u32 v207, v207, v5, v6
    v_max3_u32 v207, v207, v7, v8
    v_max3_u32 v207, v207, v9, v10
    v_max3_u32 v207, v207, v11, v12
    v_max3_u32 v207, v207, v13, v14
    v_max3_u32 v207, v207, v15, v16
    v_max3_u32 v207, v207, v17, v18
    v_max3_u32 v207, v207, v19, v20
    v_max3_u32 v207, v207, v21, v22
    v_max3_u32 v207, v207, v23, v24
    v_max3_u32 v207, v207, v25, v26
    v_max3_u32 v207, v207, v27, v28
    v_max3_u32 v207, v207, v29, v30
    v_max3_u32 v207, v207, v31, v32
    v_max3_u32 v207, v207, v33, v34
    v_max3_u32 v207, v207, v35, v36
    v_max3_u32 v207, v207, v37, v38
    v_max3_u32 v207, v207, v39, v40
    v_max3_u32 v207, v207, v41, v42
    v_max3_u32 v207, v207, v43, v44
    v_max3_u32 v207, v207, v45, v46
    v_max3_u32 v207, v207, v47, v48
    v_max3_u32 v207, v207, v49, v50
    v_max3_u32 v207, v207, v51, v52
    v_max3_u32 v207, v207, v53, v54
    v_max3_u32 v207, v207, v55, v56
    v_max3_u32 v207, v207, v57, v58
    v_max3_u32 v207, v207, v59, v60
    v_max3_u32 v207, v207, v61, v62
    v_max3_u32 v207, v207, v63, v64
    v_max3_u32 v207, v207, v65, v66
    v_max3_u32 v207, v207, v67, v68
    v_max3_u32 v207, v207, v69, v70
    v_max_u32 v207, v207, v71
    v_cmp_eq_u32 vcc, 0xffbfffbf, v207
    s_cbranch_vccnz MP_48
    s_cmp_lg_u32 s29, 0
    s_cbranch_scc1 APV_51
    v_mfma_f32_16x16x32_bf16 v[172:175], a[0:3], v[0:3], 0
    v_mfma_f32_16x16x32_bf16 v[176:179], a[72:75], v[0:3], 0
    v_mfma_f32_16x16x32_bf16 v[180:183], a[144:147], v[0:3], 0
    v_mfma_f32_16x16x32_bf16 v[184:187], a[216:219], v[0:3], 0
    v_mfma_f32_16x16x32_bf16 v[172:175], a[4:7], v[4:7], v[172:175]
    v_mfma_f32_16x16x32_bf16 v[176:179], a[76:79], v[4:7], v[176:179]
    v_mfma_f32_16x16x32_bf16 v[180:183], a[148:151], v[4:7], v[180:183]
    v_mfma_f32_16x16x32_bf16 v[184:187], a[220:223], v[4:7], v[184:187]
    v_mfma_f32_16x16x32_bf16 v[172:175], a[8:11], v[8:11], v[172:175]
    v_mfma_f32_16x16x32_bf16 v[176:179], a[80:83], v[8:11], v[176:179]
    v_mfma_f32_16x16x32_bf16 v[180:183], a[152:155], v[8:11], v[180:183]
    v_mfma_f32_16x16x32_bf16 v[184:187], a[224:227], v[8:11], v[184:187]
    v_mfma_f32_16x16x32_bf16 v[172:175], a[12:15], v[12:15], v[172:175]
    v_mfma_f32_16x16x32_bf16 v[176:179], a[84:87], v[12:15], v[176:179]
    v_mfma_f32_16x16x32_bf16 v[180:183], a[156:159], v[12:15], v[180:183]
    v_mfma_f32_16x16x32_bf16 v[184:187], a[228:231], v[12:15], v[184:187]
    v_mfma_f32_16x16x32_bf16 v[172:175], a[16:19], v[16:19], v[172:175]
    v_mfma_f32_16x16x32_bf16 v[176:179], a[88:91], v[16:19], v[176:179]
    v_mfma_f32_16x16x32_bf16 v[180:183], a[160:163], v[16:19], v[180:183]
    v_mfma_f32_16x16x32_bf16 v[184:187], a[232:235], v[16:19], v[184:187]
    v_mfma_f32_16x16x32_bf16 v[172:175], a[20:23], v[20:23], v[172:175]
    v_mfma_f32_16x16x32_bf16 v[176:179], a[92:95], v[20:23], v[176:179]
    v_mfma_f32_16x16x32_bf16 v[180:183], a[164:167], v[20:23], v[180:183]
    v_mfma_f32_16x16x32_bf16 v[184:187], a[236:239], v[20:23], v[184:187]
    v_mfma_f32_16x16x32_bf16 v[172:175], a[24:27], v[24:27], v[172:175]
    v_mfma_f32_16x16x32_bf16 v[176:179], a[96:99], v[24:27], v[176:179]
    v_mfma_f32_16x16x32_bf16 v[180:183], a[168:171], v[24:27], v[180:183]
    v_mfma_f32_16x16x32_bf16 v[184:187], a[240:243], v[24:27], v[184:187]
    v_mfma_f32_16x16x32_bf16 v[172:175], a[28:31], v[28:31], v[172:175]
    v_mfma_f32_16x16x32_bf16 v[176:179], a[100:103], v[28:31], v[176:179]
    v_mfma_f32_16x16x32_bf16 v[180:183], a[172:175], v[28:31], v[180:183]
    v_mfma_f32_16x16x32_bf16 v[184:187], a[244:247], v[28:31], v[184:187]
    v_mfma_f32_16x16x32_bf16 v[172:175], a[32:35], v[32:35], v[172:175]
    v_mfma_f32_16x16x32_bf16 v[176:179], a[104:107], v[32:35], v[176:179]
    v_mfma_f32_16x16x32_bf16 v[180:183], a[176:179], v[32:35], v[180:183]
    v_mfma_f32_16x16x32_bf16 v[184:187], a[248:251], v[32:35], v[184:187]
    v_mfma_f32_16x16x32_bf16 v[172:175], a[36:39], v[36:39], v[172:175]
    v_mfma_f32_16x16x32_bf16 v[176:179], a[108:111], v[36:39], v[176:179]
    v_mfma_f32_16x16x32_bf16 v[180:183], a[180:183], v[36:39], v[180:183]
    v_mfma_f32_16x16x32_bf16 v[184:187], a[252:255], v[36:39], v[184:187]
    v_mfma_f32_16x16x32_bf16 v[172:175], a[40:43], v[40:43], v[172:175]
    v_mfma_f32_16x16x32_bf16 v[176:179], a[112:115], v[40:43], v[176:179]
    v_mfma_f32_16x16x32_bf16 v[180:183], a[184:187], v[40:43], v[180:183]
    v_mfma_f32_16x16x32_bf16 v[184:187], v[208:211], v[40:43], v[184:187]
    v_mfma_f32_16x16x32_bf16 v[172:175], a[44:47], v[44:47], v[172:175]
    v_mfma_f32_16x16x32_bf16 v[176:179], a[116:119], v[44:47], v[176:179]
    v_mfma_f32_16x16x32_bf16 v[180:183], a[188:191], v[44:47], v[180:183]
    v_mfma_f32_16x16x32_bf16 v[184:187], v[212:215], v[44:47], v[184:187]
    v_mfma_f32_16x16x32_bf16 v[172:175], a[48:51], v[48:51], v[172:175]
    v_mfma_f32_16x16x32_bf16 v[176:179], a[120:123], v[48:51], v[176:179]
    v_mfma_f32_16x16x32_bf16 v[180:183], a[192:195], v[48:51], v[180:183]
    v_mfma_f32_16x16x32_bf16 v[184:187], v[216:219], v[48:51], v[184:187]
    v_mfma_f32_16x16x32_bf16 v[172:175], a[52:55], v[52:55], v[172:175]
    v_mfma_f32_16x16x32_bf16 v[176:179], a[124:127], v[52:55], v[176:179]
    v_mfma_f32_16x16x32_bf16 v[180:183], a[196:199], v[52:55], v[180:183]
    v_mfma_f32_16x16x32_bf16 v[184:187], v[220:223], v[52:55], v[184:187]
    v_mfma_f32_16x16x32_bf16 v[172:175], a[56:59], v[56:59], v[172:175]
    v_mfma_f32_16x16x32_bf16 v[176:179], a[128:131], v[56:59], v[176:179]
    v_mfma_f32_16x16x32_bf16 v[180:183], a[200:203], v[56:59], v[180:183]
    v_mfma_f32_16x16x32_bf16 v[184:187], v[224:227], v[56:59], v[184:187]
    v_mfma_f32_16x16x32_bf16 v[172:175], a[60:63], v[60:63], v[172:175]
    v_mfma_f32_16x16x32_bf16 v[176:179], a[132:135], v[60:63], v[176:179]
    v_mfma_f32_16x16x32_bf16 v[180:183], a[204:207], v[60:63], v[180:183]
    v_mfma_f32_16x16x32_bf16 v[184:187], v[228:231], v[60:63], v[184:187]
    v_mfma_f32_16x16x32_bf16 v[172:175], a[64:67], v[64:67], v[172:175]
    v_mfma_f32_16x16x32_bf16 v[176:179], a[136:139], v[64:67], v[176:179]
    v_mfma_f32_16x16x32_bf16 v[180:183], a[208:211], v[64:67], v[180:183]
    v_mfma_f32_16x16x32_bf16 v[184:187], v[232:235], v[64:67], v[184:187]
    v_mfma_f32_16x16x32_bf16 v[172:175], a[68:71], v[68:71], v[172:175]
    v_mfma_f32_16x16x32_bf16 v[176:179], a[140:143], v[68:71], v[176:179]
    v_mfma_f32_16x16x32_bf16 v[180:183], a[212:215], v[68:71], v[180:183]
    v_mfma_f32_16x16x32_bf16 v[184:187], v[236:239], v[68:71], v[184:187]
    s_branch APE_52
APV_51:
    v_mfma_f32_16x16x32_bf16 v[172:175], v[0:3], a[0:3], 0
    v_mfma_f32_16x16x32_bf16 v[176:179], v[0:3], a[72:75], 0
    v_mfma_f32_16x16x32_bf16 v[180:183], v[0:3], a[144:147], 0
    v_mfma_f32_16x16x32_bf16 v[184:187], v[0:3], a[216:219], 0
    v_mfma_f32_16x16x32_bf16 v[172:175], v[4:7], a[4:7], v[172:175]
    v_mfma_f32_16x16x32_bf16 v[176:179], v[4:7], a[76:79], v[176:179]
    v_mfma_f32_16x16x32_bf16 v[180:183], v[4:7], a[148:151], v[180:183]
    v_mfma_f32_16x16x32_bf16 v[184:187], v[4:7], a[220:223], v[184:187]
    v_mfma_f32_16x16x32_bf16 v[172:175], v[8:11], a[8:11], v[172:175]
    v_mfma_f32_16x16x32_bf16 v[176:179], v[8:11], a[80:83], v[176:179]
    v_mfma_f32_16x16x32_bf16 v[180:183], v[8:11], a[152:155], v[180:183]
    v_mfma_f32_16x16x32_bf16 v[184:187], v[8:11], a[224:227], v[184:187]
    v_mfma_f32_16x16x32_bf16 v[172:175], v[12:15], a[12:15], v[172:175]
    v_mfma_f32_16x16x32_bf16 v[176:179], v[12:15], a[84:87], v[176:179]
    v_mfma_f32_16x16x32_bf16 v[180:183], v[12:15], a[156:159], v[180:183]
    v_mfma_f32_16x16x32_bf16 v[184:187], v[12:15], a[228:231], v[184:187]
    v_mfma_f32_16x16x32_bf16 v[172:175], v[16:19], a[16:19], v[172:175]
    v_mfma_f32_16x16x32_bf16 v[176:179], v[16:19], a[88:91], v[176:179]
    v_mfma_f32_16x16x32_bf16 v[180:183], v[16:19], a[160:163], v[180:183]
    v_mfma_f32_16x16x32_bf16 v[184:187], v[16:19], a[232:235], v[184:187]
    v_mfma_f32_16x16x32_bf16 v[172:175], v[20:23], a[20:23], v[172:175]
    v_mfma_f32_16x16x32_bf16 v[176:179], v[20:23], a[92:95], v[176:179]
    v_mfma_f32_16x16x32_bf16 v[180:183], v[20:23], a[164:167], v[180:183]
    v_mfma_f32_16x16x32_bf16 v[184:187], v[20:23], a[236:239], v[184:187]
    v_mfma_f32_16x16x32_bf16 v[172:175], v[24:27], a[24:27], v[172:175]
    v_mfma_f32_16x16x32_bf16 v[176:179], v[24:27], a[96:99], v[176:179]
    v_mfma_f32_16x16x32_bf16 v[180:183], v[24:27], a[168:171], v[180:183]
    v_mfma_f32_16x16x32_bf16 v[184:187], v[24:27], a[240:243], v[184:187]
    v_mfma_f32_16x16x32_bf16 v[172:175], v[28:31], a[28:31], v[172:175]
    v_mfma_f32_16x16x32_bf16 v[176:179], v[28:31], a[100:103], v[176:179]
    v_mfma_f32_16x16x32_bf16 v[180:183], v[28:31], a[172:175], v[180:183]
    v_mfma_f32_16x16x32_bf16 v[184:187], v[28:31], a[244:247], v[184:187]
    v_mfma_f32_16x16x32_bf16 v[172:175], v[32:35], a[32:35], v[172:175]
    v_mfma_f32_16x16x32_bf16 v[176:179], v[32:35], a[104:107], v[176:179]
    v_mfma_f32_16x16x32_bf16 v[180:183], v[32:35], a[176:179], v[180:183]
    v_mfma_f32_16x16x32_bf16 v[184:187], v[32:35], a[248:251], v[184:187]
    v_mfma_f32_16x16x32_bf16 v[172:175], v[36:39], a[36:39], v[172:175]
    v_mfma_f32_16x16x32_bf16 v[176:179], v[36:39], a[108:111], v[176:179]
    v_mfma_f32_16x16x32_bf16 v[180:183], v[36:39], a[180:183], v[180:183]
    v_mfma_f32_16x16x32_bf16 v[184:187], v[36:39], a[252:255], v[184:187]
    v_mfma_f32_16x16x32_bf16 v[172:175], v[40:43], a[40:43], v[172:175]
    v_mfma_f32_16x16x32_bf16 v[176:179], v[40:43], a[112:115], v[176:179]
    v_mfma_f32_16x16x32_bf16 v[180:183], v[40:43], a[184:187], v[180:183]
    v_mfma_f32_16x16x32_bf16 v[184:187], v[40:43], v[208:211], v[184:187]
    v_mfma_f32_16x16x32_bf16 v[172:175], v[44:47], a[44:47], v[172:175]
    v_mfma_f32_16x16x32_bf16 v[176:179], v[44:47], a[116:119], v[176:179]
    v_mfma_f32_16x16x32_bf16 v[180:183], v[44:47], a[188:191], v[180:183]
    v_mfma_f32_16x16x32_bf16 v[184:187], v[44:47], v[212:215], v[184:187]
    v_mfma_f32_16x16x32_bf16 v[172:175], v[48:51], a[48:51], v[172:175]
    v_mfma_f32_16x16x32_bf16 v[176:179], v[48:51], a[120:123], v[176:179]
    v_mfma_f32_16x16x32_bf16 v[180:183], v[48:51], a[192:195], v[180:183]
    v_mfma_f32_16x16x32_bf16 v[184:187], v[48:51], v[216:219], v[184:187]
    v_mfma_f32_16x16x32_bf16 v[172:175], v[52:55], a[52:55], v[172:175]
    v_mfma_f32_16x16x32_bf16 v[176:179], v[52:55], a[124:127], v[176:179]
    v_mfma_f32_16x16x32_bf16 v[180:183], v[52:55], a[196:199], v[180:183]
    v_mfma_f32_16x16x32_bf16 v[184:187], v[52:55], v[220:223], v[184:187]
    v_mfma_f32_16x16x32_bf16 v[172:175], v[56:59], a[56:59], v[172:175]
    v_mfma_f32_16x16x32_bf16 v[176:179], v[56:59], a[128:131], v[176:179]
    v_mfma_f32_16x16x32_bf16 v[180:183], v[56:59], a[200:203], v[180:183]
    v_mfma_f32_16x16x32_bf16 v[184:187], v[56:59], v[224:227], v[184:187]
    v_mfma_f32_16x16x32_bf16 v[172:175], v[60:63], a[60:63], v[172:175]
    v_mfma_f32_16x16x32_bf16 v[176:179], v[60:63], a[132:135], v[176:179]
    v_mfma_f32_16x16x32_bf16 v[180:183], v[60:63], a[204:207], v[180:183]
    v_mfma_f32_16x16x32_bf16 v[184:187], v[60:63], v[228:231], v[184:187]
    v_mfma_f32_16x16x32_bf16 v[172:175], v[64:67], a[64:67], v[172:175]
    v_mfma_f32_16x16x32_bf16 v[176:179], v[64:67], a[136:139], v[176:179]
    v_mfma_f32_16x16x32_bf16 v[180:183], v[64:67], a[208:211], v[180:183]
    v_mfma_f32_16x16x32_bf16 v[184:187], v[64:67], v[232:235], v[184:187]
    v_mfma_f32_16x16x32_bf16 v[172:175], v[68:71], a[68:71], v[172:175]
    v_mfma_f32_16x16x32_bf16 v[176:179], v[68:71], a[140:143], v[176:179]
    v_mfma_f32_16x16x32_bf16 v[180:183], v[68:71], a[212:215], v[180:183]
    v_mfma_f32_16x16x32_bf16 v[184:187], v[68:71], v[236:239], v[184:187]
APE_52:
    v_cndmask_b32 v164, v164, v243, s[40:41]
    v_cndmask_b32 v165, v165, v243, s[42:43]
    v_cndmask_b32 v166, v166, v243, s[44:45]
    v_cndmask_b32 v167, v167, v243, s[46:47]
    v_cndmask_b32 v168, v168, v243, s[48:49]
    v_cndmask_b32 v169, v169, v243, s[50:51]
    v_cndmask_b32 v170, v170, v243, s[52:53]
    v_cndmask_b32 v171, v171, v243, s[54:55]
    v_cvt_pk_bf16_f32 v172, v172, v173
    v_cvt_pk_bf16_f32 v173, v174, v175
    v_cvt_pk_bf16_f32 v174, v176, v177
    v_cvt_pk_bf16_f32 v175, v178, v179
    v_cvt_pk_bf16_f32 v176, v180, v181
    v_cvt_pk_bf16_f32 v177, v182, v183
    v_cvt_pk_bf16_f32 v178, v184, v185
    v_cvt_pk_bf16_f32 v179, v186, v187
    ds_write_b128 v240, v[172:175]
    ds_write_b128 v240, v[176:179] offset:1024
    s_waitcnt lgkmcnt(0)
    s_barrier
    ds_read_b128 v[136:139], v200 offset:0
    ds_read_b128 v[140:143], v200 offset:1024
    ds_read_b128 v[144:147], v200 offset:2048
    ds_read_b128 v[148:151], v200 offset:3072
    ds_read_b128 v[152:155], v241 offset:4096
    ds_read_b128 v[156:159], v241 offset:5120
    s_waitcnt lgkmcnt(2)
    v_mfma_f32_16x16x32_bf16 v[160:163], v[136:139], v[72:75], 0
    v_mfma_f32_16x16x32_bf16 v[160:163], v[140:143], v[76:79], v[160:163]
    v_mfma_f32_16x16x32_bf16 v[160:163], v[144:147], v[80:83], v[160:163]
    v_mfma_f32_16x16x32_bf16 v[160:163], v[148:151], v[84:87], v[160:163]
    s_nop 7
    v_cndmask_b32 v160, v160, v206, s[56:57]
    v_cndmask_b32 v161, v161, v206, s[56:57]
    v_cndmask_b32 v162, v162, v206, s[56:57]
    v_cndmask_b32 v163, v163, v206, s[56:57]
    v_max3_f32 v195, v160, v161, v162
    v_max3_f32 v195, v195, v163, v164
    v_max3_f32 v195, v195, v165, v166
    v_max3_f32 v195, v195, v167, v168
    v_max3_f32 v195, v195, v169, v170
    v_max_f32 v195, v195, v171
    v_mov_b32 v196, v195
    s_nop 1
    v_permlane16_swap_b32 v195, v196
    v_max_f32 v195, v195, v196
    v_mov_b32 v196, v195
    s_nop 1
    v_permlane32_swap_b32 v195, v196
    v_max_f32 v195, v195, v196
    v_sub_f32 v160, v160, v195
    v_sub_f32 v161, v161, v195
    v_sub_f32 v162, v162, v195
    v_sub_f32 v163, v163, v195
    v_sub_f32 v164, v164, v195
    v_sub_f32 v165, v165, v195
    v_sub_f32 v166, v166, v195
    v_sub_f32 v167, v167, v195
    v_sub_f32 v168, v168, v195
    v_sub_f32 v169, v169, v195
    v_sub_f32 v170, v170, v195
    v_sub_f32 v171, v171, v195
    v_mul_f32 v160, s36, v160
    v_mul_f32 v161, s36, v161
    v_mul_f32 v162, s36, v162
    v_mul_f32 v163, s36, v163
    v_mul_f32 v164, s36, v164
    v_mul_f32 v165, s36, v165
    v_mul_f32 v166, s36, v166
    v_mul_f32 v167, s36, v167
    v_mul_f32 v168, s36, v168
    v_mul_f32 v169, s36, v169
    v_mul_f32 v170, s36, v170
    v_mul_f32 v171, s36, v171
    v_exp_f32 v160, v160
    v_exp_f32 v161, v161
    v_exp_f32 v162, v162
    v_exp_f32 v163, v163
    v_exp_f32 v164, v164
    v_exp_f32 v165, v165
    v_exp_f32 v166, v166
    v_exp_f32 v167, v167
    v_exp_f32 v168, v168
    v_exp_f32 v169, v169
    v_exp_f32 v170, v170
    v_exp_f32 v171, v171
    v_add_f32 v194, v160, v161
    v_add_f32 v194, v194, v162
    v_add_f32 v194, v194, v163
    v_add_f32 v194, v194, v164
    v_add_f32 v194, v194, v165
    v_add_f32 v194, v194, v166
    v_add_f32 v194, v194, v167
    v_add_f32 v194, v194, v168
    v_add_f32 v194, v194, v169
    v_add_f32 v194, v194, v170
    v_add_f32 v194, v194, v171
    v_mov_b32 v196, v194
    s_nop 1
    v_permlane16_swap_b32 v194, v196
    v_add_f32 v194, v194, v196
    v_mov_b32 v196, v194
    s_nop 1
    v_permlane32_swap_b32 v194, v196
    v_add_f32 v194, v194, v196
    v_rcp_f32 v194, v194
    v_cvt_pk_bf16_f32 v192, v160, v161
    v_cvt_pk_bf16_f32 v193, v162, v163
    v_cvt_pk_bf16_f32 v188, v164, v165
    v_cvt_pk_bf16_f32 v189, v166, v167
    v_cvt_pk_bf16_f32 v190, v168, v169
    v_cvt_pk_bf16_f32 v191, v170, v171
    s_waitcnt lgkmcnt(0)
    s_lshl_b32 s31, s25, 1
    s_add_u32 s31, s31, s28
    s_mul_i32 s31, s31, 149504
    s_lshl_b32 s32, s26, 12
    s_add_u32 s31, s31, s32
    s_lshl_b32 s32, s29, 11
    s_add_u32 s31, s31, s32
    s_add_u32 s31, s31, 0x5000000
    v_mfma_f32_16x16x32_bf16 v[0:3], v[120:123], v[188:191], 0
    v_mfma_f32_16x16x32_bf16 v[4:7], v[124:127], v[188:191], 0
    v_mfma_f32_16x16x32_bf16 v[8:11], v[128:131], v[188:191], 0
    v_mfma_f32_16x16x32_bf16 v[12:15], v[132:135], v[188:191], 0
    s_nop 2
    v_mfma_f32_16x16x16_bf16 v[0:3], v[152:153], v[192:193], v[0:3]
    s_nop 2
    v_mfma_f32_16x16x16_bf16 v[4:7], v[154:155], v[192:193], v[4:7]
    s_nop 2
    v_mfma_f32_16x16x16_bf16 v[8:11], v[156:157], v[192:193], v[8:11]
    s_nop 2
    v_mfma_f32_16x16x16_bf16 v[12:15], v[158:159], v[192:193], v[12:15]
    s_nop 4
    v_mul_f32 v0, v0, v194
    v_mul_f32 v1, v1, v194
    v_mul_f32 v2, v2, v194
    v_mul_f32 v3, v3, v194
    s_nop 1
    v_mul_f32 v4, v4, v194
    v_mul_f32 v5, v5, v194
    v_mul_f32 v6, v6, v194
    v_mul_f32 v7, v7, v194
    v_cvt_pk_bf16_f32 v16, v0, v1
    v_cvt_pk_bf16_f32 v17, v2, v3
    v_cvt_pk_bf16_f32 v18, v4, v5
    v_cvt_pk_bf16_f32 v19, v6, v7
    buffer_store_dwordx4 v[16:19], v200, s[4:7], s31 offen offset:0 sc1
    v_mul_f32 v8, v8, v194
    v_mul_f32 v9, v9, v194
    v_mul_f32 v10, v10, v194
    v_mul_f32 v11, v11, v194
    v_mul_f32 v12, v12, v194
    v_mul_f32 v13, v13, v194
    v_mul_f32 v14, v14, v194
    v_mul_f32 v15, v15, v194
    v_cvt_pk_bf16_f32 v20, v8, v9
    v_cvt_pk_bf16_f32 v21, v10, v11
    v_cvt_pk_bf16_f32 v22, v12, v13
    v_cvt_pk_bf16_f32 v23, v14, v15
    buffer_store_dwordx4 v[20:23], v200, s[4:7], s31 offen offset:1024 sc1
    s_lshl_b32 s31, s27, 2
    s_add_u32 s31, s31, 0x20a000
    v_mov_b32 v207, 1
    s_waitcnt vmcnt(0)
    s_barrier
    s_mov_b64 exec, 1
    buffer_store_dword v207, v203, s[4:7], s31 offen sc1
    s_mov_b64 exec, -1
    s_add_u32 s25, s25, 4
    s_cmp_lt_u32 s25, 64
    s_cbranch_scc1 AL_45
    s_branch REC_DONE
W_FINQ:
    s_add_u32 s21, s21, 96
W_FIN:
    s_sub_u32 s24, s21, 160
    s_cmp_ge_u32 s24, 90
    s_cbranch_scc1 REC_DONE
    s_load_dwordx2 s[8:9], s[0:1], 40
    s_mov_b32 s10, 4718592
    s_mov_b32 s11, 0x20000
    s_load_dwordx2 s[12:13], s[0:1], 72
    s_mov_b32 s14, 663552
    s_mov_b32 s15, 0x20000
    s_load_dwordx2 s[16:17], s[0:1], 88
    s_mov_b32 s18, 2359296
    s_mov_b32 s19, 0x20000
    s_mov_b32 s25, 0
    s_mov_b32 s26, s24
    s_cmp_ge_u32 s26, 18
    s_cselect_b32 s31, 18, 0
    s_cselect_b32 s32, 1, 0
    s_sub_u32 s26, s26, s31
    s_add_u32 s25, s25, s32
    s_cmp_ge_u32 s26, 18
    s_cselect_b32 s31, 18, 0
    s_cselect_b32 s32, 1, 0
    s_sub_u32 s26, s26, s31
    s_add_u32 s25, s25, s32
    s_cmp_ge_u32 s26, 18
    s_cselect_b32 s31, 18, 0
    s_cselect_b32 s32, 1, 0
    s_sub_u32 s26, s26, s31
    s_add_u32 s25, s25, s32
    s_cmp_ge_u32 s26, 18
    s_cselect_b32 s31, 18, 0
    s_cselect_b32 s32, 1, 0
    s_sub_u32 s26, s26, s31
    s_add_u32 s25, s25, s32
    v_and_b32 v1, 15, v201
    v_lshrrev_b32 v2, 4, v201
    v_bfe_u32 v3, v201, 2, 2
    v_and_b32 v4, 3, v201
    v_lshrrev_b32 v5, 2, v201
    v_mul_u32_u24 v6, 1152, v5
    v_lshl_add_u32 v8, v4, 4, v6
    s_lshl_b32 s31, s26, 6
    v_add_u32 v8, s31, v8
    v_lshrrev_b32 v6, 1, v5
    v_mul_u32_u24 v6, 18, v6
    v_and_b32 v7, 1, v5
    v_add3_u32 v6, v6, v7, 16
    v_mul_u32_u24 v6, 1152, v6
    v_lshl_add_u32 v9, v4, 4, v6
    v_add_u32 v9, s31, v9
    v_lshl_add_u32 v5, v2, 2, v3
    v_lshlrev_b32 v5, 6, v5
    v_lshl_add_u32 v5, v4, 3, v5
    s_mul_i32 s34, s20, 36864
    v_add_u32 v10, s34, v5
    v_lshl_add_u32 v5, v2, 3, v3
    v_lshlrev_b32 v5, 6, v5
    v_lshl_add_u32 v5, v4, 3, v5
    v_add_u32 v11, s34, v5
    s_mul_i32 s35, s20, 1179648
    s_waitcnt lgkmcnt(0)
    s_add_u32 m0, s34, 0
    s_add_u32 s31, s35, 0
    buffer_load_dwordx4 v8, s[8:11], s31 offen lds
    s_add_u32 m0, s34, 1024
    s_add_u32 s31, s35, 18432
    buffer_load_dwordx4 v8, s[8:11], s31 offen lds
    s_add_u32 m0, s34, 2048
    s_add_u32 s31, s35, 36864
    buffer_load_dwordx4 v8, s[8:11], s31 offen lds
    s_add_u32 m0, s34, 3072
    s_add_u32 s31, s35, 55296
    buffer_load_dwordx4 v8, s[8:11], s31 offen lds
    s_add_u32 m0, s34, 4096
    s_add_u32 s31, s35, 73728
    buffer_load_dwordx4 v8, s[8:11], s31 offen lds
    s_add_u32 m0, s34, 5120
    s_add_u32 s31, s35, 92160
    buffer_load_dwordx4 v8, s[8:11], s31 offen lds
    s_add_u32 m0, s34, 6144
    s_add_u32 s31, s35, 110592
    buffer_load_dwordx4 v8, s[8:11], s31 offen lds
    s_add_u32 m0, s34, 7168
    s_add_u32 s31, s35, 129024
    buffer_load_dwordx4 v8, s[8:11], s31 offen lds
    s_add_u32 m0, s34, 9216
    s_add_u32 s31, s35, 147456
    buffer_load_dwordx4 v8, s[8:11], s31 offen lds
    s_add_u32 m0, s34, 10240
    s_add_u32 s31, s35, 165888
    buffer_load_dwordx4 v8, s[8:11], s31 offen lds
    s_add_u32 m0, s34, 11264
    s_add_u32 s31, s35, 184320
    buffer_load_dwordx4 v8, s[8:11], s31 offen lds
    s_add_u32 m0, s34, 12288
    s_add_u32 s31, s35, 202752
    buffer_load_dwordx4 v8, s[8:11], s31 offen lds
    s_add_u32 m0, s34, 13312
    s_add_u32 s31, s35, 221184
    buffer_load_dwordx4 v8, s[8:11], s31 offen lds
    s_add_u32 m0, s34, 14336
    s_add_u32 s31, s35, 239616
    buffer_load_dwordx4 v8, s[8:11], s31 offen lds
    s_add_u32 m0, s34, 15360
    s_add_u32 s31, s35, 258048
    buffer_load_dwordx4 v8, s[8:11], s31 offen lds
    s_add_u32 m0, s34, 16384
    s_add_u32 s31, s35, 276480
    buffer_load_dwordx4 v8, s[8:11], s31 offen lds
    s_add_u32 m0, s34, 18432
    s_add_u32 s31, s35, 294912
    buffer_load_dwordx4 v8, s[8:11], s31 offen lds
    s_add_u32 m0, s34, 19456
    s_add_u32 s31, s35, 313344
    buffer_load_dwordx4 v8, s[8:11], s31 offen lds
    s_add_u32 m0, s34, 20480
    s_add_u32 s31, s35, 331776
    buffer_load_dwordx4 v8, s[8:11], s31 offen lds
    s_add_u32 m0, s34, 21504
    s_add_u32 s31, s35, 350208
    buffer_load_dwordx4 v8, s[8:11], s31 offen lds
    s_add_u32 m0, s34, 22528
    s_add_u32 s31, s35, 368640
    buffer_load_dwordx4 v8, s[8:11], s31 offen lds
    s_add_u32 m0, s34, 23552
    s_add_u32 s31, s35, 387072
    buffer_load_dwordx4 v8, s[8:11], s31 offen lds
    s_add_u32 m0, s34, 24576
    s_add_u32 s31, s35, 405504
    buffer_load_dwordx4 v8, s[8:11], s31 offen lds
    s_add_u32 m0, s34, 25600
    s_add_u32 s31, s35, 423936
    buffer_load_dwordx4 v8, s[8:11], s31 offen lds
    s_add_u32 m0, s34, 27648
    s_add_u32 s31, s35, 442368
    buffer_load_dwordx4 v8, s[8:11], s31 offen lds
    s_add_u32 m0, s34, 28672
    s_add_u32 s31, s35, 460800
    buffer_load_dwordx4 v8, s[8:11], s31 offen lds
    s_add_u32 m0, s34, 29696
    s_add_u32 s31, s35, 479232
    buffer_load_dwordx4 v8, s[8:11], s31 offen lds
    s_add_u32 m0, s34, 30720
    s_add_u32 s31, s35, 497664
    buffer_load_dwordx4 v8, s[8:11], s31 offen lds
    s_add_u32 m0, s34, 31744
    s_add_u32 s31, s35, 516096
    buffer_load_dwordx4 v8, s[8:11], s31 offen lds
    s_add_u32 m0, s34, 32768
    s_add_u32 s31, s35, 534528
    buffer_load_dwordx4 v8, s[8:11], s31 offen lds
    s_add_u32 m0, s34, 33792
    s_add_u32 s31, s35, 552960
    buffer_load_dwordx4 v8, s[8:11], s31 offen lds
    s_add_u32 m0, s34, 34816
    s_add_u32 s31, s35, 571392
    buffer_load_dwordx4 v8, s[8:11], s31 offen lds
    s_waitcnt vmcnt(24)
    ds_read_b64_tr_b16 a[0:1], v10 offset:0
    ds_read_b64_tr_b16 a[2:3], v10 offset:1024
    ds_read_b64_tr_b16 a[4:5], v10 offset:32
    ds_read_b64_tr_b16 a[6:7], v10 offset:1056
    ds_read_b64_tr_b16 a[8:9], v10 offset:2048
    ds_read_b64_tr_b16 a[10:11], v10 offset:3072
    ds_read_b64_tr_b16 a[12:13], v10 offset:2080
    ds_read_b64_tr_b16 a[14:15], v10 offset:3104
    ds_read_b64_tr_b16 a[16:17], v10 offset:4096
    ds_read_b64_tr_b16 a[18:19], v10 offset:5120
    ds_read_b64_tr_b16 a[20:21], v10 offset:4128
    ds_read_b64_tr_b16 a[22:23], v10 offset:5152
    ds_read_b64_tr_b16 a[24:25], v10 offset:6144
    ds_read_b64_tr_b16 a[26:27], v10 offset:7168
    ds_read_b64_tr_b16 a[28:29], v10 offset:6176
    ds_read_b64_tr_b16 a[30:31], v10 offset:7200
    s_waitcnt lgkmcnt(0)
    s_add_u32 m0, s34, 0
    s_add_u32 s31, s35, 589824
    buffer_load_dwordx4 v8, s[8:11], s31 offen lds
    s_add_u32 m0, s34, 1024
    s_add_u32 s31, s35, 608256
    buffer_load_dwordx4 v8, s[8:11], s31 offen lds
    s_add_u32 m0, s34, 2048
    s_add_u32 s31, s35, 626688
    buffer_load_dwordx4 v8, s[8:11], s31 offen lds
    s_add_u32 m0, s34, 3072
    s_add_u32 s31, s35, 645120
    buffer_load_dwordx4 v8, s[8:11], s31 offen lds
    s_add_u32 m0, s34, 4096
    s_add_u32 s31, s35, 663552
    buffer_load_dwordx4 v8, s[8:11], s31 offen lds
    s_add_u32 m0, s34, 5120
    s_add_u32 s31, s35, 681984
    buffer_load_dwordx4 v8, s[8:11], s31 offen lds
    s_add_u32 m0, s34, 6144
    s_add_u32 s31, s35, 700416
    buffer_load_dwordx4 v8, s[8:11], s31 offen lds
    s_add_u32 m0, s34, 7168
    s_add_u32 s31, s35, 718848
    buffer_load_dwordx4 v8, s[8:11], s31 offen lds
    s_waitcnt vmcnt(24)
    ds_read_b64_tr_b16 a[32:33], v10 offset:9216
    ds_read_b64_tr_b16 a[34:35], v10 offset:10240
    ds_read_b64_tr_b16 a[36:37], v10 offset:9248
    ds_read_b64_tr_b16 a[38:39], v10 offset:10272
    ds_read_b64_tr_b16 a[40:41], v10 offset:11264
    ds_read_b64_tr_b16 a[42:43], v10 offset:12288
    ds_read_b64_tr_b16 a[44:45], v10 offset:11296
    ds_read_b64_tr_b16 a[46:47], v10 offset:12320
    ds_read_b64_tr_b16 a[48:49], v10 offset:13312
    ds_read_b64_tr_b16 a[50:51], v10 offset:14336
    ds_read_b64_tr_b16 a[52:53], v10 offset:13344
    ds_read_b64_tr_b16 a[54:55], v10 offset:14368
    ds_read_b64_tr_b16 a[56:57], v10 offset:15360
    ds_read_b64_tr_b16 a[58:59], v10 offset:16384
    ds_read_b64_tr_b16 a[60:61], v10 offset:15392
    ds_read_b64_tr_b16 a[62:63], v10 offset:16416
    s_waitcnt lgkmcnt(0)
    s_add_u32 m0, s34, 9216
    s_add_u32 s31, s35, 737280
    buffer_load_dwordx4 v8, s[8:11], s31 offen lds
    s_add_u32 m0, s34, 10240
    s_add_u32 s31, s35, 755712
    buffer_load_dwordx4 v8, s[8:11], s31 offen lds
    s_add_u32 m0, s34, 11264
    s_add_u32 s31, s35, 774144
    buffer_load_dwordx4 v8, s[8:11], s31 offen lds
    s_add_u32 m0, s34, 12288
    s_add_u32 s31, s35, 792576
    buffer_load_dwordx4 v8, s[8:11], s31 offen lds
    s_add_u32 m0, s34, 13312
    s_add_u32 s31, s35, 811008
    buffer_load_dwordx4 v8, s[8:11], s31 offen lds
    s_add_u32 m0, s34, 14336
    s_add_u32 s31, s35, 829440
    buffer_load_dwordx4 v8, s[8:11], s31 offen lds
    s_add_u32 m0, s34, 15360
    s_add_u32 s31, s35, 847872
    buffer_load_dwordx4 v8, s[8:11], s31 offen lds
    s_add_u32 m0, s34, 16384
    s_add_u32 s31, s35, 866304
    buffer_load_dwordx4 v8, s[8:11], s31 offen lds
    s_waitcnt vmcnt(24)
    ds_read_b64_tr_b16 a[64:65], v10 offset:18432
    ds_read_b64_tr_b16 a[66:67], v10 offset:19456
    ds_read_b64_tr_b16 a[68:69], v10 offset:18464
    ds_read_b64_tr_b16 a[70:71], v10 offset:19488
    ds_read_b64_tr_b16 a[72:73], v10 offset:20480
    ds_read_b64_tr_b16 a[74:75], v10 offset:21504
    ds_read_b64_tr_b16 a[76:77], v10 offset:20512
    ds_read_b64_tr_b16 a[78:79], v10 offset:21536
    ds_read_b64_tr_b16 a[80:81], v10 offset:22528
    ds_read_b64_tr_b16 a[82:83], v10 offset:23552
    ds_read_b64_tr_b16 a[84:85], v10 offset:22560
    ds_read_b64_tr_b16 a[86:87], v10 offset:23584
    ds_read_b64_tr_b16 a[88:89], v10 offset:24576
    ds_read_b64_tr_b16 a[90:91], v10 offset:25600
    ds_read_b64_tr_b16 a[92:93], v10 offset:24608
    ds_read_b64_tr_b16 a[94:95], v10 offset:25632
    s_waitcnt lgkmcnt(0)
    s_add_u32 m0, s34, 18432
    s_add_u32 s31, s35, 884736
    buffer_load_dwordx4 v8, s[8:11], s31 offen lds
    s_add_u32 m0, s34, 19456
    s_add_u32 s31, s35, 903168
    buffer_load_dwordx4 v8, s[8:11], s31 offen lds
    s_add_u32 m0, s34, 20480
    s_add_u32 s31, s35, 921600
    buffer_load_dwordx4 v8, s[8:11], s31 offen lds
    s_add_u32 m0, s34, 21504
    s_add_u32 s31, s35, 940032
    buffer_load_dwordx4 v8, s[8:11], s31 offen lds
    s_add_u32 m0, s34, 22528
    s_add_u32 s31, s35, 958464
    buffer_load_dwordx4 v8, s[8:11], s31 offen lds
    s_add_u32 m0, s34, 23552
    s_add_u32 s31, s35, 976896
    buffer_load_dwordx4 v8, s[8:11], s31 offen lds
    s_add_u32 m0, s34, 24576
    s_add_u32 s31, s35, 995328
    buffer_load_dwordx4 v8, s[8:11], s31 offen lds
    s_add_u32 m0, s34, 25600
    s_add_u32 s31, s35, 1013760
    buffer_load_dwordx4 v8, s[8:11], s31 offen lds
    s_waitcnt vmcnt(24)
    ds_read_b64_tr_b16 a[96:97], v10 offset:27648
    ds_read_b64_tr_b16 a[98:99], v10 offset:28672
    ds_read_b64_tr_b16 a[100:101], v10 offset:27680
    ds_read_b64_tr_b16 a[102:103], v10 offset:28704
    ds_read_b64_tr_b16 a[104:105], v10 offset:29696
    ds_read_b64_tr_b16 a[106:107], v10 offset:30720
    ds_read_b64_tr_b16 a[108:109], v10 offset:29728
    ds_read_b64_tr_b16 a[110:111], v10 offset:30752
    ds_read_b64_tr_b16 a[112:113], v10 offset:31744
    ds_read_b64_tr_b16 a[114:115], v10 offset:32768
    ds_read_b64_tr_b16 a[116:117], v10 offset:31776
    ds_read_b64_tr_b16 a[118:119], v10 offset:32800
    ds_read_b64_tr_b16 a[120:121], v10 offset:33792
    ds_read_b64_tr_b16 a[122:123], v10 offset:34816
    ds_read_b64_tr_b16 a[124:125], v10 offset:33824
    ds_read_b64_tr_b16 a[126:127], v10 offset:34848
    s_waitcnt lgkmcnt(0)
    s_add_u32 m0, s34, 27648
    s_add_u32 s31, s35, 1032192
    buffer_load_dwordx4 v8, s[8:11], s31 offen lds
    s_add_u32 m0, s34, 28672
    s_add_u32 s31, s35, 1050624
    buffer_load_dwordx4 v8, s[8:11], s31 offen lds
    s_add_u32 m0, s34, 29696
    s_add_u32 s31, s35, 1069056
    buffer_load_dwordx4 v8, s[8:11], s31 offen lds
    s_add_u32 m0, s34, 30720
    s_add_u32 s31, s35, 1087488
    buffer_load_dwordx4 v8, s[8:11], s31 offen lds
    s_add_u32 m0, s34, 31744
    s_add_u32 s31, s35, 1105920
    buffer_load_dwordx4 v8, s[8:11], s31 offen lds
    s_add_u32 m0, s34, 32768
    s_add_u32 s31, s35, 1124352
    buffer_load_dwordx4 v8, s[8:11], s31 offen lds
    s_add_u32 m0, s34, 33792
    s_add_u32 s31, s35, 1142784
    buffer_load_dwordx4 v8, s[8:11], s31 offen lds
    s_add_u32 m0, s34, 34816
    s_add_u32 s31, s35, 1161216
    buffer_load_dwordx4 v8, s[8:11], s31 offen lds
    s_waitcnt vmcnt(24)
    ds_read_b64_tr_b16 a[128:129], v10 offset:0
    ds_read_b64_tr_b16 a[130:131], v10 offset:1024
    ds_read_b64_tr_b16 a[132:133], v10 offset:32
    ds_read_b64_tr_b16 a[134:135], v10 offset:1056
    ds_read_b64_tr_b16 a[136:137], v10 offset:2048
    ds_read_b64_tr_b16 a[138:139], v10 offset:3072
    ds_read_b64_tr_b16 a[140:141], v10 offset:2080
    ds_read_b64_tr_b16 a[142:143], v10 offset:3104
    ds_read_b64_tr_b16 a[144:145], v10 offset:4096
    ds_read_b64_tr_b16 a[146:147], v10 offset:5120
    ds_read_b64_tr_b16 a[148:149], v10 offset:4128
    ds_read_b64_tr_b16 a[150:151], v10 offset:5152
    ds_read_b64_tr_b16 a[152:153], v10 offset:6144
    ds_read_b64_tr_b16 a[154:155], v10 offset:7168
    ds_read_b64_tr_b16 a[156:157], v10 offset:6176
    ds_read_b64_tr_b16 a[158:159], v10 offset:7200
    s_waitcnt lgkmcnt(0)
    s_mul_i32 s32, s20, 165888
    s_add_u32 m0, s34, 0
    s_add_u32 s31, s32, 0
    buffer_load_dwordx4 v8, s[12:15], s31 offen lds
    s_add_u32 m0, s34, 1024
    s_add_u32 s31, s32, 18432
    buffer_load_dwordx4 v8, s[12:15], s31 offen lds
    s_add_u32 m0, s34, 2048
    s_add_u32 s31, s32, 36864
    buffer_load_dwordx4 v8, s[12:15], s31 offen lds
    s_add_u32 m0, s34, 3072
    s_add_u32 s31, s32, 55296
    buffer_load_dwordx4 v8, s[12:15], s31 offen lds
    s_add_u32 m0, s34, 4096
    s_add_u32 s31, s32, 73728
    buffer_load_dwordx4 v8, s[12:15], s31 offen lds
    s_add_u32 m0, s34, 5120
    s_add_u32 s31, s32, 92160
    buffer_load_dwordx4 v8, s[12:15], s31 offen lds
    s_add_u32 m0, s34, 6144
    s_add_u32 s31, s32, 110592
    buffer_load_dwordx4 v8, s[12:15], s31 offen lds
    s_add_u32 m0, s34, 7168
    s_add_u32 s31, s32, 129024
    buffer_load_dwordx4 v8, s[12:15], s31 offen lds
    s_add_u32 m0, s34, 8192
    s_add_u32 s31, s32, 147456
    buffer_load_dwordx4 v8, s[12:15], s31 offen lds
    s_waitcnt vmcnt(25)
    ds_read_b64_tr_b16 a[160:161], v10 offset:9216
    ds_read_b64_tr_b16 a[162:163], v10 offset:10240
    ds_read_b64_tr_b16 a[164:165], v10 offset:9248
    ds_read_b64_tr_b16 a[166:167], v10 offset:10272
    ds_read_b64_tr_b16 a[168:169], v10 offset:11264
    ds_read_b64_tr_b16 a[170:171], v10 offset:12288
    ds_read_b64_tr_b16 a[172:173], v10 offset:11296
    ds_read_b64_tr_b16 a[174:175], v10 offset:12320
    ds_read_b64_tr_b16 a[176:177], v10 offset:13312
    ds_read_b64_tr_b16 a[178:179], v10 offset:14336
    ds_read_b64_tr_b16 a[180:181], v10 offset:13344
    ds_read_b64_tr_b16 a[182:183], v10 offset:14368
    ds_read_b64_tr_b16 a[184:185], v10 offset:15360
    ds_read_b64_tr_b16 a[186:187], v10 offset:16384
    ds_read_b64_tr_b16 a[188:189], v10 offset:15392
    ds_read_b64_tr_b16 a[190:191], v10 offset:16416
    s_waitcnt lgkmcnt(0)
    s_mul_i32 s32, s20, 331776
    s_add_u32 m0, s34, 9216
    s_add_u32 s31, s32, 0
    buffer_load_dwordx4 v9, s[12:15], s31 offen lds
    s_add_u32 m0, s34, 10240
    s_add_u32 s31, s32, 165888
    buffer_load_dwordx4 v9, s[12:15], s31 offen lds
    s_waitcnt vmcnt(19)
    ds_read_b64_tr_b16 a[192:193], v10 offset:18432
    ds_read_b64_tr_b16 a[194:195], v10 offset:19456
    ds_read_b64_tr_b16 a[196:197], v10 offset:18464
    ds_read_b64_tr_b16 a[198:199], v10 offset:19488
    ds_read_b64_tr_b16 a[200:201], v10 offset:20480
    ds_read_b64_tr_b16 a[202:203], v10 offset:21504
    ds_read_b64_tr_b16 a[204:205], v10 offset:20512
    ds_read_b64_tr_b16 a[206:207], v10 offset:21536
    ds_read_b64_tr_b16 a[208:209], v10 offset:22528
    ds_read_b64_tr_b16 a[210:211], v10 offset:23552
    ds_read_b64_tr_b16 a[212:213], v10 offset:22560
    ds_read_b64_tr_b16 a[214:215], v10 offset:23584
    ds_read_b64_tr_b16 a[216:217], v10 offset:24576
    ds_read_b64_tr_b16 a[218:219], v10 offset:25600
    ds_read_b64_tr_b16 a[220:221], v10 offset:24608
    ds_read_b64_tr_b16 a[222:223], v10 offset:25632
    s_waitcnt vmcnt(11)
    ds_read_b64_tr_b16 a[224:225], v10 offset:27648
    ds_read_b64_tr_b16 a[226:227], v10 offset:28672
    ds_read_b64_tr_b16 a[228:229], v10 offset:27680
    ds_read_b64_tr_b16 a[230:231], v10 offset:28704
    ds_read_b64_tr_b16 a[232:233], v10 offset:29696
    ds_read_b64_tr_b16 a[234:235], v10 offset:30720
    ds_read_b64_tr_b16 a[236:237], v10 offset:29728
    ds_read_b64_tr_b16 a[238:239], v10 offset:30752
    ds_read_b64_tr_b16 a[240:241], v10 offset:31744
    ds_read_b64_tr_b16 a[242:243], v10 offset:32768
    ds_read_b64_tr_b16 a[244:245], v10 offset:31776
    ds_read_b64_tr_b16 a[246:247], v10 offset:32800
    ds_read_b64_tr_b16 a[248:249], v10 offset:33792
    ds_read_b64_tr_b16 a[250:251], v10 offset:34816
    ds_read_b64_tr_b16 a[252:253], v10 offset:33824
    ds_read_b64_tr_b16 a[254:255], v10 offset:34848
    s_waitcnt vmcnt(2)
    ds_read_b64_tr_b16 v[208:209], v10 offset:0
    ds_read_b64_tr_b16 v[210:211], v10 offset:1152
    ds_read_b64_tr_b16 v[212:213], v10 offset:32
    ds_read_b64_tr_b16 v[214:215], v10 offset:1184
    ds_read_b64_tr_b16 v[216:217], v10 offset:2304
    ds_read_b64_tr_b16 v[218:219], v10 offset:3456
    ds_read_b64_tr_b16 v[220:221], v10 offset:2336
    ds_read_b64_tr_b16 v[222:223], v10 offset:3488
    ds_read_b64_tr_b16 v[224:225], v10 offset:4608
    ds_read_b64_tr_b16 v[226:227], v10 offset:5760
    ds_read_b64_tr_b16 v[228:229], v10 offset:4640
    ds_read_b64_tr_b16 v[230:231], v10 offset:5792
    ds_read_b64_tr_b16 v[232:233], v10 offset:6912
    ds_read_b64_tr_b16 v[234:235], v10 offset:8064
    ds_read_b64_tr_b16 v[236:237], v10 offset:6944
    ds_read_b64_tr_b16 v[238:239], v10 offset:8096
    s_waitcnt vmcnt(0)
    ds_read_b64_tr_b16 v[240:241], v11 offset:9216
    ds_read_b64_tr_b16 v[242:243], v11 offset:9472
    ds_read_b64_tr_b16 v[244:245], v11 offset:9248
    ds_read_b64_tr_b16 v[246:247], v11 offset:9504
    s_waitcnt lgkmcnt(0)
    s_barrier
    v_lshlrev_b32 v1, 3, v200
    s_mov_b32 s31, 0x20c000
    s_mov_b32 exec_lo, 0xffffffff
    s_mov_b32 exec_hi, 0xffffffff
POLL_53:
    buffer_load_dword v2, v1, s[4:7], s31 offen sc1
    s_waitcnt vmcnt(0)
    v_cmp_gt_u32 vcc, 1, v2
    s_cbranch_vccz POLLOK_54
    s_sleep 8
    s_sub_u32 s22, s22, 1
    s_cbranch_scc0 POLL_53
    s_mov_b64 exec, -1
    s_branch W_FAIL
POLLOK_54:
    s_mov_b64 exec, -1
    v_lshlrev_b32 v203, 2, v201
    v_and_b32 v204, 60, v203
    v_and_b32 v1, 15, v201
    v_mul_u32_u24 v1, 1152, v1
    v_lshrrev_b32 v2, 4, v201
    v_lshl_add_u32 v205, v2, 3, v1
    s_and_b32 s32, s20, 1
    s_lshl_b32 s31, s32, 5
    s_lshl_b32 s33, s26, 6
    s_add_u32 s31, s31, s33
    v_add_u32 v205, s31, v205
    s_lshl_b32 s31, s20, 11
    v_add_u32 v206, s31, v200
    s_lshl_b32 s31, s32, 10
    v_add_u32 v207, s31, v200
    s_lshl_b32 s40, s26, 7
    s_add_u32 s40, s40, 0x20f000
    v_mov_b32 v38, 0
    v_mov_b32 v39, 20480
    s_cmp_lg_u32 s20, 3
    s_cbranch_scc1 TK_55
    v_mov_b32 v35, 1
    s_mov_b64 exec, 1
    buffer_atomic_add v35, v38, s[4:7], s40 offen sc0
    s_mov_b64 exec, -1
TK_55:
    s_waitcnt vmcnt(0)
    s_cmp_lg_u32 s20, 3
    s_cbranch_scc1 TW_56
    s_mov_b64 exec, 1
    ds_write_b32 v39, v35
    s_mov_b64 exec, -1
TW_56:
    s_waitcnt lgkmcnt(0)
    s_barrier
    ds_read_b32 v33, v39
    v_xor_b32 v39, 64, v39
    s_waitcnt lgkmcnt(0)
    v_readfirstlane_b32 s25, v33
    s_nop 0
    s_cmp_ge_u32 s25, 128
    s_cbranch_scc1 REC_DONE
FL_57:
    s_mul_i32 s31, s25, 149504
    s_add_u32 s31, s31, 0x5000000
    s_lshl_b32 s32, s20, 15
    s_add_u32 s27, s31, s32
    s_lshl_b32 s32, s20, 12
    s_add_u32 s28, s31, s32
    s_add_u32 s28, s28, 131072
    s_and_b32 s32, s20, 1
    s_lshl_b32 s32, s32, 10
    s_add_u32 s29, s31, s32
    s_add_u32 s29, s29, 147456
    buffer_load_dwordx4 v[168:171], v200, s[4:7], s28 offen offset:0 sc1
    buffer_load_dwordx4 v[172:175], v200, s[4:7], s28 offen offset:1024 sc1
    buffer_load_dwordx4 v[176:179], v200, s[4:7], s28 offen offset:2048 sc1
    buffer_load_dwordx4 v[180:183], v200, s[4:7], s28 offen offset:3072 sc1
    buffer_load_dwordx4 v[184:187], v200, s[4:7], s29 offen sc1
    s_lshl_b32 s31, s25, 6
    s_add_u32 s32, s31, 0x280000
    buffer_load_dword v32, v204, s[4:7], s32 offen sc1
    s_lshr_b32 s31, s25, 1
    s_lshl_b32 s31, s31, 7
    s_lshl_b32 s32, s20, 5
    s_add_u32 s31, s31, s32
    s_add_u32 s31, s31, 0x20a000
    s_mov_b32 exec_lo, 0xff
    s_mov_b32 exec_hi, 0x0
POLL_58:
    buffer_load_dword v34, v203, s[4:7], s31 offen sc1
    s_waitcnt vmcnt(0)
    v_cmp_gt_u32 vcc, 1, v34
    s_cbranch_vccz POLLOK_59
    s_sleep 1
    s_sub_u32 s22, s22, 1
    s_cbranch_scc0 POLL_58
    s_mov_b64 exec, -1
    s_branch W_FAIL
POLLOK_59:
    s_mov_b64 exec, -1
    s_cmp_lg_u32 s20, 3
    s_cbranch_scc1 TK_60
    v_mov_b32 v35, 1
    s_mov_b64 exec, 1
    buffer_atomic_add v35, v38, s[4:7], s40 offen sc0
    s_mov_b64 exec, -1
TK_60:
    s_add_u32 s33, s27, 0
    buffer_load_dwordx4 v[40:43], v200, s[4:7], s33 offen offset:0 sc1
    buffer_load_dwordx4 v[44:47], v200, s[4:7], s33 offen offset:1024 sc1
    buffer_load_dwordx4 v[48:51], v200, s[4:7], s33 offen offset:2048 sc1
    buffer_load_dwordx4 v[52:55], v200, s[4:7], s33 offen offset:3072 sc1
    s_add_u32 s33, s27, 4096
    buffer_load_dwordx4 v[56:59], v200, s[4:7], s33 offen offset:0 sc1
    buffer_load_dwordx4 v[60:63], v200, s[4:7], s33 offen offset:1024 sc1
    buffer_load_dwordx4 v[64:67], v200, s[4:7], s33 offen offset:2048 sc1
    buffer_load_dwordx4 v[68:71], v200, s[4:7], s33 offen offset:3072 sc1
    s_add_u32 s33, s27, 8192
    buffer_load_dwordx4 v[72:75], v200, s[4:7], s33 offen offset:0 sc1
    buffer_load_dwordx4 v[76:79], v200, s[4:7], s33 offen offset:1024 sc1
    buffer_load_dwordx4 v[80:83], v200, s[4:7], s33 offen offset:2048 sc1
    buffer_load_dwordx4 v[84:87], v200, s[4:7], s33 offen offset:3072 sc1
    s_add_u32 s33, s27, 12288
    buffer_load_dwordx4 v[88:91], v200, s[4:7], s33 offen offset:0 sc1
    buffer_load_dwordx4 v[92:95], v200, s[4:7], s33 offen offset:1024 sc1
    buffer_load_dwordx4 v[96:99], v200, s[4:7], s33 offen offset:2048 sc1
    buffer_load_dwordx4 v[100:103], v200, s[4:7], s33 offen offset:3072 sc1
    s_add_u32 s33, s27, 16384
    buffer_load_dwordx4 v[104:107], v200, s[4:7], s33 offen offset:0 sc1
    buffer_load_dwordx4 v[108:111], v200, s[4:7], s33 offen offset:1024 sc1
    buffer_load_dwordx4 v[112:115], v200, s[4:7], s33 offen offset:2048 sc1
    buffer_load_dwordx4 v[116:119], v200, s[4:7], s33 offen offset:3072 sc1
    s_add_u32 s33, s27, 20480
    buffer_load_dwordx4 v[120:123], v200, s[4:7], s33 offen offset:0 sc1
    buffer_load_dwordx4 v[124:127], v200, s[4:7], s33 offen offset:1024 sc1
    buffer_load_dwordx4 v[128:131], v200, s[4:7], s33 offen offset:2048 sc1
    buffer_load_dwordx4 v[132:135], v200, s[4:7], s33 offen offset:3072 sc1
    s_add_u32 s33, s27, 24576
    buffer_load_dwordx4 v[136:139], v200, s[4:7], s33 offen offset:0 sc1
    buffer_load_dwordx4 v[140:143], v200, s[4:7], s33 offen offset:1024 sc1
    buffer_load_dwordx4 v[144:147], v200, s[4:7], s33 offen offset:2048 sc1
    buffer_load_dwordx4 v[148:151], v200, s[4:7], s33 offen offset:3072 sc1
    s_add_u32 s33, s27, 28672
    buffer_load_dwordx4 v[152:155], v200, s[4:7], s33 offen offset:0 sc1
    buffer_load_dwordx4 v[156:159], v200, s[4:7], s33 offen offset:1024 sc1
    buffer_load_dwordx4 v[160:163], v200, s[4:7], s33 offen offset:2048 sc1
    buffer_load_dwordx4 v[164:167], v200, s[4:7], s33 offen offset:3072 sc1
    v_mfma_f32_16x16x32_bf16 v[16:19], v[208:211], v[168:171], 0
    v_mfma_f32_16x16x32_bf16 v[20:23], v[212:215], v[168:171], 0
    v_mfma_f32_16x16x32_bf16 v[16:19], v[216:219], v[172:175], v[16:19]
    v_mfma_f32_16x16x32_bf16 v[20:23], v[220:223], v[172:175], v[20:23]
    v_mfma_f32_16x16x32_bf16 v[16:19], v[224:227], v[176:179], v[16:19]
    v_mfma_f32_16x16x32_bf16 v[20:23], v[228:231], v[176:179], v[20:23]
    v_mfma_f32_16x16x32_bf16 v[16:19], v[232:235], v[180:183], v[16:19]
    v_mfma_f32_16x16x32_bf16 v[20:23], v[236:239], v[180:183], v[20:23]
    v_mfma_f32_16x16x32_bf16 v[16:19], v[240:243], v[184:187], v[16:19]
    v_mfma_f32_16x16x32_bf16 v[20:23], v[244:247], v[184:187], v[20:23]
    s_waitcnt vmcnt(31)
    v_mfma_f32_16x16x32_bf16 v[0:3], a[0:3], v[40:43], 0
    v_mfma_f32_16x16x32_bf16 v[4:7], a[4:7], v[40:43], 0
    s_waitcnt vmcnt(30)
    v_mfma_f32_16x16x32_bf16 v[0:3], a[8:11], v[44:47], v[0:3]
    v_mfma_f32_16x16x32_bf16 v[4:7], a[12:15], v[44:47], v[4:7]
    s_waitcnt vmcnt(29)
    v_mfma_f32_16x16x32_bf16 v[0:3], a[16:19], v[48:51], v[0:3]
    v_mfma_f32_16x16x32_bf16 v[4:7], a[20:23], v[48:51], v[4:7]
    s_waitcnt vmcnt(28)
    v_mfma_f32_16x16x32_bf16 v[0:3], a[24:27], v[52:55], v[0:3]
    v_mfma_f32_16x16x32_bf16 v[4:7], a[28:31], v[52:55], v[4:7]
    s_waitcnt vmcnt(27)
    v_mfma_f32_16x16x32_bf16 v[0:3], a[32:35], v[56:59], v[0:3]
    v_mfma_f32_16x16x32_bf16 v[4:7], a[36:39], v[56:59], v[4:7]
    s_waitcnt vmcnt(26)
    v_mfma_f32_16x16x32_bf16 v[0:3], a[40:43], v[60:63], v[0:3]
    v_mfma_f32_16x16x32_bf16 v[4:7], a[44:47], v[60:63], v[4:7]
    s_waitcnt vmcnt(25)
    v_mfma_f32_16x16x32_bf16 v[0:3], a[48:51], v[64:67], v[0:3]
    v_mfma_f32_16x16x32_bf16 v[4:7], a[52:55], v[64:67], v[4:7]
    s_waitcnt vmcnt(24)
    v_mfma_f32_16x16x32_bf16 v[0:3], a[56:59], v[68:71], v[0:3]
    v_mfma_f32_16x16x32_bf16 v[4:7], a[60:63], v[68:71], v[4:7]
    s_waitcnt vmcnt(23)
    v_mfma_f32_16x16x32_bf16 v[0:3], a[64:67], v[72:75], v[0:3]
    v_mfma_f32_16x16x32_bf16 v[4:7], a[68:71], v[72:75], v[4:7]
    s_waitcnt vmcnt(22)
    v_mfma_f32_16x16x32_bf16 v[0:3], a[72:75], v[76:79], v[0:3]
    v_mfma_f32_16x16x32_bf16 v[4:7], a[76:79], v[76:79], v[4:7]
    s_waitcnt vmcnt(21)
    v_mfma_f32_16x16x32_bf16 v[0:3], a[80:83], v[80:83], v[0:3]
    v_mfma_f32_16x16x32_bf16 v[4:7], a[84:87], v[80:83], v[4:7]
    s_waitcnt vmcnt(20)
    v_mfma_f32_16x16x32_bf16 v[0:3], a[88:91], v[84:87], v[0:3]
    v_mfma_f32_16x16x32_bf16 v[4:7], a[92:95], v[84:87], v[4:7]
    s_waitcnt vmcnt(19)
    v_mfma_f32_16x16x32_bf16 v[0:3], a[96:99], v[88:91], v[0:3]
    v_mfma_f32_16x16x32_bf16 v[4:7], a[100:103], v[88:91], v[4:7]
    s_waitcnt vmcnt(18)
    v_mfma_f32_16x16x32_bf16 v[0:3], a[104:107], v[92:95], v[0:3]
    v_mfma_f32_16x16x32_bf16 v[4:7], a[108:111], v[92:95], v[4:7]
    s_waitcnt vmcnt(17)
    v_mfma_f32_16x16x32_bf16 v[0:3], a[112:115], v[96:99], v[0:3]
    v_mfma_f32_16x16x32_bf16 v[4:7], a[116:119], v[96:99], v[4:7]
    s_waitcnt vmcnt(16)
    v_mfma_f32_16x16x32_bf16 v[0:3], a[120:123], v[100:103], v[0:3]
    v_mfma_f32_16x16x32_bf16 v[4:7], a[124:127], v[100:103], v[4:7]
    s_waitcnt vmcnt(15)
    v_mfma_f32_16x16x32_bf16 v[0:3], a[128:131], v[104:107], v[0:3]
    v_mfma_f32_16x16x32_bf16 v[4:7], a[132:135], v[104:107], v[4:7]
    s_waitcnt vmcnt(14)
    v_mfma_f32_16x16x32_bf16 v[0:3], a[136:139], v[108:111], v[0:3]
    v_mfma_f32_16x16x32_bf16 v[4:7], a[140:143], v[108:111], v[4:7]
    s_waitcnt vmcnt(13)
    v_mfma_f32_16x16x32_bf16 v[0:3], a[144:147], v[112:115], v[0:3]
    v_mfma_f32_16x16x32_bf16 v[4:7], a[148:151], v[112:115], v[4:7]
    s_waitcnt vmcnt(12)
    v_mfma_f32_16x16x32_bf16 v[0:3], a[152:155], v[116:119], v[0:3]
    v_mfma_f32_16x16x32_bf16 v[4:7], a[156:159], v[116:119], v[4:7]
    s_waitcnt vmcnt(11)
    v_mfma_f32_16x16x32_bf16 v[0:3], a[160:163], v[120:123], v[0:3]
    v_mfma_f32_16x16x32_bf16 v[4:7], a[164:167], v[120:123], v[4:7]
    s_waitcnt vmcnt(10)
    v_mfma_f32_16x16x32_bf16 v[0:3], a[168:171], v[124:127], v[0:3]
    v_mfma_f32_16x16x32_bf16 v[4:7], a[172:175], v[124:127], v[4:7]
    s_waitcnt vmcnt(9)
    v_mfma_f32_16x16x32_bf16 v[0:3], a[176:179], v[128:131], v[0:3]
    v_mfma_f32_16x16x32_bf16 v[4:7], a[180:183], v[128:131], v[4:7]
    s_waitcnt vmcnt(8)
    v_mfma_f32_16x16x32_bf16 v[0:3], a[184:187], v[132:135], v[0:3]
    v_mfma_f32_16x16x32_bf16 v[4:7], a[188:191], v[132:135], v[4:7]
    s_waitcnt vmcnt(7)
    v_mfma_f32_16x16x32_bf16 v[0:3], a[192:195], v[136:139], v[0:3]
    v_mfma_f32_16x16x32_bf16 v[4:7], a[196:199], v[136:139], v[4:7]
    s_waitcnt vmcnt(6)
    v_mfma_f32_16x16x32_bf16 v[0:3], a[200:203], v[140:143], v[0:3]
    v_mfma_f32_16x16x32_bf16 v[4:7], a[204:207], v[140:143], v[4:7]
    s_waitcnt vmcnt(5)
    v_mfma_f32_16x16x32_bf16 v[0:3], a[208:211], v[144:147], v[0:3]
    v_mfma_f32_16x16x32_bf16 v[4:7], a[212:215], v[144:147], v[4:7]
    s_waitcnt vmcnt(4)
    v_mfma_f32_16x16x32_bf16 v[0:3], a[216:219], v[148:151], v[0:3]
    v_mfma_f32_16x16x32_bf16 v[4:7], a[220:223], v[148:151], v[4:7]
    s_waitcnt vmcnt(3)
    v_mfma_f32_16x16x32_bf16 v[0:3], a[224:227], v[152:155], v[0:3]
    v_mfma_f32_16x16x32_bf16 v[4:7], a[228:231], v[152:155], v[4:7]
    s_waitcnt vmcnt(2)
    v_mfma_f32_16x16x32_bf16 v[0:3], a[232:235], v[156:159], v[0:3]
    v_mfma_f32_16x16x32_bf16 v[4:7], a[236:239], v[156:159], v[4:7]
    s_waitcnt vmcnt(1)
    v_mfma_f32_16x16x32_bf16 v[0:3], a[240:243], v[160:163], v[0:3]
    v_mfma_f32_16x16x32_bf16 v[4:7], a[244:247], v[160:163], v[4:7]
    s_waitcnt vmcnt(0)
    v_mfma_f32_16x16x32_bf16 v[0:3], a[248:251], v[164:167], v[0:3]
    v_mfma_f32_16x16x32_bf16 v[4:7], a[252:255], v[164:167], v[4:7]
    s_nop 6
    v_sub_f32 v0, v0, v16
    v_fma_f32 v0, v0, v32, v16
    v_sub_f32 v1, v1, v17
    v_fma_f32 v1, v1, v32, v17
    v_sub_f32 v2, v2, v18
    v_fma_f32 v2, v2, v32, v18
    v_sub_f32 v3, v3, v19
    v_fma_f32 v3, v3, v32, v19
    v_sub_f32 v4, v4, v20
    v_fma_f32 v4, v4, v32, v20
    v_sub_f32 v5, v5, v21
    v_fma_f32 v5, v5, v32, v21
    v_sub_f32 v6, v6, v22
    v_fma_f32 v6, v6, v32, v22
    v_sub_f32 v7, v7, v23
    v_fma_f32 v7, v7, v32, v23
    ds_write_b128 v206, v[0:3] offset:0
    ds_write_b128 v206, v[4:7] offset:1024
    s_cmp_lg_u32 s20, 3
    s_cbranch_scc1 TW_61
    s_mov_b64 exec, 1
    ds_write_b32 v39, v35
    s_mov_b64 exec, -1
TW_61:
    s_waitcnt lgkmcnt(0)
    s_barrier
    ds_read_b32 v33, v39
    v_xor_b32 v39, 64, v39
    s_cmp_ge_u32 s20, 2
    s_cbranch_scc1 FSK_62
    ds_read_b128 v[16:19], v207 offset:0
    ds_read_b128 v[20:23], v207 offset:2048
    ds_read_b128 v[24:27], v207 offset:4096
    ds_read_b128 v[28:31], v207 offset:6144
    s_mul_i32 s31, s25, 18432
    s_waitcnt lgkmcnt(0)
    v_add_f32 v16, v16, v20
    v_add_f32 v24, v24, v28
    v_add_f32 v16, v16, v24
    v_add_f32 v17, v17, v21
    v_add_f32 v25, v25, v29
    v_add_f32 v17, v17, v25
    v_add_f32 v18, v18, v22
    v_add_f32 v26, v26, v30
    v_add_f32 v18, v18, v26
    v_add_f32 v19, v19, v23
    v_add_f32 v27, v27, v31
    v_add_f32 v19, v19, v27
    v_cvt_pk_bf16_f32 v36, v16, v17
    v_cvt_pk_bf16_f32 v37, v18, v19
    buffer_store_dwordx2 v[36:37], v205, s[16:19], s31 offen
FSK_62:
    v_xor_b32 v206, 8192, v206
    v_xor_b32 v207, 8192, v207
    s_waitcnt lgkmcnt(0)
    v_readfirstlane_b32 s25, v33
    s_nop 0
    s_cmp_lt_u32 s25, 128
    s_cbranch_scc1 FL_57
    s_branch REC_DONE
REC_FAIL:
W_FAIL:
    s_load_dwordx2 s[12:13], s[0:1], 96
    s_mov_b32 s14, 256
    s_mov_b32 s15, 0x20000
    v_mov_b32 v0, 0
    v_mov_b32 v1, s2
    v_add_u32 v1, 0x1000, v1
    s_waitcnt lgkmcnt(0)
    buffer_store_dword v1, v0, s[12:15], 0 offen offset:252
    s_endpgm
REC_DONE:
X_DONE:
    s_endpgm
.section .rodata,"a"
.p2align 6
.amdhsa_kernel gated_mix__memory_aug_recurrent_mem_tr__linear_attn_block__prompt_kernel
  .amdhsa_next_free_vgpr 512
  .amdhsa_next_free_sgpr 102
  .amdhsa_accum_offset 256
  .amdhsa_group_segment_fixed_size 0
  .amdhsa_kernarg_size 112
  .amdhsa_user_sgpr_count 2
  .amdhsa_user_sgpr_kernarg_segment_ptr 1
  .amdhsa_system_sgpr_workgroup_id_x 1
  .amdhsa_float_denorm_mode_32 3
.end_amdhsa_kernel
```
